```python
import torch

def _softmax(x, axis=-1):
    return torch.softmax(x, dim=axis)

def _gelu(x):
    return torch.nn.functional.gelu(x, approximate='tanh')

def _silu(x):
    return torch.nn.functional.silu(x)

def _sigmoid(x):
    return torch.sigmoid(x)

def _layernorm(x, axis=-1, eps=1e-05):
    m = x.mean(dim=axis, keepdim=True)
    v = x.var(dim=axis, keepdim=True, unbiased=False)
    return (x - m) / torch.sqrt(v + eps)

def _scatter_add(tgt, idx, src, axis=0):
    return tgt.clone().index_add_(axis, idx, src)

def _segment_sum(src, seg, n):
    out = torch.zeros((n,) + src.shape[1:], dtype=src.dtype)
    return out.index_add_(0, seg, src)

def _pad(x, pw):
    flat = tuple((v for pair in reversed(pw) for v in pair))
    return torch.nn.functional.pad(x, flat)
kernel_name = 'gated_mix__linear_attn_block__memory_aug_recurrent_mem_tr__prompt'

def setup_inputs():

    _w = lambda a: (lambda t: t.to(torch.bfloat16) if t.is_floating_point() else t)(torch.as_tensor(a))

    def _A_setup():
        B, S, D = (1, 2048, 448)
        return {'x': _w((lambda *s: torch.randn(*s, dtype=torch.bfloat16) * 0.05)(B, S, D)), 'wqkv': _w((lambda *s: torch.randn(*s, dtype=torch.bfloat16) * 1.6)(D, 3 * D)), 'wo': _w((lambda *s: torch.randn(*s, dtype=torch.bfloat16) * 0.1)(D, D))}
    _A_in = _A_setup()

    def _B_setup():
        B, S, Dm = (1, 2048, 448)
        H, Dh = (16, 256)
        M, seg = (8, 32)
        seg = min(seg, S)
        S = S // seg * seg
        return {'x': _w((lambda *s: torch.randn(*s, dtype=torch.bfloat16) * 0.05)(B, S, Dm)), 'mem0': _w((lambda *s: torch.randn(*s, dtype=torch.bfloat16) * 0.8)(B, M, Dm)), 'Wq': _w((lambda *s: torch.randn(*s, dtype=torch.bfloat16) * 3.2)(Dm, H, Dh) * Dm ** (-0.5)), 'Wk': _w((lambda *s: torch.randn(*s, dtype=torch.bfloat16) * 3.2)(Dm, H, Dh) * Dm ** (-0.5)), 'Wv': _w((lambda *s: torch.randn(*s, dtype=torch.bfloat16) * 0.8)(Dm, H, Dh) * Dm ** (-0.5)), 'Wo': _w((lambda *s: torch.randn(*s, dtype=torch.bfloat16) * 0.8)(H, Dh, Dm) * (H * Dh) ** (-0.5)), 'seg_len': seg}
    _B_in = _B_setup()
    return {'A_x': _A_in['x'], 'A_wqkv': _A_in['wqkv'], 'A_wo': _A_in['wo'], 'B_x': _B_in['x'], 'B_mem0': _B_in['mem0'], 'B_Wq': _B_in['Wq'], 'B_Wk': _B_in['Wk'], 'B_Wv': _B_in['Wv'], 'B_Wo': _B_in['Wo'], 'B_seg_len': _B_in['seg_len'], 'gate_w': _w((lambda *s: torch.randn(*s, dtype=torch.bfloat16) * 0.05)(448) * 16.0)}

def reference(A_x, A_wqkv, A_wo, B_x, B_mem0, B_Wq, B_Wk, B_Wv, B_Wo, B_seg_len, gate_w):

    def _A_ref(x, wqkv, wo):
        B, S, D = x.shape
        H = 16
        Dh = D // H
        qkv = (lambda x, *d: x.permute(*d))((x @ wqkv).reshape(B, S, 3, H, Dh), 2, 0, 3, 1, 4)
        q, k, v = (qkv[0], qkv[1], qkv[2])
        phi = lambda t: torch.where(t > 0, t + 1, torch.exp(t)) + 1e-06
        pq, pk = (phi(q), phi(k))
        kv = torch.einsum('bhsd,bhse->bhde', pk, v)
        z = torch.einsum('bhsd->bhd', pk)
        num = torch.einsum('bhqd,bhde->bhqe', pq, kv)
        den = torch.einsum('bhqd,bhd->bhq', pq, z)[..., None] + 1e-06
        o = num / den
        return (lambda x, *d: x.permute(*d))(o, 0, 2, 1, 3).reshape(B, S, D) @ wo

    def _B_ref(x, mem0, Wq, Wk, Wv, Wo, seg_len):
        B, S, Dm = x.shape
        H, Dh = (Wq.shape[1], Wq.shape[2])
        M = mem0.shape[1]
        scale = Dh ** (-0.5)
        n_seg = S // seg_len
        L = M + seg_len
        idx = torch.arange(L)
        mask = (idx[:, None] < M) | (idx[:, None] >= idx[None, :])
        mem = mem0
        outs = []
        for s in range(n_seg):
            xs = x[:, s * seg_len:(s + 1) * seg_len, :].clone()
            h = torch.concatenate([mem, xs], axis=1)
            q = torch.einsum('btd,dhe->bhte', h, Wq)
            k = torch.einsum('btd,dhe->bhte', h, Wk)
            v = torch.einsum('btd,dhe->bhte', h, Wv)
            scores = torch.einsum('bhqe,bhke->bhqk', q, k) * scale
            scores = torch.where(mask[None, None], scores, -1000000000.0)
            p = _softmax(scores, axis=-1)
            o = torch.einsum('bhqk,bhke->bhqe', p, v)
            o = torch.einsum('bhte,hed->btd', o, Wo)
            mem = o[:, :M, :].clone()
            outs.append(o[:, M:, :])
        return torch.concatenate(outs, axis=1)
    x = A_x
    g = _sigmoid((x * gate_w).sum(-1, keepdims=True))
    a = _A_ref(x, A_wqkv, A_wo)
    b = _B_ref(x, B_mem0, B_Wq, B_Wk, B_Wv, B_Wo, B_seg_len)
    return g * a + (1 - g) * b
```

```asm
; @launch grid=(256,1,1) block=(256,1,1) lds=159744
.amdgcn_target "amdgcn-amd-amdhsa--gfx950"
.text
.globl gated_mix__linear_attn_block__memory_aug_recurrent_mem_tr__prompt_kernel
.p2align 8
.type gated_mix__linear_attn_block__memory_aug_recurrent_mem_tr__prompt_kernel,@function
gated_mix__linear_attn_block__memory_aug_recurrent_mem_tr__prompt_kernel:
  s_cmp_ge_u32 s2, 256
  s_cbranch_scc1 Lk1_exit
  s_load_dwordx8 s[40:47], s[0:1], 40
  s_load_dwordx4 s[48:51], s[0:1], 96
  s_load_dwordx2 s[56:57], s[0:1], 32
  s_getpc_b64 s[76:77]
Lpf:
  s_bfe_u32 s75, s2, 0x30003
  s_lshl_b32 s75, s75, 14
  v_lshl_add_u32 v254, v0, 6, s75
  v_min_u32 v254, (Lk1_exit - Lpf), v254
  global_load_dword v255, v254, s[76:77]
  v_lshrrev_b32 v1, 6, v0
  v_and_b32 v0, 63, v0
  v_readfirstlane_b32 s20, v1
  s_and_b32 s28, s2, 7
  s_lshl_b32 s28, s28, 2
  s_lshr_b32 s29, s2, 6
  s_add_u32 s28, s28, s29
  s_and_b32 s21, s28, 1
  s_lshr_b32 s22, s28, 1
  s_bfe_u32 s23, s2, 0x10003
  s_bfe_u32 s24, s2, 0x20004
  v_lshrrev_b32 v14, 5, v0
  s_and_b32 s28, s20, 1
  s_lshl_b32 s28, s28, 1
  v_add_u32 v15, s28, v14
  v_and_b32 v16, 31, v0
  v_xor_b32 v15, v15, v16
  v_lshlrev_b32 v15, 4, v15
  v_lshl_add_u32 v4, v14, 13, v15
  v_xor_b32 v5, 64, v4
  v_xor_b32 v6, 128, v4
  v_xor_b32 v7, 192, v4
  s_lshl_b32 s30, s22, 9
  s_lshl_b32 s31, s20, 14
  s_add_u32 s30, s30, s31
  s_lshl_b32 s27, s20, 10
  s_mul_i32 s25, s23, 1835008
  s_add_u32 s25, s25, s30
  s_mov_b32 s10, 3670016
  s_mov_b32 s11, 0x20000
  s_mov_b32 s14, 3670016
  s_mov_b32 s15, 0x20000
  s_waitcnt lgkmcnt(0)
  s_cmp_eq_u32 s21, 0
  s_cselect_b64 s[8:9], s[40:41], s[44:45]
  s_cselect_b64 s[12:13], s[42:43], s[46:47]
  s_cbranch_scc0 Lk0_B
  s_mul_i32 s26, s24, 917504
  s_add_u32 s26, s26, s30
  s_add_u32 m0, s27, 0
  s_mov_b32 s28, 3
Lrow_1:
  buffer_load_dwordx4 v4, s[12:15], s26 offen lds
  s_add_u32 s26, s26, 65536
  s_add_u32 m0, m0, 4096
  s_nop 0
  buffer_load_dwordx4 v5, s[12:15], s26 offen lds
  s_add_u32 s26, s26, 65536
  s_add_u32 m0, m0, 4096
  s_nop 0
  buffer_load_dwordx4 v6, s[12:15], s26 offen lds
  s_add_u32 s26, s26, 65536
  s_add_u32 m0, m0, 4096
  s_nop 0
  buffer_load_dwordx4 v7, s[12:15], s26 offen lds
  s_add_u32 s26, s26, 65536
  s_add_u32 m0, m0, 4096
  s_sub_u32 s28, s28, 1
  s_cmp_lg_u32 s28, 0
  s_cbranch_scc1 Lrow_1
  buffer_load_dwordx4 v4, s[12:15], s26 offen lds
  s_add_u32 s26, s26, 65536
  s_add_u32 m0, m0, 4096
  s_nop 0
  buffer_load_dwordx4 v5, s[12:15], s26 offen lds
  s_add_u32 s26, s26, 65536
  s_add_u32 m0, m0, 4096
  s_add_u32 m0, s27, 57344
  s_mov_b32 s28, 6
Lrow_2:
  buffer_load_dwordx4 v4, s[8:11], s25 offen lds
  s_add_u32 s25, s25, 65536
  s_add_u32 m0, m0, 4096
  s_nop 0
  buffer_load_dwordx4 v5, s[8:11], s25 offen lds
  s_add_u32 s25, s25, 65536
  s_add_u32 m0, m0, 4096
  s_nop 0
  buffer_load_dwordx4 v6, s[8:11], s25 offen lds
  s_add_u32 s25, s25, 65536
  s_add_u32 m0, m0, 4096
  s_nop 0
  buffer_load_dwordx4 v7, s[8:11], s25 offen lds
  s_add_u32 s25, s25, 65536
  s_add_u32 m0, m0, 4096
  s_sub_u32 s28, s28, 1
  s_cmp_lg_u32 s28, 0
  s_cbranch_scc1 Lrow_2
  s_memrealtime s[72:73]
  s_getreg_b32 s74, hwreg(HW_REG_XCC_ID, 0, 4)
  s_mov_b32 s4, s50
  s_mov_b32 s5, s51
  s_mov_b32 s6, 0x10000000
  s_mov_b32 s7, 0x20000
  s_mov_b32 s68, s48
  s_mov_b32 s69, s49
  s_mov_b32 s70, 0x100
  s_mov_b32 s71, 0x20000
  s_waitcnt lgkmcnt(0)
  v_lshlrev_b32 v1, 4, v0
  v_and_b32 v2, 15, v0
  v_lshrrev_b32 v3, 4, v0
  s_lshl_b32 s28, s2, 2
  s_add_u32 s28, s28, s20
  s_sub_u32 s29, s28, 54
  s_min_u32 s29, s28, s29
  s_cmp_ge_u32 s28, 502
  s_cselect_b32 s31, 0, -1
  v_mov_b32 v20, s31
  v_mov_b32 v21, s31
  v_mov_b32 v22, s31
  v_mov_b32 v23, s31
  s_cmp_ge_u32 s28, 590
  s_cselect_b32 s31, 0x40000, s28
  s_lshl_b32 s31, s31, 10
  s_add_u32 s31, s31, 72024064
  s_cmp_ge_u32 s29, 7
  s_cbranch_scc1 Lgo_4
  s_mov_b32 s16, s56
  s_mov_b32 s17, s57
  s_mov_b32 s18, 7168
  s_mov_b32 s19, 0x20000
  s_lshl_b32 s29, s29, 7
  v_lshrrev_b32 v14, 1, v0
  v_lshlrev_b32 v14, 2, v14
  v_and_b32 v15, 1, v0
  v_mul_u32_u24 v15, 3584, v15
  v_add3_u32 v14, v14, v15, s29
  buffer_load_dword v20, v14, s[16:19], 0 offen offset:0
  buffer_load_dword v21, v14, s[16:19], 0 offen offset:896
  buffer_load_dword v22, v14, s[16:19], 0 offen offset:1792
  buffer_load_dword v23, v14, s[16:19], 0 offen offset:2688
  s_waitcnt vmcnt(0)
  s_mov_b32 s29, 0x05040100
  s_mov_b32 s32, 0x07060302
  v_perm_b32 v14, v21, v20, s29
  v_perm_b32 v21, v21, v20, s32
  v_min_u32 v20, -2, v14
  v_min_u32 v21, -2, v21
  v_perm_b32 v14, v23, v22, s29
  v_perm_b32 v23, v23, v22, s32
  v_min_u32 v22, -2, v14
  v_min_u32 v23, -2, v23
Lgo_4:
  buffer_store_dwordx4 v[20:23], v1, s[4:7], s31 offen sc1
  s_cmp_lg_u32 s20, 0
  s_cbranch_scc1 Lr0_5
  s_mov_b64 exec, 1
  s_lshl_b32 s75, s74, 2
  v_mov_b32 v249, s75
  v_mov_b32 v248, 1
  buffer_atomic_add v248, v249, s[68:71], 0 offen sc0
  s_cmp_lg_u32 s2, 0
  s_cbranch_scc1 Lr0_6
  s_or_b32 s72, s72, 1
  v_mov_b32 v250, s72
  buffer_store_dword v250, off, s[68:71], 0 offset:128 sc1
Lr0_6:
  s_mov_b64 exec, -1
Lr0_5:
  v_lshrrev_b32 v14, 2, v2
  v_and_b32 v15, 3, v2
  v_xor_b32 v16, v3, v15
  v_lshl_add_u32 v16, v14, 2, v16
  v_lshlrev_b32 v8, 12, v14
  v_lshl_add_u32 v8, v15, 9, v8
  v_lshl_add_u32 v8, v16, 4, v8
  v_add_u32 v8, 57344, v8
  v_xor_b32 v9, 64, v8
  v_xor_b32 v10, 128, v8
  v_xor_b32 v11, 192, v8
  s_mul_i32 s32, s23, 7168
  s_mul_i32 s28, s22, 401408
  s_add_u32 s32, s32, s28
  s_mul_i32 s28, s24, 7
  s_add_u32 s28, s28, s20
  s_mul_i32 s28, s28, 14336
  s_add_u32 s32, s32, s28
  v_mov_b32 v12, v1
  v_add_u32 v13, 57344, v1
  s_lshl_b32 s28, s20, 1
  v_lshrrev_b32 v14, 3, v2
  v_add_u32 v14, s28, v14
  v_and_b32 v14, 3, v14
  v_xor_b32 v16, v3, v15
  v_lshl_add_u32 v16, v14, 2, v16
  s_lshl_b32 s28, s20, 13
  v_lshlrev_b32 v14, 9, v2
  v_lshl_add_u32 v14, v16, 4, v14
  v_add_u32 v14, s28, v14
  v_xor_b32 v15, 64, v14
  v_xor_b32 v16, 128, v14
  v_xor_b32 v17, 192, v14
  s_cmp_lg_u32 s20, 3
  s_cbranch_scc1 Lw3_7
  v_mov_b32 v13, 0x40000000
Lw3_7:
  s_mov_b32 s29, 0x3db8aa3b
  s_waitcnt vmcnt(25)
  s_barrier
  ds_read_b128 v[24:27], v14 offset:0
  ds_read_b128 v[28:31], v15 offset:0
  ds_read_b128 v[32:35], v16 offset:0
  ds_read_b128 v[36:39], v17 offset:0
  ds_read_b128 v[40:43], v14 offset:256
  ds_read_b128 v[44:47], v15 offset:256
  ds_read_b128 v[48:51], v16 offset:256
  ds_read_b128 v[52:55], v17 offset:256
  ds_read_b128 v[56:59], v14 offset:32768
  ds_read_b128 v[60:63], v15 offset:32768
  ds_read_b128 v[64:67], v16 offset:32768
  ds_read_b128 v[68:71], v17 offset:32768
  ds_read_b128 v[72:75], v14 offset:33024
  ds_read_b128 v[76:79], v15 offset:33024
  ds_read_b128 v[80:83], v16 offset:33024
  ds_read_b128 v[84:87], v17 offset:33024
  s_waitcnt lgkmcnt(0)
  s_barrier
  s_add_u32 m0, s27, 0
  s_nop 0
  buffer_load_dwordx4 v4, s[8:11], s25 offen lds
  s_add_u32 s25, s25, 65536
  s_add_u32 m0, m0, 4096
  s_nop 0
  buffer_load_dwordx4 v5, s[8:11], s25 offen lds
  s_add_u32 s25, s25, 65536
  s_add_u32 m0, m0, 4096
  s_nop 0
  buffer_load_dwordx4 v6, s[8:11], s25 offen lds
  s_add_u32 s25, s25, 65536
  s_add_u32 m0, m0, 4096
  s_nop 0
  buffer_load_dwordx4 v7, s[8:11], s25 offen lds
  s_add_u32 s25, s25, 65536
  s_add_u32 m0, m0, 4096
  s_waitcnt vmcnt(25)
  s_barrier
  ds_read_b128 v[120:123], v8 offset:0
  ds_read_b128 v[124:127], v8 offset:2048
  ds_read_b128 v[128:131], v9 offset:0
  ds_read_b128 v[132:135], v9 offset:2048
  ds_read_b128 v[136:139], v10 offset:0
  ds_read_b128 v[140:143], v10 offset:2048
  ds_read_b128 v[144:147], v11 offset:0
  ds_read_b128 v[148:151], v11 offset:2048
  ds_read_b128 v[152:155], v8 offset:256
  ds_read_b128 v[156:159], v8 offset:2304
  ds_read_b128 v[160:163], v9 offset:256
  ds_read_b128 v[164:167], v9 offset:2304
  ds_read_b128 v[168:171], v10 offset:256
  ds_read_b128 v[172:175], v10 offset:2304
  ds_read_b128 v[176:179], v11 offset:256
  ds_read_b128 v[180:183], v11 offset:2304
  s_waitcnt vmcnt(21)
  s_barrier
  v_add_u32 v8, 16384, v8
  v_add_u32 v9, 16384, v9
  v_add_u32 v10, 16384, v10
  v_add_u32 v11, 16384, v11
  s_waitcnt lgkmcnt(0)
  v_mfma_f32_16x16x32_bf16 v[88:91], v[120:123], v[24:27], 0
  v_mfma_f32_16x16x32_bf16 v[92:95], v[124:127], v[24:27], 0
  ds_read_b128 v[184:187], v8 offset:0
  v_mfma_f32_16x16x32_bf16 v[96:99], v[120:123], v[56:59], 0
  v_mfma_f32_16x16x32_bf16 v[100:103], v[124:127], v[56:59], 0
  ds_read_b128 v[188:191], v8 offset:2048
  v_mfma_f32_16x16x32_bf16 v[88:91], v[128:131], v[28:31], v[88:91]
  v_mfma_f32_16x16x32_bf16 v[92:95], v[132:135], v[28:31], v[92:95]
  ds_read_b128 v[192:195], v9 offset:0
  v_mfma_f32_16x16x32_bf16 v[96:99], v[128:131], v[60:63], v[96:99]
  v_mfma_f32_16x16x32_bf16 v[100:103], v[132:135], v[60:63], v[100:103]
  ds_read_b128 v[196:199], v9 offset:2048
  v_mfma_f32_16x16x32_bf16 v[88:91], v[136:139], v[32:35], v[88:91]
  v_mfma_f32_16x16x32_bf16 v[92:95], v[140:143], v[32:35], v[92:95]
  ds_read_b128 v[200:203], v10 offset:0
  v_mfma_f32_16x16x32_bf16 v[96:99], v[136:139], v[64:67], v[96:99]
  v_mfma_f32_16x16x32_bf16 v[100:103], v[140:143], v[64:67], v[100:103]
  ds_read_b128 v[204:207], v10 offset:2048
  v_mfma_f32_16x16x32_bf16 v[88:91], v[144:147], v[36:39], v[88:91]
  v_mfma_f32_16x16x32_bf16 v[92:95], v[148:151], v[36:39], v[92:95]
  ds_read_b128 v[208:211], v11 offset:0
  v_mfma_f32_16x16x32_bf16 v[96:99], v[144:147], v[68:71], v[96:99]
  v_mfma_f32_16x16x32_bf16 v[100:103], v[148:151], v[68:71], v[100:103]
  ds_read_b128 v[212:215], v11 offset:2048
  v_mfma_f32_16x16x32_bf16 v[88:91], v[152:155], v[40:43], v[88:91]
  v_mfma_f32_16x16x32_bf16 v[92:95], v[156:159], v[40:43], v[92:95]
  ds_read_b128 v[216:219], v8 offset:256
  v_mfma_f32_16x16x32_bf16 v[96:99], v[152:155], v[72:75], v[96:99]
  v_mfma_f32_16x16x32_bf16 v[100:103], v[156:159], v[72:75], v[100:103]
  ds_read_b128 v[220:223], v8 offset:2304
  v_mfma_f32_16x16x32_bf16 v[88:91], v[160:163], v[44:47], v[88:91]
  v_mfma_f32_16x16x32_bf16 v[92:95], v[164:167], v[44:47], v[92:95]
  ds_read_b128 v[224:227], v9 offset:256
  v_mfma_f32_16x16x32_bf16 v[96:99], v[160:163], v[76:79], v[96:99]
  v_mfma_f32_16x16x32_bf16 v[100:103], v[164:167], v[76:79], v[100:103]
  ds_read_b128 v[228:231], v9 offset:2304
  v_mfma_f32_16x16x32_bf16 v[88:91], v[168:171], v[48:51], v[88:91]
  v_mfma_f32_16x16x32_bf16 v[92:95], v[172:175], v[48:51], v[92:95]
  ds_read_b128 v[232:235], v10 offset:256
  v_mfma_f32_16x16x32_bf16 v[96:99], v[168:171], v[80:83], v[96:99]
  v_mfma_f32_16x16x32_bf16 v[100:103], v[172:175], v[80:83], v[100:103]
  ds_read_b128 v[236:239], v10 offset:2304
  v_mfma_f32_16x16x32_bf16 v[88:91], v[176:179], v[52:55], v[88:91]
  v_mfma_f32_16x16x32_bf16 v[92:95], v[180:183], v[52:55], v[92:95]
  ds_read_b128 v[240:243], v11 offset:256
  v_mfma_f32_16x16x32_bf16 v[96:99], v[176:179], v[84:87], v[96:99]
  v_mfma_f32_16x16x32_bf16 v[100:103], v[180:183], v[84:87], v[100:103]
  ds_read_b128 v[244:247], v11 offset:2304
  s_waitcnt vmcnt(17)
  s_barrier
  v_add_u32 v8, 16384, v8
  v_add_u32 v9, 16384, v9
  v_add_u32 v10, 16384, v10
  v_add_u32 v11, 16384, v11
  s_waitcnt lgkmcnt(0)
  v_mfma_f32_16x16x32_bf16 v[104:107], v[184:187], v[24:27], 0
  v_mfma_f32_16x16x32_bf16 v[108:111], v[188:191], v[24:27], 0
  ds_read_b128 v[120:123], v8 offset:0
  v_mfma_f32_16x16x32_bf16 v[112:115], v[184:187], v[56:59], 0
  v_mul_f32 v88, s29, v88
  v_mfma_f32_16x16x32_bf16 v[116:119], v[188:191], v[56:59], 0
  ds_read_b128 v[124:127], v8 offset:2048
  v_mul_f32 v89, s29, v89
  v_mfma_f32_16x16x32_bf16 v[104:107], v[192:195], v[28:31], v[104:107]
  v_mul_f32 v90, s29, v90
  v_mfma_f32_16x16x32_bf16 v[108:111], v[196:199], v[28:31], v[108:111]
  ds_read_b128 v[128:131], v9 offset:0
  v_mul_f32 v91, s29, v91
  v_mfma_f32_16x16x32_bf16 v[112:115], v[192:195], v[60:63], v[112:115]
  v_mul_f32 v92, s29, v92
  v_mfma_f32_16x16x32_bf16 v[116:119], v[196:199], v[60:63], v[116:119]
  ds_read_b128 v[132:135], v9 offset:2048
  v_mul_f32 v93, s29, v93
  v_mfma_f32_16x16x32_bf16 v[104:107], v[200:203], v[32:35], v[104:107]
  v_mul_f32 v94, s29, v94
  v_mfma_f32_16x16x32_bf16 v[108:111], v[204:207], v[32:35], v[108:111]
  ds_read_b128 v[136:139], v10 offset:0
  v_mul_f32 v95, s29, v95
  v_mfma_f32_16x16x32_bf16 v[112:115], v[200:203], v[64:67], v[112:115]
  v_cvt_pk_bf16_f32 v88, v88, v89
  v_mfma_f32_16x16x32_bf16 v[116:119], v[204:207], v[64:67], v[116:119]
  ds_read_b128 v[140:143], v10 offset:2048
  v_cvt_pk_bf16_f32 v89, v90, v91
  v_mfma_f32_16x16x32_bf16 v[104:107], v[208:211], v[36:39], v[104:107]
  v_cvt_pk_bf16_f32 v90, v92, v93
  v_mfma_f32_16x16x32_bf16 v[108:111], v[212:215], v[36:39], v[108:111]
  ds_read_b128 v[144:147], v11 offset:0
  v_cvt_pk_bf16_f32 v91, v94, v95
  v_mfma_f32_16x16x32_bf16 v[112:115], v[208:211], v[68:71], v[112:115]
  buffer_store_dwordx4 v[88:91], v12, s[4:7], s32 offen sc1
  v_mfma_f32_16x16x32_bf16 v[116:119], v[212:215], v[68:71], v[116:119]
  ds_read_b128 v[148:151], v11 offset:2048
  v_mul_f32 v96, s29, v96
  v_mfma_f32_16x16x32_bf16 v[104:107], v[216:219], v[40:43], v[104:107]
  v_mul_f32 v97, s29, v97
  v_mfma_f32_16x16x32_bf16 v[108:111], v[220:223], v[40:43], v[108:111]
  ds_read_b128 v[152:155], v8 offset:256
  v_mul_f32 v98, s29, v98
  v_mfma_f32_16x16x32_bf16 v[112:115], v[216:219], v[72:75], v[112:115]
  v_mul_f32 v99, s29, v99
  v_mfma_f32_16x16x32_bf16 v[116:119], v[220:223], v[72:75], v[116:119]
  ds_read_b128 v[156:159], v8 offset:2304
  v_mul_f32 v100, s29, v100
  v_mfma_f32_16x16x32_bf16 v[104:107], v[224:227], v[44:47], v[104:107]
  v_mul_f32 v101, s29, v101
  v_mfma_f32_16x16x32_bf16 v[108:111], v[228:231], v[44:47], v[108:111]
  ds_read_b128 v[160:163], v9 offset:256
  v_mul_f32 v102, s29, v102
  v_mfma_f32_16x16x32_bf16 v[112:115], v[224:227], v[76:79], v[112:115]
  v_mul_f32 v103, s29, v103
  v_mfma_f32_16x16x32_bf16 v[116:119], v[228:231], v[76:79], v[116:119]
  ds_read_b128 v[164:167], v9 offset:2304
  v_cvt_pk_bf16_f32 v96, v96, v97
  v_mfma_f32_16x16x32_bf16 v[104:107], v[232:235], v[48:51], v[104:107]
  v_cvt_pk_bf16_f32 v97, v98, v99
  v_mfma_f32_16x16x32_bf16 v[108:111], v[236:239], v[48:51], v[108:111]
  ds_read_b128 v[168:171], v10 offset:256
  v_cvt_pk_bf16_f32 v98, v100, v101
  v_mfma_f32_16x16x32_bf16 v[112:115], v[232:235], v[80:83], v[112:115]
  v_cvt_pk_bf16_f32 v99, v102, v103
  v_mfma_f32_16x16x32_bf16 v[116:119], v[236:239], v[80:83], v[116:119]
  ds_read_b128 v[172:175], v10 offset:2304
  buffer_store_dwordx4 v[96:99], v13, s[4:7], s32 offen sc1
  v_mfma_f32_16x16x32_bf16 v[104:107], v[240:243], v[52:55], v[104:107]
  s_add_u32 s32, s32, 1024
  v_mfma_f32_16x16x32_bf16 v[108:111], v[244:247], v[52:55], v[108:111]
  ds_read_b128 v[176:179], v11 offset:256
  v_mfma_f32_16x16x32_bf16 v[112:115], v[240:243], v[84:87], v[112:115]
  v_mfma_f32_16x16x32_bf16 v[116:119], v[244:247], v[84:87], v[116:119]
  ds_read_b128 v[180:183], v11 offset:2304
  s_waitcnt vmcnt(15)
  s_barrier
  v_add_u32 v8, 16384, v8
  v_add_u32 v9, 16384, v9
  v_add_u32 v10, 16384, v10
  v_add_u32 v11, 16384, v11
  s_waitcnt lgkmcnt(0)
  v_mfma_f32_16x16x32_bf16 v[88:91], v[120:123], v[24:27], 0
  v_mfma_f32_16x16x32_bf16 v[92:95], v[124:127], v[24:27], 0
  ds_read_b128 v[184:187], v8 offset:0
  v_mfma_f32_16x16x32_bf16 v[96:99], v[120:123], v[56:59], 0
  v_mul_f32 v104, s29, v104
  v_mfma_f32_16x16x32_bf16 v[100:103], v[124:127], v[56:59], 0
  ds_read_b128 v[188:191], v8 offset:2048
  v_mul_f32 v105, s29, v105
  v_mfma_f32_16x16x32_bf16 v[88:91], v[128:131], v[28:31], v[88:91]
  v_mul_f32 v106, s29, v106
  v_mfma_f32_16x16x32_bf16 v[92:95], v[132:135], v[28:31], v[92:95]
  ds_read_b128 v[192:195], v9 offset:0
  v_mul_f32 v107, s29, v107
  v_mfma_f32_16x16x32_bf16 v[96:99], v[128:131], v[60:63], v[96:99]
  v_mul_f32 v108, s29, v108
  v_mfma_f32_16x16x32_bf16 v[100:103], v[132:135], v[60:63], v[100:103]
  ds_read_b128 v[196:199], v9 offset:2048
  v_mul_f32 v109, s29, v109
  v_mfma_f32_16x16x32_bf16 v[88:91], v[136:139], v[32:35], v[88:91]
  v_mul_f32 v110, s29, v110
  v_mfma_f32_16x16x32_bf16 v[92:95], v[140:143], v[32:35], v[92:95]
  ds_read_b128 v[200:203], v10 offset:0
  v_mul_f32 v111, s29, v111
  v_mfma_f32_16x16x32_bf16 v[96:99], v[136:139], v[64:67], v[96:99]
  v_cvt_pk_bf16_f32 v104, v104, v105
  v_mfma_f32_16x16x32_bf16 v[100:103], v[140:143], v[64:67], v[100:103]
  ds_read_b128 v[204:207], v10 offset:2048
  v_cvt_pk_bf16_f32 v105, v106, v107
  v_mfma_f32_16x16x32_bf16 v[88:91], v[144:147], v[36:39], v[88:91]
  v_cvt_pk_bf16_f32 v106, v108, v109
  v_mfma_f32_16x16x32_bf16 v[92:95], v[148:151], v[36:39], v[92:95]
  ds_read_b128 v[208:211], v11 offset:0
  v_cvt_pk_bf16_f32 v107, v110, v111
  v_mfma_f32_16x16x32_bf16 v[96:99], v[144:147], v[68:71], v[96:99]
  buffer_store_dwordx4 v[104:107], v12, s[4:7], s32 offen sc1
  v_mfma_f32_16x16x32_bf16 v[100:103], v[148:151], v[68:71], v[100:103]
  ds_read_b128 v[212:215], v11 offset:2048
  v_mul_f32 v112, s29, v112
  v_mfma_f32_16x16x32_bf16 v[88:91], v[152:155], v[40:43], v[88:91]
  v_mul_f32 v113, s29, v113
  v_mfma_f32_16x16x32_bf16 v[92:95], v[156:159], v[40:43], v[92:95]
  ds_read_b128 v[216:219], v8 offset:256
  v_mul_f32 v114, s29, v114
  v_mfma_f32_16x16x32_bf16 v[96:99], v[152:155], v[72:75], v[96:99]
  v_mul_f32 v115, s29, v115
  v_mfma_f32_16x16x32_bf16 v[100:103], v[156:159], v[72:75], v[100:103]
  ds_read_b128 v[220:223], v8 offset:2304
  v_mul_f32 v116, s29, v116
  v_mfma_f32_16x16x32_bf16 v[88:91], v[160:163], v[44:47], v[88:91]
  v_mul_f32 v117, s29, v117
  v_mfma_f32_16x16x32_bf16 v[92:95], v[164:167], v[44:47], v[92:95]
  ds_read_b128 v[224:227], v9 offset:256
  v_mul_f32 v118, s29, v118
  v_mfma_f32_16x16x32_bf16 v[96:99], v[160:163], v[76:79], v[96:99]
  v_mul_f32 v119, s29, v119
  v_mfma_f32_16x16x32_bf16 v[100:103], v[164:167], v[76:79], v[100:103]
  ds_read_b128 v[228:231], v9 offset:2304
  v_cvt_pk_bf16_f32 v112, v112, v113
  v_mfma_f32_16x16x32_bf16 v[88:91], v[168:171], v[48:51], v[88:91]
  v_cvt_pk_bf16_f32 v113, v114, v115
  v_mfma_f32_16x16x32_bf16 v[92:95], v[172:175], v[48:51], v[92:95]
  ds_read_b128 v[232:235], v10 offset:256
  v_cvt_pk_bf16_f32 v114, v116, v117
  v_mfma_f32_16x16x32_bf16 v[96:99], v[168:171], v[80:83], v[96:99]
  v_cvt_pk_bf16_f32 v115, v118, v119
  v_mfma_f32_16x16x32_bf16 v[100:103], v[172:175], v[80:83], v[100:103]
  ds_read_b128 v[236:239], v10 offset:2304
  buffer_store_dwordx4 v[112:115], v13, s[4:7], s32 offen sc1
  v_mfma_f32_16x16x32_bf16 v[88:91], v[176:179], v[52:55], v[88:91]
  s_add_u32 s32, s32, 1024
  v_mfma_f32_16x16x32_bf16 v[92:95], v[180:183], v[52:55], v[92:95]
  ds_read_b128 v[240:243], v11 offset:256
  v_mfma_f32_16x16x32_bf16 v[96:99], v[176:179], v[84:87], v[96:99]
  v_mfma_f32_16x16x32_bf16 v[100:103], v[180:183], v[84:87], v[100:103]
  ds_read_b128 v[244:247], v11 offset:2304
  s_waitcnt vmcnt(13)
  s_barrier
  v_add_u32 v8, 16384, v8
  v_add_u32 v9, 16384, v9
  v_add_u32 v10, 16384, v10
  v_add_u32 v11, 16384, v11
  s_waitcnt lgkmcnt(0)
  v_mfma_f32_16x16x32_bf16 v[104:107], v[184:187], v[24:27], 0
  v_mfma_f32_16x16x32_bf16 v[108:111], v[188:191], v[24:27], 0
  ds_read_b128 v[120:123], v8 offset:0
  v_mfma_f32_16x16x32_bf16 v[112:115], v[184:187], v[56:59], 0
  v_mul_f32 v88, s29, v88
  v_mfma_f32_16x16x32_bf16 v[116:119], v[188:191], v[56:59], 0
  ds_read_b128 v[124:127], v8 offset:2048
  v_mul_f32 v89, s29, v89
  v_mfma_f32_16x16x32_bf16 v[104:107], v[192:195], v[28:31], v[104:107]
  v_mul_f32 v90, s29, v90
  v_mfma_f32_16x16x32_bf16 v[108:111], v[196:199], v[28:31], v[108:111]
  ds_read_b128 v[128:131], v9 offset:0
  v_mul_f32 v91, s29, v91
  v_mfma_f32_16x16x32_bf16 v[112:115], v[192:195], v[60:63], v[112:115]
  v_mul_f32 v92, s29, v92
  v_mfma_f32_16x16x32_bf16 v[116:119], v[196:199], v[60:63], v[116:119]
  ds_read_b128 v[132:135], v9 offset:2048
  v_mul_f32 v93, s29, v93
  v_mfma_f32_16x16x32_bf16 v[104:107], v[200:203], v[32:35], v[104:107]
  v_mul_f32 v94, s29, v94
  v_mfma_f32_16x16x32_bf16 v[108:111], v[204:207], v[32:35], v[108:111]
  ds_read_b128 v[136:139], v10 offset:0
  v_mul_f32 v95, s29, v95
  v_mfma_f32_16x16x32_bf16 v[112:115], v[200:203], v[64:67], v[112:115]
  v_cvt_pk_bf16_f32 v88, v88, v89
  v_mfma_f32_16x16x32_bf16 v[116:119], v[204:207], v[64:67], v[116:119]
  ds_read_b128 v[140:143], v10 offset:2048
  v_cvt_pk_bf16_f32 v89, v90, v91
  v_mfma_f32_16x16x32_bf16 v[104:107], v[208:211], v[36:39], v[104:107]
  v_cvt_pk_bf16_f32 v90, v92, v93
  v_mfma_f32_16x16x32_bf16 v[108:111], v[212:215], v[36:39], v[108:111]
  ds_read_b128 v[144:147], v11 offset:0
  v_cvt_pk_bf16_f32 v91, v94, v95
  v_mfma_f32_16x16x32_bf16 v[112:115], v[208:211], v[68:71], v[112:115]
  buffer_store_dwordx4 v[88:91], v12, s[4:7], s32 offen sc1
  v_mfma_f32_16x16x32_bf16 v[116:119], v[212:215], v[68:71], v[116:119]
  ds_read_b128 v[148:151], v11 offset:2048
  v_mul_f32 v96, s29, v96
  v_mfma_f32_16x16x32_bf16 v[104:107], v[216:219], v[40:43], v[104:107]
  v_mul_f32 v97, s29, v97
  v_mfma_f32_16x16x32_bf16 v[108:111], v[220:223], v[40:43], v[108:111]
  ds_read_b128 v[152:155], v8 offset:256
  v_mul_f32 v98, s29, v98
  v_mfma_f32_16x16x32_bf16 v[112:115], v[216:219], v[72:75], v[112:115]
  v_mul_f32 v99, s29, v99
  v_mfma_f32_16x16x32_bf16 v[116:119], v[220:223], v[72:75], v[116:119]
  ds_read_b128 v[156:159], v8 offset:2304
  v_mul_f32 v100, s29, v100
  v_mfma_f32_16x16x32_bf16 v[104:107], v[224:227], v[44:47], v[104:107]
  v_mul_f32 v101, s29, v101
  v_mfma_f32_16x16x32_bf16 v[108:111], v[228:231], v[44:47], v[108:111]
  ds_read_b128 v[160:163], v9 offset:256
  v_mul_f32 v102, s29, v102
  v_mfma_f32_16x16x32_bf16 v[112:115], v[224:227], v[76:79], v[112:115]
  v_mul_f32 v103, s29, v103
  v_mfma_f32_16x16x32_bf16 v[116:119], v[228:231], v[76:79], v[116:119]
  ds_read_b128 v[164:167], v9 offset:2304
  v_cvt_pk_bf16_f32 v96, v96, v97
  v_mfma_f32_16x16x32_bf16 v[104:107], v[232:235], v[48:51], v[104:107]
  v_cvt_pk_bf16_f32 v97, v98, v99
  v_mfma_f32_16x16x32_bf16 v[108:111], v[236:239], v[48:51], v[108:111]
  ds_read_b128 v[168:171], v10 offset:256
  v_cvt_pk_bf16_f32 v98, v100, v101
  v_mfma_f32_16x16x32_bf16 v[112:115], v[232:235], v[80:83], v[112:115]
  v_cvt_pk_bf16_f32 v99, v102, v103
  v_mfma_f32_16x16x32_bf16 v[116:119], v[236:239], v[80:83], v[116:119]
  ds_read_b128 v[172:175], v10 offset:2304
  buffer_store_dwordx4 v[96:99], v13, s[4:7], s32 offen sc1
  v_mfma_f32_16x16x32_bf16 v[104:107], v[240:243], v[52:55], v[104:107]
  s_add_u32 s32, s32, 1024
  v_mfma_f32_16x16x32_bf16 v[108:111], v[244:247], v[52:55], v[108:111]
  ds_read_b128 v[176:179], v11 offset:256
  v_mfma_f32_16x16x32_bf16 v[112:115], v[240:243], v[84:87], v[112:115]
  v_mfma_f32_16x16x32_bf16 v[116:119], v[244:247], v[84:87], v[116:119]
  ds_read_b128 v[180:183], v11 offset:2304
  s_waitcnt vmcnt(11)
  s_barrier
  v_add_u32 v8, 16384, v8
  v_add_u32 v9, 16384, v9
  v_add_u32 v10, 16384, v10
  v_add_u32 v11, 16384, v11
  s_waitcnt lgkmcnt(0)
  v_mfma_f32_16x16x32_bf16 v[88:91], v[120:123], v[24:27], 0
  v_mfma_f32_16x16x32_bf16 v[92:95], v[124:127], v[24:27], 0
  ds_read_b128 v[184:187], v8 offset:0
  v_mfma_f32_16x16x32_bf16 v[96:99], v[120:123], v[56:59], 0
  v_mul_f32 v104, s29, v104
  v_mfma_f32_16x16x32_bf16 v[100:103], v[124:127], v[56:59], 0
  ds_read_b128 v[188:191], v8 offset:2048
  v_mul_f32 v105, s29, v105
  v_mfma_f32_16x16x32_bf16 v[88:91], v[128:131], v[28:31], v[88:91]
  v_mul_f32 v106, s29, v106
  v_mfma_f32_16x16x32_bf16 v[92:95], v[132:135], v[28:31], v[92:95]
  ds_read_b128 v[192:195], v9 offset:0
  v_mul_f32 v107, s29, v107
  v_mfma_f32_16x16x32_bf16 v[96:99], v[128:131], v[60:63], v[96:99]
  v_mul_f32 v108, s29, v108
  v_mfma_f32_16x16x32_bf16 v[100:103], v[132:135], v[60:63], v[100:103]
  ds_read_b128 v[196:199], v9 offset:2048
  v_mul_f32 v109, s29, v109
  v_mfma_f32_16x16x32_bf16 v[88:91], v[136:139], v[32:35], v[88:91]
  v_mul_f32 v110, s29, v110
  v_mfma_f32_16x16x32_bf16 v[92:95], v[140:143], v[32:35], v[92:95]
  ds_read_b128 v[200:203], v10 offset:0
  v_mul_f32 v111, s29, v111
  v_mfma_f32_16x16x32_bf16 v[96:99], v[136:139], v[64:67], v[96:99]
  v_cvt_pk_bf16_f32 v104, v104, v105
  v_mfma_f32_16x16x32_bf16 v[100:103], v[140:143], v[64:67], v[100:103]
  ds_read_b128 v[204:207], v10 offset:2048
  v_cvt_pk_bf16_f32 v105, v106, v107
  v_mfma_f32_16x16x32_bf16 v[88:91], v[144:147], v[36:39], v[88:91]
  v_cvt_pk_bf16_f32 v106, v108, v109
  v_mfma_f32_16x16x32_bf16 v[92:95], v[148:151], v[36:39], v[92:95]
  ds_read_b128 v[208:211], v11 offset:0
  v_cvt_pk_bf16_f32 v107, v110, v111
  v_mfma_f32_16x16x32_bf16 v[96:99], v[144:147], v[68:71], v[96:99]
  buffer_store_dwordx4 v[104:107], v12, s[4:7], s32 offen sc1
  v_mfma_f32_16x16x32_bf16 v[100:103], v[148:151], v[68:71], v[100:103]
  ds_read_b128 v[212:215], v11 offset:2048
  v_mul_f32 v112, s29, v112
  v_mfma_f32_16x16x32_bf16 v[88:91], v[152:155], v[40:43], v[88:91]
  v_mul_f32 v113, s29, v113
  v_mfma_f32_16x16x32_bf16 v[92:95], v[156:159], v[40:43], v[92:95]
  ds_read_b128 v[216:219], v8 offset:256
  v_mul_f32 v114, s29, v114
  v_mfma_f32_16x16x32_bf16 v[96:99], v[152:155], v[72:75], v[96:99]
  v_mul_f32 v115, s29, v115
  v_mfma_f32_16x16x32_bf16 v[100:103], v[156:159], v[72:75], v[100:103]
  ds_read_b128 v[220:223], v8 offset:2304
  v_mul_f32 v116, s29, v116
  v_mfma_f32_16x16x32_bf16 v[88:91], v[160:163], v[44:47], v[88:91]
  v_mul_f32 v117, s29, v117
  v_mfma_f32_16x16x32_bf16 v[92:95], v[164:167], v[44:47], v[92:95]
  ds_read_b128 v[224:227], v9 offset:256
  v_mul_f32 v118, s29, v118
  v_mfma_f32_16x16x32_bf16 v[96:99], v[160:163], v[76:79], v[96:99]
  v_mul_f32 v119, s29, v119
  v_mfma_f32_16x16x32_bf16 v[100:103], v[164:167], v[76:79], v[100:103]
  ds_read_b128 v[228:231], v9 offset:2304
  v_cvt_pk_bf16_f32 v112, v112, v113
  v_mfma_f32_16x16x32_bf16 v[88:91], v[168:171], v[48:51], v[88:91]
  v_cvt_pk_bf16_f32 v113, v114, v115
  v_mfma_f32_16x16x32_bf16 v[92:95], v[172:175], v[48:51], v[92:95]
  ds_read_b128 v[232:235], v10 offset:256
  v_cvt_pk_bf16_f32 v114, v116, v117
  v_mfma_f32_16x16x32_bf16 v[96:99], v[168:171], v[80:83], v[96:99]
  v_cvt_pk_bf16_f32 v115, v118, v119
  v_mfma_f32_16x16x32_bf16 v[100:103], v[172:175], v[80:83], v[100:103]
  ds_read_b128 v[236:239], v10 offset:2304
  buffer_store_dwordx4 v[112:115], v13, s[4:7], s32 offen sc1
  v_mfma_f32_16x16x32_bf16 v[88:91], v[176:179], v[52:55], v[88:91]
  s_add_u32 s32, s32, 1024
  v_mfma_f32_16x16x32_bf16 v[92:95], v[180:183], v[52:55], v[92:95]
  ds_read_b128 v[240:243], v11 offset:256
  v_mfma_f32_16x16x32_bf16 v[96:99], v[176:179], v[84:87], v[96:99]
  v_mfma_f32_16x16x32_bf16 v[100:103], v[180:183], v[84:87], v[100:103]
  ds_read_b128 v[244:247], v11 offset:2304
  s_waitcnt vmcnt(8)
  s_barrier
  s_cmp_lg_u32 s20, 0
  s_cbranch_scc1 Lr1_8
  v_readfirstlane_b32 s75, v248
  s_nop 0
  s_cmp_lg_u32 s75, 31
  s_cbranch_scc1 Lr1_9
  s_cmp_lg_u32 s74, 3
  s_cbranch_scc1 Lr1_9
  s_mov_b64 exec, 1
  s_add_u32 s75, s74, 1
  v_mov_b32 v252, s75
  v_mov_b32 v253, 0
  buffer_atomic_cmpswap v[252:253], off, s[68:71], 0 offset:64
  s_mov_b64 exec, -1
Lr1_9:
  buffer_load_dword v250, off, s[68:71], 0 offset:128 sc1
Lr1_8:
  v_add_u32 v8, 4294828032, v8
  v_add_u32 v9, 4294828032, v9
  v_add_u32 v10, 4294828032, v10
  v_add_u32 v11, 4294828032, v11
  s_waitcnt lgkmcnt(0)
  v_mfma_f32_16x16x32_bf16 v[104:107], v[184:187], v[24:27], 0
  v_mfma_f32_16x16x32_bf16 v[108:111], v[188:191], v[24:27], 0
  ds_read_b128 v[120:123], v8 offset:0
  v_mfma_f32_16x16x32_bf16 v[112:115], v[184:187], v[56:59], 0
  v_mul_f32 v88, s29, v88
  v_mfma_f32_16x16x32_bf16 v[116:119], v[188:191], v[56:59], 0
  ds_read_b128 v[124:127], v8 offset:2048
  v_mul_f32 v89, s29, v89
  v_mfma_f32_16x16x32_bf16 v[104:107], v[192:195], v[28:31], v[104:107]
  v_mul_f32 v90, s29, v90
  v_mfma_f32_16x16x32_bf16 v[108:111], v[196:199], v[28:31], v[108:111]
  ds_read_b128 v[128:131], v9 offset:0
  v_mul_f32 v91, s29, v91
  v_mfma_f32_16x16x32_bf16 v[112:115], v[192:195], v[60:63], v[112:115]
  v_mul_f32 v92, s29, v92
  v_mfma_f32_16x16x32_bf16 v[116:119], v[196:199], v[60:63], v[116:119]
  ds_read_b128 v[132:135], v9 offset:2048
  v_mul_f32 v93, s29, v93
  v_mfma_f32_16x16x32_bf16 v[104:107], v[200:203], v[32:35], v[104:107]
  v_mul_f32 v94, s29, v94
  v_mfma_f32_16x16x32_bf16 v[108:111], v[204:207], v[32:35], v[108:111]
  ds_read_b128 v[136:139], v10 offset:0
  v_mul_f32 v95, s29, v95
  v_mfma_f32_16x16x32_bf16 v[112:115], v[200:203], v[64:67], v[112:115]
  v_cvt_pk_bf16_f32 v88, v88, v89
  v_mfma_f32_16x16x32_bf16 v[116:119], v[204:207], v[64:67], v[116:119]
  ds_read_b128 v[140:143], v10 offset:2048
  v_cvt_pk_bf16_f32 v89, v90, v91
  v_mfma_f32_16x16x32_bf16 v[104:107], v[208:211], v[36:39], v[104:107]
  v_cvt_pk_bf16_f32 v90, v92, v93
  v_mfma_f32_16x16x32_bf16 v[108:111], v[212:215], v[36:39], v[108:111]
  ds_read_b128 v[144:147], v11 offset:0
  v_cvt_pk_bf16_f32 v91, v94, v95
  v_mfma_f32_16x16x32_bf16 v[112:115], v[208:211], v[68:71], v[112:115]
  buffer_store_dwordx4 v[88:91], v12, s[4:7], s32 offen sc1
  v_mfma_f32_16x16x32_bf16 v[116:119], v[212:215], v[68:71], v[116:119]
  ds_read_b128 v[148:151], v11 offset:2048
  v_mul_f32 v96, s29, v96
  v_mfma_f32_16x16x32_bf16 v[104:107], v[216:219], v[40:43], v[104:107]
  v_mul_f32 v97, s29, v97
  v_mfma_f32_16x16x32_bf16 v[108:111], v[220:223], v[40:43], v[108:111]
  ds_read_b128 v[152:155], v8 offset:256
  v_mul_f32 v98, s29, v98
  v_mfma_f32_16x16x32_bf16 v[112:115], v[216:219], v[72:75], v[112:115]
  v_mul_f32 v99, s29, v99
  v_mfma_f32_16x16x32_bf16 v[116:119], v[220:223], v[72:75], v[116:119]
  ds_read_b128 v[156:159], v8 offset:2304
  v_mul_f32 v100, s29, v100
  v_mfma_f32_16x16x32_bf16 v[104:107], v[224:227], v[44:47], v[104:107]
  v_mul_f32 v101, s29, v101
  v_mfma_f32_16x16x32_bf16 v[108:111], v[228:231], v[44:47], v[108:111]
  ds_read_b128 v[160:163], v9 offset:256
  v_mul_f32 v102, s29, v102
  v_mfma_f32_16x16x32_bf16 v[112:115], v[224:227], v[76:79], v[112:115]
  v_mul_f32 v103, s29, v103
  v_mfma_f32_16x16x32_bf16 v[116:119], v[228:231], v[76:79], v[116:119]
  ds_read_b128 v[164:167], v9 offset:2304
  v_cvt_pk_bf16_f32 v96, v96, v97
  v_mfma_f32_16x16x32_bf16 v[104:107], v[232:235], v[48:51], v[104:107]
  v_cvt_pk_bf16_f32 v97, v98, v99
  v_mfma_f32_16x16x32_bf16 v[108:111], v[236:239], v[48:51], v[108:111]
  ds_read_b128 v[168:171], v10 offset:256
  v_cvt_pk_bf16_f32 v98, v100, v101
  v_mfma_f32_16x16x32_bf16 v[112:115], v[232:235], v[80:83], v[112:115]
  v_cvt_pk_bf16_f32 v99, v102, v103
  v_mfma_f32_16x16x32_bf16 v[116:119], v[236:239], v[80:83], v[116:119]
  ds_read_b128 v[172:175], v10 offset:2304
  buffer_store_dwordx4 v[96:99], v13, s[4:7], s32 offen sc1
  v_mfma_f32_16x16x32_bf16 v[104:107], v[240:243], v[52:55], v[104:107]
  s_add_u32 s32, s32, 1024
  v_mfma_f32_16x16x32_bf16 v[108:111], v[244:247], v[52:55], v[108:111]
  ds_read_b128 v[176:179], v11 offset:256
  v_mfma_f32_16x16x32_bf16 v[112:115], v[240:243], v[84:87], v[112:115]
  v_mfma_f32_16x16x32_bf16 v[116:119], v[244:247], v[84:87], v[116:119]
  ds_read_b128 v[180:183], v11 offset:2304
  s_waitcnt lgkmcnt(0)
  v_mfma_f32_16x16x32_bf16 v[88:91], v[120:123], v[24:27], 0
  v_mfma_f32_16x16x32_bf16 v[92:95], v[124:127], v[24:27], 0
  v_mfma_f32_16x16x32_bf16 v[96:99], v[120:123], v[56:59], 0
  v_mul_f32 v104, s29, v104
  v_mfma_f32_16x16x32_bf16 v[100:103], v[124:127], v[56:59], 0
  v_mul_f32 v105, s29, v105
  v_mfma_f32_16x16x32_bf16 v[88:91], v[128:131], v[28:31], v[88:91]
  v_mul_f32 v106, s29, v106
  v_mfma_f32_16x16x32_bf16 v[92:95], v[132:135], v[28:31], v[92:95]
  v_mul_f32 v107, s29, v107
  v_mfma_f32_16x16x32_bf16 v[96:99], v[128:131], v[60:63], v[96:99]
  v_mul_f32 v108, s29, v108
  v_mfma_f32_16x16x32_bf16 v[100:103], v[132:135], v[60:63], v[100:103]
  v_mul_f32 v109, s29, v109
  v_mfma_f32_16x16x32_bf16 v[88:91], v[136:139], v[32:35], v[88:91]
  v_mul_f32 v110, s29, v110
  v_mfma_f32_16x16x32_bf16 v[92:95], v[140:143], v[32:35], v[92:95]
  v_mul_f32 v111, s29, v111
  v_mfma_f32_16x16x32_bf16 v[96:99], v[136:139], v[64:67], v[96:99]
  v_cvt_pk_bf16_f32 v104, v104, v105
  v_mfma_f32_16x16x32_bf16 v[100:103], v[140:143], v[64:67], v[100:103]
  v_cvt_pk_bf16_f32 v105, v106, v107
  v_mfma_f32_16x16x32_bf16 v[88:91], v[144:147], v[36:39], v[88:91]
  v_cvt_pk_bf16_f32 v106, v108, v109
  v_mfma_f32_16x16x32_bf16 v[92:95], v[148:151], v[36:39], v[92:95]
  v_cvt_pk_bf16_f32 v107, v110, v111
  v_mfma_f32_16x16x32_bf16 v[96:99], v[144:147], v[68:71], v[96:99]
  buffer_store_dwordx4 v[104:107], v12, s[4:7], s32 offen sc1
  v_mfma_f32_16x16x32_bf16 v[100:103], v[148:151], v[68:71], v[100:103]
  v_mul_f32 v112, s29, v112
  v_mfma_f32_16x16x32_bf16 v[88:91], v[152:155], v[40:43], v[88:91]
  v_mul_f32 v113, s29, v113
  v_mfma_f32_16x16x32_bf16 v[92:95], v[156:159], v[40:43], v[92:95]
  v_mul_f32 v114, s29, v114
  v_mfma_f32_16x16x32_bf16 v[96:99], v[152:155], v[72:75], v[96:99]
  v_mul_f32 v115, s29, v115
  v_mfma_f32_16x16x32_bf16 v[100:103], v[156:159], v[72:75], v[100:103]
  v_mul_f32 v116, s29, v116
  v_mfma_f32_16x16x32_bf16 v[88:91], v[160:163], v[44:47], v[88:91]
  v_mul_f32 v117, s29, v117
  v_mfma_f32_16x16x32_bf16 v[92:95], v[164:167], v[44:47], v[92:95]
  v_mul_f32 v118, s29, v118
  v_mfma_f32_16x16x32_bf16 v[96:99], v[160:163], v[76:79], v[96:99]
  v_mul_f32 v119, s29, v119
  v_mfma_f32_16x16x32_bf16 v[100:103], v[164:167], v[76:79], v[100:103]
  v_cvt_pk_bf16_f32 v112, v112, v113
  v_mfma_f32_16x16x32_bf16 v[88:91], v[168:171], v[48:51], v[88:91]
  v_cvt_pk_bf16_f32 v113, v114, v115
  v_mfma_f32_16x16x32_bf16 v[92:95], v[172:175], v[48:51], v[92:95]
  v_cvt_pk_bf16_f32 v114, v116, v117
  v_mfma_f32_16x16x32_bf16 v[96:99], v[168:171], v[80:83], v[96:99]
  v_cvt_pk_bf16_f32 v115, v118, v119
  v_mfma_f32_16x16x32_bf16 v[100:103], v[172:175], v[80:83], v[100:103]
  buffer_store_dwordx4 v[112:115], v13, s[4:7], s32 offen sc1
  v_mfma_f32_16x16x32_bf16 v[88:91], v[176:179], v[52:55], v[88:91]
  s_add_u32 s32, s32, 1024
  v_mfma_f32_16x16x32_bf16 v[92:95], v[180:183], v[52:55], v[92:95]
  v_mfma_f32_16x16x32_bf16 v[96:99], v[176:179], v[84:87], v[96:99]
  v_mfma_f32_16x16x32_bf16 v[100:103], v[180:183], v[84:87], v[100:103]
  s_nop 3
  v_mul_f32 v88, s29, v88
  v_mul_f32 v89, s29, v89
  v_mul_f32 v90, s29, v90
  v_mul_f32 v91, s29, v91
  v_mul_f32 v92, s29, v92
  v_mul_f32 v93, s29, v93
  v_mul_f32 v94, s29, v94
  v_mul_f32 v95, s29, v95
  v_cvt_pk_bf16_f32 v88, v88, v89
  v_cvt_pk_bf16_f32 v89, v90, v91
  v_cvt_pk_bf16_f32 v90, v92, v93
  v_cvt_pk_bf16_f32 v91, v94, v95
  buffer_store_dwordx4 v[88:91], v12, s[4:7], s32 offen sc1
  v_mul_f32 v96, s29, v96
  v_mul_f32 v97, s29, v97
  v_mul_f32 v98, s29, v98
  v_mul_f32 v99, s29, v99
  v_mul_f32 v100, s29, v100
  v_mul_f32 v101, s29, v101
  v_mul_f32 v102, s29, v102
  v_mul_f32 v103, s29, v103
  v_cvt_pk_bf16_f32 v96, v96, v97
  v_cvt_pk_bf16_f32 v97, v98, v99
  v_cvt_pk_bf16_f32 v98, v100, v101
  v_cvt_pk_bf16_f32 v99, v102, v103
  buffer_store_dwordx4 v[96:99], v13, s[4:7], s32 offen sc1
  s_add_u32 s32, s32, 1024
  s_branch Lk0_done
Lk0_B:
  v_mul_u32_u24 v14, 0x124a, v0
  v_lshrrev_b32 v14, 16, v14
  v_mul_u32_u24 v15, 14, v14
  v_sub_u32 v15, v0, v15
  v_lshlrev_b32 v15, 4, v15
  v_mul_u32_u24 v14, 896, v14
  v_add_u32 v14, v14, v15
  s_mul_i32 s26, s22, 229376
  s_mul_i32 s28, s24, 224
  s_add_u32 s26, s26, s28
  s_mul_i32 s28, s20, 3584
  s_add_u32 s26, s26, s28
  s_mul_i32 s28, s20, 896
  s_mov_b32 exec_hi, 0xffffff
  s_mov_b32 m0, s28
  s_mov_b32 s28, 16
Lrow_10:
  buffer_load_dwordx4 v14, s[12:15], s26 offen lds
  s_add_u32 s26, s26, 14336
  s_add_u32 m0, m0, 3584
  s_sub_u32 s28, s28, 1
  s_cmp_lg_u32 s28, 0
  s_cbranch_scc1 Lrow_10
  s_mov_b32 exec_hi, -1
  s_add_u32 m0, s27, 57344
  s_mov_b32 s28, 6
Lrow_11:
  buffer_load_dwordx4 v4, s[8:11], s25 offen lds
  s_add_u32 s25, s25, 65536
  s_add_u32 m0, m0, 4096
  s_nop 0
  buffer_load_dwordx4 v5, s[8:11], s25 offen lds
  s_add_u32 s25, s25, 65536
  s_add_u32 m0, m0, 4096
  s_nop 0
  buffer_load_dwordx4 v6, s[8:11], s25 offen lds
  s_add_u32 s25, s25, 65536
  s_add_u32 m0, m0, 4096
  s_nop 0
  buffer_load_dwordx4 v7, s[8:11], s25 offen lds
  s_add_u32 s25, s25, 65536
  s_add_u32 m0, m0, 4096
  s_sub_u32 s28, s28, 1
  s_cmp_lg_u32 s28, 0
  s_cbranch_scc1 Lrow_11
  s_memrealtime s[72:73]
  s_getreg_b32 s74, hwreg(HW_REG_XCC_ID, 0, 4)
  s_mov_b32 s4, s50
  s_mov_b32 s5, s51
  s_mov_b32 s6, 0x10000000
  s_mov_b32 s7, 0x20000
  s_mov_b32 s68, s48
  s_mov_b32 s69, s49
  s_mov_b32 s70, 0x100
  s_mov_b32 s71, 0x20000
  s_waitcnt lgkmcnt(0)
  v_lshlrev_b32 v1, 4, v0
  v_and_b32 v2, 15, v0
  v_lshrrev_b32 v3, 4, v0
  s_lshl_b32 s28, s2, 2
  s_add_u32 s28, s28, s20
  s_sub_u32 s29, s28, 54
  s_min_u32 s29, s28, s29
  s_cmp_ge_u32 s28, 502
  s_cselect_b32 s31, 0, -1
  v_mov_b32 v20, s31
  v_mov_b32 v21, s31
  v_mov_b32 v22, s31
  v_mov_b32 v23, s31
  s_cmp_ge_u32 s28, 590
  s_cselect_b32 s31, 0x40000, s28
  s_lshl_b32 s31, s31, 10
  s_add_u32 s31, s31, 72024064
  s_cmp_ge_u32 s29, 7
  s_cbranch_scc1 Lgo_13
  s_mov_b32 s16, s56
  s_mov_b32 s17, s57
  s_mov_b32 s18, 7168
  s_mov_b32 s19, 0x20000
  s_lshl_b32 s29, s29, 7
  v_lshrrev_b32 v14, 1, v0
  v_lshlrev_b32 v14, 2, v14
  v_and_b32 v15, 1, v0
  v_mul_u32_u24 v15, 3584, v15
  v_add3_u32 v14, v14, v15, s29
  buffer_load_dword v20, v14, s[16:19], 0 offen offset:0
  buffer_load_dword v21, v14, s[16:19], 0 offen offset:896
  buffer_load_dword v22, v14, s[16:19], 0 offen offset:1792
  buffer_load_dword v23, v14, s[16:19], 0 offen offset:2688
  s_waitcnt vmcnt(0)
  s_mov_b32 s29, 0x05040100
  s_mov_b32 s32, 0x07060302
  v_perm_b32 v14, v21, v20, s29
  v_perm_b32 v21, v21, v20, s32
  v_min_u32 v20, -2, v14
  v_min_u32 v21, -2, v21
  v_perm_b32 v14, v23, v22, s29
  v_perm_b32 v23, v23, v22, s32
  v_min_u32 v22, -2, v14
  v_min_u32 v23, -2, v23
Lgo_13:
  buffer_store_dwordx4 v[20:23], v1, s[4:7], s31 offen sc1
  s_cmp_lg_u32 s20, 0
  s_cbranch_scc1 Lr0_14
  s_mov_b64 exec, 1
  s_lshl_b32 s75, s74, 2
  v_mov_b32 v249, s75
  v_mov_b32 v248, 1
  buffer_atomic_add v248, v249, s[68:71], 0 offen sc0
  s_cmp_lg_u32 s2, 0
  s_cbranch_scc1 Lr0_15
  s_or_b32 s72, s72, 1
  v_mov_b32 v250, s72
  buffer_store_dword v250, off, s[68:71], 0 offset:128 sc1
Lr0_15:
  s_mov_b64 exec, -1
Lr0_14:
  v_lshrrev_b32 v14, 2, v2
  v_and_b32 v15, 3, v2
  v_xor_b32 v16, v3, v15
  v_lshl_add_u32 v16, v14, 2, v16
  v_lshlrev_b32 v8, 12, v14
  v_lshl_add_u32 v8, v15, 9, v8
  v_lshl_add_u32 v8, v16, 4, v8
  v_add_u32 v8, 57344, v8
  v_xor_b32 v9, 64, v8
  v_xor_b32 v10, 128, v8
  v_xor_b32 v11, 192, v8
  s_mul_i32 s32, s23, 7168
  s_mul_i32 s28, s24, 1605632
  s_add_u32 s32, s32, s28
  s_add_u32 s32, s32, 6422528
  s_mul_i32 s29, s22, 28
  s_lshl_b32 s28, s20, 4
  v_add_u32 v14, s28, v2
  v_mul_u32_u24 v15, 0x925, v14
  v_lshrrev_b32 v15, 16, v15
  v_mul_u32_u24 v16, 28, v15
  v_sub_u32 v14, v14, v16
  v_add_u32 v14, s29, v14
  v_mul_u32_u24 v15, 401408, v15
  v_lshrrev_b32 v16, 4, v14
  v_mul_u32_u24 v16, 14336, v16
  v_and_b32 v14, 15, v14
  v_lshl_add_u32 v14, v3, 4, v14
  v_lshlrev_b32 v14, 4, v14
  v_add3_u32 v12, v14, v15, v16
  v_add_u32 v14, s28, v2
  v_add_u32 v14, 64, v14
  v_mul_u32_u24 v15, 0x925, v14
  v_lshrrev_b32 v15, 16, v15
  v_mul_u32_u24 v16, 28, v15
  v_sub_u32 v14, v14, v16
  v_add_u32 v14, s29, v14
  v_mul_u32_u24 v15, 401408, v15
  v_lshrrev_b32 v16, 4, v14
  v_mul_u32_u24 v16, 14336, v16
  v_and_b32 v14, 15, v14
  v_lshl_add_u32 v14, v3, 4, v14
  v_lshlrev_b32 v14, 4, v14
  v_add3_u32 v13, v14, v15, v16
  v_lshrrev_b32 v14, 2, v2
  v_lshl_add_u32 v14, v3, 3, v14
  v_mul_u32_u24 v14, 224, v14
  v_and_b32 v15, 3, v2
  v_lshl_add_u32 v14, v15, 3, v14
  s_lshl_b32 s28, s20, 5
  v_add_u32 v14, s28, v14
  s_cmp_lg_u32 s20, 3
  s_cbranch_scc1 Lw3_16
  v_mov_b32 v13, 0x40000000
Lw3_16:
  s_mov_b32 s29, 0x3db8aa3b
  s_waitcnt vmcnt(25)
  s_barrier
  ds_read_b64_tr_b16 v[24:25], v14 offset:0
  ds_read_b64_tr_b16 v[26:27], v14 offset:896
  ds_read_b64_tr_b16 v[28:29], v14 offset:7168
  ds_read_b64_tr_b16 v[30:31], v14 offset:8064
  ds_read_b64_tr_b16 v[32:33], v14 offset:14336
  ds_read_b64_tr_b16 v[34:35], v14 offset:15232
  ds_read_b64_tr_b16 v[36:37], v14 offset:21504
  ds_read_b64_tr_b16 v[38:39], v14 offset:22400
  ds_read_b64_tr_b16 v[40:41], v14 offset:28672
  ds_read_b64_tr_b16 v[42:43], v14 offset:29568
  ds_read_b64_tr_b16 v[44:45], v14 offset:35840
  ds_read_b64_tr_b16 v[46:47], v14 offset:36736
  ds_read_b64_tr_b16 v[48:49], v14 offset:43008
  ds_read_b64_tr_b16 v[50:51], v14 offset:43904
  ds_read_b64_tr_b16 v[52:53], v14 offset:50176
  ds_read_b64_tr_b16 v[54:55], v14 offset:51072
  ds_read_b64_tr_b16 v[56:57], v14 offset:128
  ds_read_b64_tr_b16 v[58:59], v14 offset:1024
  ds_read_b64_tr_b16 v[60:61], v14 offset:7296
  ds_read_b64_tr_b16 v[62:63], v14 offset:8192
  ds_read_b64_tr_b16 v[64:65], v14 offset:14464
  ds_read_b64_tr_b16 v[66:67], v14 offset:15360
  ds_read_b64_tr_b16 v[68:69], v14 offset:21632
  ds_read_b64_tr_b16 v[70:71], v14 offset:22528
  ds_read_b64_tr_b16 v[72:73], v14 offset:28800
  ds_read_b64_tr_b16 v[74:75], v14 offset:29696
  ds_read_b64_tr_b16 v[76:77], v14 offset:35968
  ds_read_b64_tr_b16 v[78:79], v14 offset:36864
  ds_read_b64_tr_b16 v[80:81], v14 offset:43136
  ds_read_b64_tr_b16 v[82:83], v14 offset:44032
  ds_read_b64_tr_b16 v[84:85], v14 offset:50304
  ds_read_b64_tr_b16 v[86:87], v14 offset:51200
  s_waitcnt lgkmcnt(0)
  s_barrier
  s_add_u32 m0, s27, 0
  s_nop 0
  buffer_load_dwordx4 v4, s[8:11], s25 offen lds
  s_add_u32 s25, s25, 65536
  s_add_u32 m0, m0, 4096
  s_nop 0
  buffer_load_dwordx4 v5, s[8:11], s25 offen lds
  s_add_u32 s25, s25, 65536
  s_add_u32 m0, m0, 4096
  s_nop 0
  buffer_load_dwordx4 v6, s[8:11], s25 offen lds
  s_add_u32 s25, s25, 65536
  s_add_u32 m0, m0, 4096
  s_nop 0
  buffer_load_dwordx4 v7, s[8:11], s25 offen lds
  s_add_u32 s25, s25, 65536
  s_add_u32 m0, m0, 4096
  s_waitcnt vmcnt(25)
  s_barrier
  ds_read_b128 v[120:123], v8 offset:0
  ds_read_b128 v[124:127], v8 offset:2048
  ds_read_b128 v[128:131], v9 offset:0
  ds_read_b128 v[132:135], v9 offset:2048
  ds_read_b128 v[136:139], v10 offset:0
  ds_read_b128 v[140:143], v10 offset:2048
  ds_read_b128 v[144:147], v11 offset:0
  ds_read_b128 v[148:151], v11 offset:2048
  ds_read_b128 v[152:155], v8 offset:256
  ds_read_b128 v[156:159], v8 offset:2304
  ds_read_b128 v[160:163], v9 offset:256
  ds_read_b128 v[164:167], v9 offset:2304
  ds_read_b128 v[168:171], v10 offset:256
  ds_read_b128 v[172:175], v10 offset:2304
  ds_read_b128 v[176:179], v11 offset:256
  ds_read_b128 v[180:183], v11 offset:2304
  s_waitcnt vmcnt(21)
  s_barrier
  v_add_u32 v8, 16384, v8
  v_add_u32 v9, 16384, v9
  v_add_u32 v10, 16384, v10
  v_add_u32 v11, 16384, v11
  s_waitcnt lgkmcnt(0)
  v_mfma_f32_16x16x32_bf16 v[88:91], v[120:123], v[24:27], 0
  v_mfma_f32_16x16x32_bf16 v[92:95], v[124:127], v[24:27], 0
  ds_read_b128 v[184:187], v8 offset:0
  v_mfma_f32_16x16x32_bf16 v[96:99], v[120:123], v[56:59], 0
  v_mfma_f32_16x16x32_bf16 v[100:103], v[124:127], v[56:59], 0
  ds_read_b128 v[188:191], v8 offset:2048
  v_mfma_f32_16x16x32_bf16 v[88:91], v[128:131], v[28:31], v[88:91]
  v_mfma_f32_16x16x32_bf16 v[92:95], v[132:135], v[28:31], v[92:95]
  ds_read_b128 v[192:195], v9 offset:0
  v_mfma_f32_16x16x32_bf16 v[96:99], v[128:131], v[60:63], v[96:99]
  v_mfma_f32_16x16x32_bf16 v[100:103], v[132:135], v[60:63], v[100:103]
  ds_read_b128 v[196:199], v9 offset:2048
  v_mfma_f32_16x16x32_bf16 v[88:91], v[136:139], v[32:35], v[88:91]
  v_mfma_f32_16x16x32_bf16 v[92:95], v[140:143], v[32:35], v[92:95]
  ds_read_b128 v[200:203], v10 offset:0
  v_mfma_f32_16x16x32_bf16 v[96:99], v[136:139], v[64:67], v[96:99]
  v_mfma_f32_16x16x32_bf16 v[100:103], v[140:143], v[64:67], v[100:103]
  ds_read_b128 v[204:207], v10 offset:2048
  v_mfma_f32_16x16x32_bf16 v[88:91], v[144:147], v[36:39], v[88:91]
  v_mfma_f32_16x16x32_bf16 v[92:95], v[148:151], v[36:39], v[92:95]
  ds_read_b128 v[208:211], v11 offset:0
  v_mfma_f32_16x16x32_bf16 v[96:99], v[144:147], v[68:71], v[96:99]
  v_mfma_f32_16x16x32_bf16 v[100:103], v[148:151], v[68:71], v[100:103]
  ds_read_b128 v[212:215], v11 offset:2048
  v_mfma_f32_16x16x32_bf16 v[88:91], v[152:155], v[40:43], v[88:91]
  v_mfma_f32_16x16x32_bf16 v[92:95], v[156:159], v[40:43], v[92:95]
  ds_read_b128 v[216:219], v8 offset:256
  v_mfma_f32_16x16x32_bf16 v[96:99], v[152:155], v[72:75], v[96:99]
  v_mfma_f32_16x16x32_bf16 v[100:103], v[156:159], v[72:75], v[100:103]
  ds_read_b128 v[220:223], v8 offset:2304
  v_mfma_f32_16x16x32_bf16 v[88:91], v[160:163], v[44:47], v[88:91]
  v_mfma_f32_16x16x32_bf16 v[92:95], v[164:167], v[44:47], v[92:95]
  ds_read_b128 v[224:227], v9 offset:256
  v_mfma_f32_16x16x32_bf16 v[96:99], v[160:163], v[76:79], v[96:99]
  v_mfma_f32_16x16x32_bf16 v[100:103], v[164:167], v[76:79], v[100:103]
  ds_read_b128 v[228:231], v9 offset:2304
  v_mfma_f32_16x16x32_bf16 v[88:91], v[168:171], v[48:51], v[88:91]
  v_mfma_f32_16x16x32_bf16 v[92:95], v[172:175], v[48:51], v[92:95]
  ds_read_b128 v[232:235], v10 offset:256
  v_mfma_f32_16x16x32_bf16 v[96:99], v[168:171], v[80:83], v[96:99]
  v_mfma_f32_16x16x32_bf16 v[100:103], v[172:175], v[80:83], v[100:103]
  ds_read_b128 v[236:239], v10 offset:2304
  v_mfma_f32_16x16x32_bf16 v[88:91], v[176:179], v[52:55], v[88:91]
  v_mfma_f32_16x16x32_bf16 v[92:95], v[180:183], v[52:55], v[92:95]
  ds_read_b128 v[240:243], v11 offset:256
  v_mfma_f32_16x16x32_bf16 v[96:99], v[176:179], v[84:87], v[96:99]
  v_mfma_f32_16x16x32_bf16 v[100:103], v[180:183], v[84:87], v[100:103]
  ds_read_b128 v[244:247], v11 offset:2304
  s_waitcnt vmcnt(17)
  s_barrier
  v_add_u32 v8, 16384, v8
  v_add_u32 v9, 16384, v9
  v_add_u32 v10, 16384, v10
  v_add_u32 v11, 16384, v11
  s_waitcnt lgkmcnt(0)
  v_mfma_f32_16x16x32_bf16 v[104:107], v[184:187], v[24:27], 0
  v_mfma_f32_16x16x32_bf16 v[108:111], v[188:191], v[24:27], 0
  ds_read_b128 v[120:123], v8 offset:0
  v_mfma_f32_16x16x32_bf16 v[112:115], v[184:187], v[56:59], 0
  v_cvt_pk_bf16_f32 v88, v88, v89
  v_mfma_f32_16x16x32_bf16 v[116:119], v[188:191], v[56:59], 0
  ds_read_b128 v[124:127], v8 offset:2048
  v_cvt_pk_bf16_f32 v89, v90, v91
  v_mfma_f32_16x16x32_bf16 v[104:107], v[192:195], v[28:31], v[104:107]
  v_cvt_pk_bf16_f32 v90, v92, v93
  v_mfma_f32_16x16x32_bf16 v[108:111], v[196:199], v[28:31], v[108:111]
  ds_read_b128 v[128:131], v9 offset:0
  v_cvt_pk_bf16_f32 v91, v94, v95
  v_mfma_f32_16x16x32_bf16 v[112:115], v[192:195], v[60:63], v[112:115]
  buffer_store_dwordx4 v[88:91], v12, s[4:7], s32 offen sc1
  v_mfma_f32_16x16x32_bf16 v[116:119], v[196:199], v[60:63], v[116:119]
  ds_read_b128 v[132:135], v9 offset:2048
  v_cvt_pk_bf16_f32 v96, v96, v97
  v_mfma_f32_16x16x32_bf16 v[104:107], v[200:203], v[32:35], v[104:107]
  v_cvt_pk_bf16_f32 v97, v98, v99
  v_mfma_f32_16x16x32_bf16 v[108:111], v[204:207], v[32:35], v[108:111]
  ds_read_b128 v[136:139], v10 offset:0
  v_cvt_pk_bf16_f32 v98, v100, v101
  v_mfma_f32_16x16x32_bf16 v[112:115], v[200:203], v[64:67], v[112:115]
  v_cvt_pk_bf16_f32 v99, v102, v103
  v_mfma_f32_16x16x32_bf16 v[116:119], v[204:207], v[64:67], v[116:119]
  ds_read_b128 v[140:143], v10 offset:2048
  buffer_store_dwordx4 v[96:99], v13, s[4:7], s32 offen sc1
  v_mfma_f32_16x16x32_bf16 v[104:107], v[208:211], v[36:39], v[104:107]
  s_add_u32 s32, s32, 1024
  v_mfma_f32_16x16x32_bf16 v[108:111], v[212:215], v[36:39], v[108:111]
  ds_read_b128 v[144:147], v11 offset:0
  v_mfma_f32_16x16x32_bf16 v[112:115], v[208:211], v[68:71], v[112:115]
  v_mfma_f32_16x16x32_bf16 v[116:119], v[212:215], v[68:71], v[116:119]
  ds_read_b128 v[148:151], v11 offset:2048
  v_mfma_f32_16x16x32_bf16 v[104:107], v[216:219], v[40:43], v[104:107]
  v_mfma_f32_16x16x32_bf16 v[108:111], v[220:223], v[40:43], v[108:111]
  ds_read_b128 v[152:155], v8 offset:256
  v_mfma_f32_16x16x32_bf16 v[112:115], v[216:219], v[72:75], v[112:115]
  v_mfma_f32_16x16x32_bf16 v[116:119], v[220:223], v[72:75], v[116:119]
  ds_read_b128 v[156:159], v8 offset:2304
  v_mfma_f32_16x16x32_bf16 v[104:107], v[224:227], v[44:47], v[104:107]
  v_mfma_f32_16x16x32_bf16 v[108:111], v[228:231], v[44:47], v[108:111]
  ds_read_b128 v[160:163], v9 offset:256
  v_mfma_f32_16x16x32_bf16 v[112:115], v[224:227], v[76:79], v[112:115]
  v_mfma_f32_16x16x32_bf16 v[116:119], v[228:231], v[76:79], v[116:119]
  ds_read_b128 v[164:167], v9 offset:2304
  v_mfma_f32_16x16x32_bf16 v[104:107], v[232:235], v[48:51], v[104:107]
  v_mfma_f32_16x16x32_bf16 v[108:111], v[236:239], v[48:51], v[108:111]
  ds_read_b128 v[168:171], v10 offset:256
  v_mfma_f32_16x16x32_bf16 v[112:115], v[232:235], v[80:83], v[112:115]
  v_mfma_f32_16x16x32_bf16 v[116:119], v[236:239], v[80:83], v[116:119]
  ds_read_b128 v[172:175], v10 offset:2304
  v_mfma_f32_16x16x32_bf16 v[104:107], v[240:243], v[52:55], v[104:107]
  v_mfma_f32_16x16x32_bf16 v[108:111], v[244:247], v[52:55], v[108:111]
  ds_read_b128 v[176:179], v11 offset:256
  v_mfma_f32_16x16x32_bf16 v[112:115], v[240:243], v[84:87], v[112:115]
  v_mfma_f32_16x16x32_bf16 v[116:119], v[244:247], v[84:87], v[116:119]
  ds_read_b128 v[180:183], v11 offset:2304
  s_waitcnt vmcnt(15)
  s_barrier
  v_add_u32 v8, 16384, v8
  v_add_u32 v9, 16384, v9
  v_add_u32 v10, 16384, v10
  v_add_u32 v11, 16384, v11
  s_waitcnt lgkmcnt(0)
  v_mfma_f32_16x16x32_bf16 v[88:91], v[120:123], v[24:27], 0
  v_mfma_f32_16x16x32_bf16 v[92:95], v[124:127], v[24:27], 0
  ds_read_b128 v[184:187], v8 offset:0
  v_mfma_f32_16x16x32_bf16 v[96:99], v[120:123], v[56:59], 0
  v_cvt_pk_bf16_f32 v104, v104, v105
  v_mfma_f32_16x16x32_bf16 v[100:103], v[124:127], v[56:59], 0
  ds_read_b128 v[188:191], v8 offset:2048
  v_cvt_pk_bf16_f32 v105, v106, v107
  v_mfma_f32_16x16x32_bf16 v[88:91], v[128:131], v[28:31], v[88:91]
  v_cvt_pk_bf16_f32 v106, v108, v109
  v_mfma_f32_16x16x32_bf16 v[92:95], v[132:135], v[28:31], v[92:95]
  ds_read_b128 v[192:195], v9 offset:0
  v_cvt_pk_bf16_f32 v107, v110, v111
  v_mfma_f32_16x16x32_bf16 v[96:99], v[128:131], v[60:63], v[96:99]
  buffer_store_dwordx4 v[104:107], v12, s[4:7], s32 offen sc1
  v_mfma_f32_16x16x32_bf16 v[100:103], v[132:135], v[60:63], v[100:103]
  ds_read_b128 v[196:199], v9 offset:2048
  v_cvt_pk_bf16_f32 v112, v112, v113
  v_mfma_f32_16x16x32_bf16 v[88:91], v[136:139], v[32:35], v[88:91]
  v_cvt_pk_bf16_f32 v113, v114, v115
  v_mfma_f32_16x16x32_bf16 v[92:95], v[140:143], v[32:35], v[92:95]
  ds_read_b128 v[200:203], v10 offset:0
  v_cvt_pk_bf16_f32 v114, v116, v117
  v_mfma_f32_16x16x32_bf16 v[96:99], v[136:139], v[64:67], v[96:99]
  v_cvt_pk_bf16_f32 v115, v118, v119
  v_mfma_f32_16x16x32_bf16 v[100:103], v[140:143], v[64:67], v[100:103]
  ds_read_b128 v[204:207], v10 offset:2048
  buffer_store_dwordx4 v[112:115], v13, s[4:7], s32 offen sc1
  v_mfma_f32_16x16x32_bf16 v[88:91], v[144:147], v[36:39], v[88:91]
  s_add_u32 s32, s32, 1024
  v_mfma_f32_16x16x32_bf16 v[92:95], v[148:151], v[36:39], v[92:95]
  ds_read_b128 v[208:211], v11 offset:0
  v_mfma_f32_16x16x32_bf16 v[96:99], v[144:147], v[68:71], v[96:99]
  v_mfma_f32_16x16x32_bf16 v[100:103], v[148:151], v[68:71], v[100:103]
  ds_read_b128 v[212:215], v11 offset:2048
  v_mfma_f32_16x16x32_bf16 v[88:91], v[152:155], v[40:43], v[88:91]
  v_mfma_f32_16x16x32_bf16 v[92:95], v[156:159], v[40:43], v[92:95]
  ds_read_b128 v[216:219], v8 offset:256
  v_mfma_f32_16x16x32_bf16 v[96:99], v[152:155], v[72:75], v[96:99]
  v_mfma_f32_16x16x32_bf16 v[100:103], v[156:159], v[72:75], v[100:103]
  ds_read_b128 v[220:223], v8 offset:2304
  v_mfma_f32_16x16x32_bf16 v[88:91], v[160:163], v[44:47], v[88:91]
  v_mfma_f32_16x16x32_bf16 v[92:95], v[164:167], v[44:47], v[92:95]
  ds_read_b128 v[224:227], v9 offset:256
  v_mfma_f32_16x16x32_bf16 v[96:99], v[160:163], v[76:79], v[96:99]
  v_mfma_f32_16x16x32_bf16 v[100:103], v[164:167], v[76:79], v[100:103]
  ds_read_b128 v[228:231], v9 offset:2304
  v_mfma_f32_16x16x32_bf16 v[88:91], v[168:171], v[48:51], v[88:91]
  v_mfma_f32_16x16x32_bf16 v[92:95], v[172:175], v[48:51], v[92:95]
  ds_read_b128 v[232:235], v10 offset:256
  v_mfma_f32_16x16x32_bf16 v[96:99], v[168:171], v[80:83], v[96:99]
  v_mfma_f32_16x16x32_bf16 v[100:103], v[172:175], v[80:83], v[100:103]
  ds_read_b128 v[236:239], v10 offset:2304
  v_mfma_f32_16x16x32_bf16 v[88:91], v[176:179], v[52:55], v[88:91]
  v_mfma_f32_16x16x32_bf16 v[92:95], v[180:183], v[52:55], v[92:95]
  ds_read_b128 v[240:243], v11 offset:256
  v_mfma_f32_16x16x32_bf16 v[96:99], v[176:179], v[84:87], v[96:99]
  v_mfma_f32_16x16x32_bf16 v[100:103], v[180:183], v[84:87], v[100:103]
  ds_read_b128 v[244:247], v11 offset:2304
  s_waitcnt vmcnt(13)
  s_barrier
  v_add_u32 v8, 16384, v8
  v_add_u32 v9, 16384, v9
  v_add_u32 v10, 16384, v10
  v_add_u32 v11, 16384, v11
  s_waitcnt lgkmcnt(0)
  v_mfma_f32_16x16x32_bf16 v[104:107], v[184:187], v[24:27], 0
  v_mfma_f32_16x16x32_bf16 v[108:111], v[188:191], v[24:27], 0
  ds_read_b128 v[120:123], v8 offset:0
  v_mfma_f32_16x16x32_bf16 v[112:115], v[184:187], v[56:59], 0
  v_cvt_pk_bf16_f32 v88, v88, v89
  v_mfma_f32_16x16x32_bf16 v[116:119], v[188:191], v[56:59], 0
  ds_read_b128 v[124:127], v8 offset:2048
  v_cvt_pk_bf16_f32 v89, v90, v91
  v_mfma_f32_16x16x32_bf16 v[104:107], v[192:195], v[28:31], v[104:107]
  v_cvt_pk_bf16_f32 v90, v92, v93
  v_mfma_f32_16x16x32_bf16 v[108:111], v[196:199], v[28:31], v[108:111]
  ds_read_b128 v[128:131], v9 offset:0
  v_cvt_pk_bf16_f32 v91, v94, v95
  v_mfma_f32_16x16x32_bf16 v[112:115], v[192:195], v[60:63], v[112:115]
  buffer_store_dwordx4 v[88:91], v12, s[4:7], s32 offen sc1
  v_mfma_f32_16x16x32_bf16 v[116:119], v[196:199], v[60:63], v[116:119]
  ds_read_b128 v[132:135], v9 offset:2048
  v_cvt_pk_bf16_f32 v96, v96, v97
  v_mfma_f32_16x16x32_bf16 v[104:107], v[200:203], v[32:35], v[104:107]
  v_cvt_pk_bf16_f32 v97, v98, v99
  v_mfma_f32_16x16x32_bf16 v[108:111], v[204:207], v[32:35], v[108:111]
  ds_read_b128 v[136:139], v10 offset:0
  v_cvt_pk_bf16_f32 v98, v100, v101
  v_mfma_f32_16x16x32_bf16 v[112:115], v[200:203], v[64:67], v[112:115]
  v_cvt_pk_bf16_f32 v99, v102, v103
  v_mfma_f32_16x16x32_bf16 v[116:119], v[204:207], v[64:67], v[116:119]
  ds_read_b128 v[140:143], v10 offset:2048
  buffer_store_dwordx4 v[96:99], v13, s[4:7], s32 offen sc1
  v_mfma_f32_16x16x32_bf16 v[104:107], v[208:211], v[36:39], v[104:107]
  s_add_u32 s32, s32, 1024
  v_mfma_f32_16x16x32_bf16 v[108:111], v[212:215], v[36:39], v[108:111]
  ds_read_b128 v[144:147], v11 offset:0
  v_mfma_f32_16x16x32_bf16 v[112:115], v[208:211], v[68:71], v[112:115]
  v_mfma_f32_16x16x32_bf16 v[116:119], v[212:215], v[68:71], v[116:119]
  ds_read_b128 v[148:151], v11 offset:2048
  v_mfma_f32_16x16x32_bf16 v[104:107], v[216:219], v[40:43], v[104:107]
  v_mfma_f32_16x16x32_bf16 v[108:111], v[220:223], v[40:43], v[108:111]
  ds_read_b128 v[152:155], v8 offset:256
  v_mfma_f32_16x16x32_bf16 v[112:115], v[216:219], v[72:75], v[112:115]
  v_mfma_f32_16x16x32_bf16 v[116:119], v[220:223], v[72:75], v[116:119]
  ds_read_b128 v[156:159], v8 offset:2304
  v_mfma_f32_16x16x32_bf16 v[104:107], v[224:227], v[44:47], v[104:107]
  v_mfma_f32_16x16x32_bf16 v[108:111], v[228:231], v[44:47], v[108:111]
  ds_read_b128 v[160:163], v9 offset:256
  v_mfma_f32_16x16x32_bf16 v[112:115], v[224:227], v[76:79], v[112:115]
  v_mfma_f32_16x16x32_bf16 v[116:119], v[228:231], v[76:79], v[116:119]
  ds_read_b128 v[164:167], v9 offset:2304
  v_mfma_f32_16x16x32_bf16 v[104:107], v[232:235], v[48:51], v[104:107]
  v_mfma_f32_16x16x32_bf16 v[108:111], v[236:239], v[48:51], v[108:111]
  ds_read_b128 v[168:171], v10 offset:256
  v_mfma_f32_16x16x32_bf16 v[112:115], v[232:235], v[80:83], v[112:115]
  v_mfma_f32_16x16x32_bf16 v[116:119], v[236:239], v[80:83], v[116:119]
  ds_read_b128 v[172:175], v10 offset:2304
  v_mfma_f32_16x16x32_bf16 v[104:107], v[240:243], v[52:55], v[104:107]
  v_mfma_f32_16x16x32_bf16 v[108:111], v[244:247], v[52:55], v[108:111]
  ds_read_b128 v[176:179], v11 offset:256
  v_mfma_f32_16x16x32_bf16 v[112:115], v[240:243], v[84:87], v[112:115]
  v_mfma_f32_16x16x32_bf16 v[116:119], v[244:247], v[84:87], v[116:119]
  ds_read_b128 v[180:183], v11 offset:2304
  s_waitcnt vmcnt(11)
  s_barrier
  v_add_u32 v8, 16384, v8
  v_add_u32 v9, 16384, v9
  v_add_u32 v10, 16384, v10
  v_add_u32 v11, 16384, v11
  s_waitcnt lgkmcnt(0)
  v_mfma_f32_16x16x32_bf16 v[88:91], v[120:123], v[24:27], 0
  v_mfma_f32_16x16x32_bf16 v[92:95], v[124:127], v[24:27], 0
  ds_read_b128 v[184:187], v8 offset:0
  v_mfma_f32_16x16x32_bf16 v[96:99], v[120:123], v[56:59], 0
  v_cvt_pk_bf16_f32 v104, v104, v105
  v_mfma_f32_16x16x32_bf16 v[100:103], v[124:127], v[56:59], 0
  ds_read_b128 v[188:191], v8 offset:2048
  v_cvt_pk_bf16_f32 v105, v106, v107
  v_mfma_f32_16x16x32_bf16 v[88:91], v[128:131], v[28:31], v[88:91]
  v_cvt_pk_bf16_f32 v106, v108, v109
  v_mfma_f32_16x16x32_bf16 v[92:95], v[132:135], v[28:31], v[92:95]
  ds_read_b128 v[192:195], v9 offset:0
  v_cvt_pk_bf16_f32 v107, v110, v111
  v_mfma_f32_16x16x32_bf16 v[96:99], v[128:131], v[60:63], v[96:99]
  buffer_store_dwordx4 v[104:107], v12, s[4:7], s32 offen sc1
  v_mfma_f32_16x16x32_bf16 v[100:103], v[132:135], v[60:63], v[100:103]
  ds_read_b128 v[196:199], v9 offset:2048
  v_cvt_pk_bf16_f32 v112, v112, v113
  v_mfma_f32_16x16x32_bf16 v[88:91], v[136:139], v[32:35], v[88:91]
  v_cvt_pk_bf16_f32 v113, v114, v115
  v_mfma_f32_16x16x32_bf16 v[92:95], v[140:143], v[32:35], v[92:95]
  ds_read_b128 v[200:203], v10 offset:0
  v_cvt_pk_bf16_f32 v114, v116, v117
  v_mfma_f32_16x16x32_bf16 v[96:99], v[136:139], v[64:67], v[96:99]
  v_cvt_pk_bf16_f32 v115, v118, v119
  v_mfma_f32_16x16x32_bf16 v[100:103], v[140:143], v[64:67], v[100:103]
  ds_read_b128 v[204:207], v10 offset:2048
  buffer_store_dwordx4 v[112:115], v13, s[4:7], s32 offen sc1
  v_mfma_f32_16x16x32_bf16 v[88:91], v[144:147], v[36:39], v[88:91]
  s_add_u32 s32, s32, 1024
  v_mfma_f32_16x16x32_bf16 v[92:95], v[148:151], v[36:39], v[92:95]
  ds_read_b128 v[208:211], v11 offset:0
  v_mfma_f32_16x16x32_bf16 v[96:99], v[144:147], v[68:71], v[96:99]
  v_mfma_f32_16x16x32_bf16 v[100:103], v[148:151], v[68:71], v[100:103]
  ds_read_b128 v[212:215], v11 offset:2048
  v_mfma_f32_16x16x32_bf16 v[88:91], v[152:155], v[40:43], v[88:91]
  v_mfma_f32_16x16x32_bf16 v[92:95], v[156:159], v[40:43], v[92:95]
  ds_read_b128 v[216:219], v8 offset:256
  v_mfma_f32_16x16x32_bf16 v[96:99], v[152:155], v[72:75], v[96:99]
  v_mfma_f32_16x16x32_bf16 v[100:103], v[156:159], v[72:75], v[100:103]
  ds_read_b128 v[220:223], v8 offset:2304
  v_mfma_f32_16x16x32_bf16 v[88:91], v[160:163], v[44:47], v[88:91]
  v_mfma_f32_16x16x32_bf16 v[92:95], v[164:167], v[44:47], v[92:95]
  ds_read_b128 v[224:227], v9 offset:256
  v_mfma_f32_16x16x32_bf16 v[96:99], v[160:163], v[76:79], v[96:99]
  v_mfma_f32_16x16x32_bf16 v[100:103], v[164:167], v[76:79], v[100:103]
  ds_read_b128 v[228:231], v9 offset:2304
  v_mfma_f32_16x16x32_bf16 v[88:91], v[168:171], v[48:51], v[88:91]
  v_mfma_f32_16x16x32_bf16 v[92:95], v[172:175], v[48:51], v[92:95]
  ds_read_b128 v[232:235], v10 offset:256
  v_mfma_f32_16x16x32_bf16 v[96:99], v[168:171], v[80:83], v[96:99]
  v_mfma_f32_16x16x32_bf16 v[100:103], v[172:175], v[80:83], v[100:103]
  ds_read_b128 v[236:239], v10 offset:2304
  v_mfma_f32_16x16x32_bf16 v[88:91], v[176:179], v[52:55], v[88:91]
  v_mfma_f32_16x16x32_bf16 v[92:95], v[180:183], v[52:55], v[92:95]
  ds_read_b128 v[240:243], v11 offset:256
  v_mfma_f32_16x16x32_bf16 v[96:99], v[176:179], v[84:87], v[96:99]
  v_mfma_f32_16x16x32_bf16 v[100:103], v[180:183], v[84:87], v[100:103]
  ds_read_b128 v[244:247], v11 offset:2304
  s_waitcnt vmcnt(8)
  s_barrier
  s_cmp_lg_u32 s20, 0
  s_cbranch_scc1 Lr1_17
  v_readfirstlane_b32 s75, v248
  s_nop 0
  s_cmp_lg_u32 s75, 31
  s_cbranch_scc1 Lr1_18
  s_cmp_lg_u32 s74, 3
  s_cbranch_scc1 Lr1_18
  s_mov_b64 exec, 1
  s_add_u32 s75, s74, 1
  v_mov_b32 v252, s75
  v_mov_b32 v253, 0
  buffer_atomic_cmpswap v[252:253], off, s[68:71], 0 offset:64
  s_mov_b64 exec, -1
Lr1_18:
  buffer_load_dword v250, off, s[68:71], 0 offset:128 sc1
Lr1_17:
  v_add_u32 v8, 4294828032, v8
  v_add_u32 v9, 4294828032, v9
  v_add_u32 v10, 4294828032, v10
  v_add_u32 v11, 4294828032, v11
  s_waitcnt lgkmcnt(0)
  v_mfma_f32_16x16x32_bf16 v[104:107], v[184:187], v[24:27], 0
  v_mfma_f32_16x16x32_bf16 v[108:111], v[188:191], v[24:27], 0
  ds_read_b128 v[120:123], v8 offset:0
  v_mfma_f32_16x16x32_bf16 v[112:115], v[184:187], v[56:59], 0
  v_cvt_pk_bf16_f32 v88, v88, v89
  v_mfma_f32_16x16x32_bf16 v[116:119], v[188:191], v[56:59], 0
  ds_read_b128 v[124:127], v8 offset:2048
  v_cvt_pk_bf16_f32 v89, v90, v91
  v_mfma_f32_16x16x32_bf16 v[104:107], v[192:195], v[28:31], v[104:107]
  v_cvt_pk_bf16_f32 v90, v92, v93
  v_mfma_f32_16x16x32_bf16 v[108:111], v[196:199], v[28:31], v[108:111]
  ds_read_b128 v[128:131], v9 offset:0
  v_cvt_pk_bf16_f32 v91, v94, v95
  v_mfma_f32_16x16x32_bf16 v[112:115], v[192:195], v[60:63], v[112:115]
  buffer_store_dwordx4 v[88:91], v12, s[4:7], s32 offen sc1
  v_mfma_f32_16x16x32_bf16 v[116:119], v[196:199], v[60:63], v[116:119]
  ds_read_b128 v[132:135], v9 offset:2048
  v_cvt_pk_bf16_f32 v96, v96, v97
  v_mfma_f32_16x16x32_bf16 v[104:107], v[200:203], v[32:35], v[104:107]
  v_cvt_pk_bf16_f32 v97, v98, v99
  v_mfma_f32_16x16x32_bf16 v[108:111], v[204:207], v[32:35], v[108:111]
  ds_read_b128 v[136:139], v10 offset:0
  v_cvt_pk_bf16_f32 v98, v100, v101
  v_mfma_f32_16x16x32_bf16 v[112:115], v[200:203], v[64:67], v[112:115]
  v_cvt_pk_bf16_f32 v99, v102, v103
  v_mfma_f32_16x16x32_bf16 v[116:119], v[204:207], v[64:67], v[116:119]
  ds_read_b128 v[140:143], v10 offset:2048
  buffer_store_dwordx4 v[96:99], v13, s[4:7], s32 offen sc1
  v_mfma_f32_16x16x32_bf16 v[104:107], v[208:211], v[36:39], v[104:107]
  s_add_u32 s32, s32, 1024
  v_mfma_f32_16x16x32_bf16 v[108:111], v[212:215], v[36:39], v[108:111]
  ds_read_b128 v[144:147], v11 offset:0
  v_mfma_f32_16x16x32_bf16 v[112:115], v[208:211], v[68:71], v[112:115]
  v_mfma_f32_16x16x32_bf16 v[116:119], v[212:215], v[68:71], v[116:119]
  ds_read_b128 v[148:151], v11 offset:2048
  v_mfma_f32_16x16x32_bf16 v[104:107], v[216:219], v[40:43], v[104:107]
  v_mfma_f32_16x16x32_bf16 v[108:111], v[220:223], v[40:43], v[108:111]
  ds_read_b128 v[152:155], v8 offset:256
  v_mfma_f32_16x16x32_bf16 v[112:115], v[216:219], v[72:75], v[112:115]
  v_mfma_f32_16x16x32_bf16 v[116:119], v[220:223], v[72:75], v[116:119]
  ds_read_b128 v[156:159], v8 offset:2304
  v_mfma_f32_16x16x32_bf16 v[104:107], v[224:227], v[44:47], v[104:107]
  v_mfma_f32_16x16x32_bf16 v[108:111], v[228:231], v[44:47], v[108:111]
  ds_read_b128 v[160:163], v9 offset:256
  v_mfma_f32_16x16x32_bf16 v[112:115], v[224:227], v[76:79], v[112:115]
  v_mfma_f32_16x16x32_bf16 v[116:119], v[228:231], v[76:79], v[116:119]
  ds_read_b128 v[164:167], v9 offset:2304
  v_mfma_f32_16x16x32_bf16 v[104:107], v[232:235], v[48:51], v[104:107]
  v_mfma_f32_16x16x32_bf16 v[108:111], v[236:239], v[48:51], v[108:111]
  ds_read_b128 v[168:171], v10 offset:256
  v_mfma_f32_16x16x32_bf16 v[112:115], v[232:235], v[80:83], v[112:115]
  v_mfma_f32_16x16x32_bf16 v[116:119], v[236:239], v[80:83], v[116:119]
  ds_read_b128 v[172:175], v10 offset:2304
  v_mfma_f32_16x16x32_bf16 v[104:107], v[240:243], v[52:55], v[104:107]
  v_mfma_f32_16x16x32_bf16 v[108:111], v[244:247], v[52:55], v[108:111]
  ds_read_b128 v[176:179], v11 offset:256
  v_mfma_f32_16x16x32_bf16 v[112:115], v[240:243], v[84:87], v[112:115]
  v_mfma_f32_16x16x32_bf16 v[116:119], v[244:247], v[84:87], v[116:119]
  ds_read_b128 v[180:183], v11 offset:2304
  s_waitcnt lgkmcnt(0)
  v_mfma_f32_16x16x32_bf16 v[88:91], v[120:123], v[24:27], 0
  v_mfma_f32_16x16x32_bf16 v[92:95], v[124:127], v[24:27], 0
  v_mfma_f32_16x16x32_bf16 v[96:99], v[120:123], v[56:59], 0
  v_cvt_pk_bf16_f32 v104, v104, v105
  v_mfma_f32_16x16x32_bf16 v[100:103], v[124:127], v[56:59], 0
  v_cvt_pk_bf16_f32 v105, v106, v107
  v_mfma_f32_16x16x32_bf16 v[88:91], v[128:131], v[28:31], v[88:91]
  v_cvt_pk_bf16_f32 v106, v108, v109
  v_mfma_f32_16x16x32_bf16 v[92:95], v[132:135], v[28:31], v[92:95]
  v_cvt_pk_bf16_f32 v107, v110, v111
  v_mfma_f32_16x16x32_bf16 v[96:99], v[128:131], v[60:63], v[96:99]
  buffer_store_dwordx4 v[104:107], v12, s[4:7], s32 offen sc1
  v_mfma_f32_16x16x32_bf16 v[100:103], v[132:135], v[60:63], v[100:103]
  v_cvt_pk_bf16_f32 v112, v112, v113
  v_mfma_f32_16x16x32_bf16 v[88:91], v[136:139], v[32:35], v[88:91]
  v_cvt_pk_bf16_f32 v113, v114, v115
  v_mfma_f32_16x16x32_bf16 v[92:95], v[140:143], v[32:35], v[92:95]
  v_cvt_pk_bf16_f32 v114, v116, v117
  v_mfma_f32_16x16x32_bf16 v[96:99], v[136:139], v[64:67], v[96:99]
  v_cvt_pk_bf16_f32 v115, v118, v119
  v_mfma_f32_16x16x32_bf16 v[100:103], v[140:143], v[64:67], v[100:103]
  buffer_store_dwordx4 v[112:115], v13, s[4:7], s32 offen sc1
  v_mfma_f32_16x16x32_bf16 v[88:91], v[144:147], v[36:39], v[88:91]
  s_add_u32 s32, s32, 1024
  v_mfma_f32_16x16x32_bf16 v[92:95], v[148:151], v[36:39], v[92:95]
  v_mfma_f32_16x16x32_bf16 v[96:99], v[144:147], v[68:71], v[96:99]
  v_mfma_f32_16x16x32_bf16 v[100:103], v[148:151], v[68:71], v[100:103]
  v_mfma_f32_16x16x32_bf16 v[88:91], v[152:155], v[40:43], v[88:91]
  v_mfma_f32_16x16x32_bf16 v[92:95], v[156:159], v[40:43], v[92:95]
  v_mfma_f32_16x16x32_bf16 v[96:99], v[152:155], v[72:75], v[96:99]
  v_mfma_f32_16x16x32_bf16 v[100:103], v[156:159], v[72:75], v[100:103]
  v_mfma_f32_16x16x32_bf16 v[88:91], v[160:163], v[44:47], v[88:91]
  v_mfma_f32_16x16x32_bf16 v[92:95], v[164:167], v[44:47], v[92:95]
  v_mfma_f32_16x16x32_bf16 v[96:99], v[160:163], v[76:79], v[96:99]
  v_mfma_f32_16x16x32_bf16 v[100:103], v[164:167], v[76:79], v[100:103]
  v_mfma_f32_16x16x32_bf16 v[88:91], v[168:171], v[48:51], v[88:91]
  v_mfma_f32_16x16x32_bf16 v[92:95], v[172:175], v[48:51], v[92:95]
  v_mfma_f32_16x16x32_bf16 v[96:99], v[168:171], v[80:83], v[96:99]
  v_mfma_f32_16x16x32_bf16 v[100:103], v[172:175], v[80:83], v[100:103]
  v_mfma_f32_16x16x32_bf16 v[88:91], v[176:179], v[52:55], v[88:91]
  v_mfma_f32_16x16x32_bf16 v[92:95], v[180:183], v[52:55], v[92:95]
  v_mfma_f32_16x16x32_bf16 v[96:99], v[176:179], v[84:87], v[96:99]
  v_mfma_f32_16x16x32_bf16 v[100:103], v[180:183], v[84:87], v[100:103]
  s_nop 4
  v_cvt_pk_bf16_f32 v88, v88, v89
  v_cvt_pk_bf16_f32 v89, v90, v91
  v_cvt_pk_bf16_f32 v90, v92, v93
  v_cvt_pk_bf16_f32 v91, v94, v95
  buffer_store_dwordx4 v[88:91], v12, s[4:7], s32 offen sc1
  v_cvt_pk_bf16_f32 v96, v96, v97
  v_cvt_pk_bf16_f32 v97, v98, v99
  v_cvt_pk_bf16_f32 v98, v100, v101
  v_cvt_pk_bf16_f32 v99, v102, v103
  buffer_store_dwordx4 v[96:99], v13, s[4:7], s32 offen sc1
  s_add_u32 s32, s32, 1024
Lk0_done:
  s_load_dwordx2 s[42:43], s[0:1], 0
  s_load_dwordx2 s[44:45], s[0:1], 88
  s_waitcnt vmcnt(0)
  s_barrier
  v_mov_b32 v4, 159728
  s_mov_b32 s21, s74
  s_cmp_lg_u32 s20, 0
  s_cbranch_scc1 Lrole_19
  s_mov_b32 s30, 1048576
Ltag_20:
  v_readfirstlane_b32 s72, v250
  s_nop 0
  s_cmp_lg_u32 s72, 0
  s_cbranch_scc1 Ltag_21
  buffer_load_dword v250, off, s[68:71], 0 offset:128 sc1
  s_waitcnt vmcnt(0)
  s_sub_u32 s30, s30, 1
  s_cbranch_scc0 Ltag_20
Ltag_21:
  s_and_b32 s75, s2, 7
  s_lshl_b32 s75, s75, 2
  s_lshr_b32 s76, s2, 6
  s_add_u32 s75, s75, s76
  s_lshl_b32 s75, s75, 3
  s_bfe_u32 s76, s2, 0x30003
  s_add_u32 s75, s75, s76
  s_lshl_b32 s75, s75, 2
  s_add_u32 s75, s75, 88659968
  s_mov_b64 exec, 1
  buffer_store_dword v250, off, s[4:7], s75 sc1
  ds_write_b96 v4, v[248:250]
  s_mov_b64 exec, -1
  s_waitcnt lgkmcnt(0)
Lrole_19:
  s_barrier
  ds_read_b96 v[2:4], v4
  s_waitcnt lgkmcnt(0)
  v_readfirstlane_b32 s72, v4
  s_mov_b32 s8, s42
  s_mov_b32 s9, s43
  s_mov_b32 s10, 0x1c0000
  s_mov_b32 s11, 0x20000
  s_mov_b32 s12, s44
  s_mov_b32 s13, s45
  s_mov_b32 s14, 0x1c0000
  s_mov_b32 s15, 0x20000
  v_readfirstlane_b32 s78, v2
  s_mov_b32 s23, 3
  s_mov_b32 s79, 4
Ldispatch:
  s_mov_b32 s22, s78
  s_cmp_lg_u32 s23, s21
  s_cbranch_scc1 Lworker
  s_cmp_ge_u32 s22, 32
  s_cbranch_scc1 Lworker
  s_cmp_ge_u32 s22, 16
  s_cbranch_scc1 Locu
  v_and_b32 v1, 15, v0
  v_lshrrev_b32 v2, 4, v0
  v_lshlrev_b32 v115, 4, v0
  v_and_b32 v3, 2, v0
  v_cmp_eq_u32 vcc, 0, v3
  v_mov_b32 v112, 0xdddd
  v_mov_b32 v3, 0x8888
  v_cndmask_b32 v112, v112, v3, vcc
  v_lshlrev_b32 v113, 3, v1
  v_lshl_add_u32 v113, v2, 8, v113
  s_mov_b32 s46, 28672
  s_and_b32 s26, s22, 15
  s_lshl_b32 s27, s26, 4
  s_lshl_b32 s28, s20, 1
  s_add_u32 s27, s27, s28
  s_lshr_b32 s26, s26, 2
  s_lshl_b32 s26, s26, 1
  s_lshl_b32 s28, s20, 6
  s_add_u32 s26, s26, s28
  s_add_u32 s26, s26, 8
  s_cmp_lt_u32 s22, 16
  s_cselect_b32 s26, s27, s26
  s_cselect_b32 s27, 0, 16
  v_bfe_u32 v4, v0, 1, 2
  v_mul_lo_u32 v4, v4, s27
  v_and_b32 v5, 0, v0
  v_add3_u32 v4, v4, v5, s26
  v_lshlrev_b32 v4, 2, v4
  s_mov_b32 s30, 1048576
  s_mov_b32 s29, 88659968
Lgo_22:
  buffer_load_dword v5, v4, s[4:7], s29 offen sc1
  s_waitcnt vmcnt(0)
  v_cmp_ne_u32 vcc, s72, v5
  s_cbranch_vccz Lgod_23
  s_sleep 4
  s_sub_u32 s30, s30, 1
  s_cbranch_scc0 Lgo_22
  s_branch Lk1_exit
Lgod_23:
  s_mul_i32 s26, s22, 401408
  s_mul_i32 s27, s20, 100352
  s_add_u32 s26, s26, s27
  s_add_u32 s28, s26, 0
  s_add_u32 s27, s28, 0
  buffer_load_dwordx4 v[120:123], v115, s[4:7], s27 offen offset:0 sc1
  buffer_load_dwordx4 v[124:127], v115, s[4:7], s27 offen offset:1024 sc1
  buffer_load_dwordx4 v[128:131], v115, s[4:7], s27 offen offset:2048 sc1
  buffer_load_dwordx4 v[132:135], v115, s[4:7], s27 offen offset:3072 sc1
  s_add_u32 s27, s27, 4096
  buffer_load_dwordx4 v[136:139], v115, s[4:7], s27 offen offset:0 sc1
  buffer_load_dwordx4 v[140:143], v115, s[4:7], s27 offen offset:1024 sc1
  buffer_load_dwordx4 v[144:147], v115, s[4:7], s27 offen offset:2048 sc1
  s_add_u32 s27, s27, 10240
  buffer_load_dwordx4 v[176:179], v115, s[4:7], s27 offen offset:0 sc1
  buffer_load_dwordx4 v[180:183], v115, s[4:7], s27 offen offset:1024 sc1
  buffer_load_dwordx4 v[184:187], v115, s[4:7], s27 offen offset:2048 sc1
  buffer_load_dwordx4 v[188:191], v115, s[4:7], s27 offen offset:3072 sc1
  s_add_u32 s27, s27, 4096
  buffer_load_dwordx4 v[192:195], v115, s[4:7], s27 offen offset:0 sc1
  buffer_load_dwordx4 v[196:199], v115, s[4:7], s27 offen offset:1024 sc1
  buffer_load_dwordx4 v[200:203], v115, s[4:7], s27 offen offset:2048 sc1
  s_add_u32 s27, s27, 10240
  buffer_load_dwordx4 v[232:235], v115, s[4:7], s27 offen offset:0 sc1
  buffer_load_dwordx4 v[236:239], v115, s[4:7], s27 offen offset:1024 sc1
  buffer_load_dwordx4 v[240:243], v115, s[4:7], s27 offen offset:2048 sc1
  buffer_load_dwordx4 v[244:247], v115, s[4:7], s27 offen offset:3072 sc1
  s_add_u32 s27, s27, 4096
  buffer_load_dwordx4 v[248:251], v115, s[4:7], s27 offen offset:0 sc1
  buffer_load_dwordx4 v[252:255], v115, s[4:7], s27 offen offset:1024 sc1
  buffer_load_dwordx4 a[0:3], v115, s[4:7], s27 offen offset:2048 sc1
  s_add_u32 s27, s27, 10240
  buffer_load_dwordx4 a[32:35], v115, s[4:7], s27 offen offset:0 sc1
  buffer_load_dwordx4 a[36:39], v115, s[4:7], s27 offen offset:1024 sc1
  buffer_load_dwordx4 a[40:43], v115, s[4:7], s27 offen offset:2048 sc1
  buffer_load_dwordx4 a[44:47], v115, s[4:7], s27 offen offset:3072 sc1
  s_add_u32 s27, s27, 4096
  buffer_load_dwordx4 a[48:51], v115, s[4:7], s27 offen offset:0 sc1
  buffer_load_dwordx4 a[52:55], v115, s[4:7], s27 offen offset:1024 sc1
  buffer_load_dwordx4 a[56:59], v115, s[4:7], s27 offen offset:2048 sc1
  s_add_u32 s27, s27, 10240
  buffer_load_dwordx4 a[88:91], v115, s[4:7], s27 offen offset:0 sc1
  buffer_load_dwordx4 a[92:95], v115, s[4:7], s27 offen offset:1024 sc1
  buffer_load_dwordx4 a[96:99], v115, s[4:7], s27 offen offset:2048 sc1
  buffer_load_dwordx4 a[100:103], v115, s[4:7], s27 offen offset:3072 sc1
  s_add_u32 s27, s27, 4096
  buffer_load_dwordx4 a[104:107], v115, s[4:7], s27 offen offset:0 sc1
  buffer_load_dwordx4 a[108:111], v115, s[4:7], s27 offen offset:1024 sc1
  buffer_load_dwordx4 a[112:115], v115, s[4:7], s27 offen offset:2048 sc1
  s_add_u32 s27, s27, 10240
  buffer_load_dwordx4 a[144:147], v115, s[4:7], s27 offen offset:0 sc1
  buffer_load_dwordx4 a[148:151], v115, s[4:7], s27 offen offset:1024 sc1
  buffer_load_dwordx4 a[152:155], v115, s[4:7], s27 offen offset:2048 sc1
  buffer_load_dwordx4 a[156:159], v115, s[4:7], s27 offen offset:3072 sc1
  s_add_u32 s27, s27, 4096
  buffer_load_dwordx4 a[160:163], v115, s[4:7], s27 offen offset:0 sc1
  buffer_load_dwordx4 a[164:167], v115, s[4:7], s27 offen offset:1024 sc1
  buffer_load_dwordx4 a[168:171], v115, s[4:7], s27 offen offset:2048 sc1
  s_add_u32 s27, s27, 10240
  buffer_load_dwordx4 a[200:203], v115, s[4:7], s27 offen offset:0 sc1
  buffer_load_dwordx4 a[204:207], v115, s[4:7], s27 offen offset:1024 sc1
  buffer_load_dwordx4 a[208:211], v115, s[4:7], s27 offen offset:2048 sc1
  buffer_load_dwordx4 a[212:215], v115, s[4:7], s27 offen offset:3072 sc1
  s_add_u32 s27, s27, 4096
  buffer_load_dwordx4 a[216:219], v115, s[4:7], s27 offen offset:0 sc1
  buffer_load_dwordx4 a[220:223], v115, s[4:7], s27 offen offset:1024 sc1
  buffer_load_dwordx4 a[224:227], v115, s[4:7], s27 offen offset:2048 sc1
  s_mov_b32 s30, 1048576
  s_mov_b32 s29, 88659968
Lgo_24:
  buffer_load_dwordx4 v[8:11], v115, s[4:7], s29 offen sc1
  buffer_load_dword v12, off, s[68:71], 0 offset:64 sc1
  s_waitcnt vmcnt(0)
  v_xor_b32 v8, s72, v8
  v_xor_b32 v9, s72, v9
  v_xor_b32 v10, s72, v10
  v_xor_b32 v11, s72, v11
  v_or3_b32 v8, v8, v9, v10
  v_or_b32 v8, v8, v11
  v_cmp_ne_u32 vcc, 0, v8
  s_cbranch_vccz Lgod_25
  s_sleep 4
  s_sub_u32 s30, s30, 1
  s_cbranch_scc0 Lgo_24
  s_branch Lk1_exit
Lgod_25:
  v_readfirstlane_b32 s27, v12
  s_nop 0
  s_cmp_lg_u32 s27, s79
  s_cbranch_scc1 Lfallback
  s_add_u32 s27, s28, 7168
  buffer_load_dwordx4 v[148:151], v115, s[4:7], s27 offen offset:0 sc1
  buffer_load_dwordx4 v[152:155], v115, s[4:7], s27 offen offset:1024 sc1
  buffer_load_dwordx4 v[156:159], v115, s[4:7], s27 offen offset:2048 sc1
  buffer_load_dwordx4 v[160:163], v115, s[4:7], s27 offen offset:3072 sc1
  s_add_u32 s27, s27, 4096
  buffer_load_dwordx4 v[164:167], v115, s[4:7], s27 offen offset:0 sc1
  buffer_load_dwordx4 v[168:171], v115, s[4:7], s27 offen offset:1024 sc1
  buffer_load_dwordx4 v[172:175], v115, s[4:7], s27 offen offset:2048 sc1
  s_add_u32 s27, s27, 10240
  buffer_load_dwordx4 v[204:207], v115, s[4:7], s27 offen offset:0 sc1
  buffer_load_dwordx4 v[208:211], v115, s[4:7], s27 offen offset:1024 sc1
  buffer_load_dwordx4 v[212:215], v115, s[4:7], s27 offen offset:2048 sc1
  buffer_load_dwordx4 v[216:219], v115, s[4:7], s27 offen offset:3072 sc1
  s_add_u32 s27, s27, 4096
  buffer_load_dwordx4 v[220:223], v115, s[4:7], s27 offen offset:0 sc1
  buffer_load_dwordx4 v[224:227], v115, s[4:7], s27 offen offset:1024 sc1
  buffer_load_dwordx4 v[228:231], v115, s[4:7], s27 offen offset:2048 sc1
  s_add_u32 s27, s27, 10240
  buffer_load_dwordx4 a[4:7], v115, s[4:7], s27 offen offset:0 sc1
  buffer_load_dwordx4 a[8:11], v115, s[4:7], s27 offen offset:1024 sc1
  buffer_load_dwordx4 a[12:15], v115, s[4:7], s27 offen offset:2048 sc1
  buffer_load_dwordx4 a[16:19], v115, s[4:7], s27 offen offset:3072 sc1
  s_add_u32 s27, s27, 4096
  buffer_load_dwordx4 a[20:23], v115, s[4:7], s27 offen offset:0 sc1
  buffer_load_dwordx4 a[24:27], v115, s[4:7], s27 offen offset:1024 sc1
  buffer_load_dwordx4 a[28:31], v115, s[4:7], s27 offen offset:2048 sc1
  s_add_u32 s27, s27, 10240
  buffer_load_dwordx4 a[60:63], v115, s[4:7], s27 offen offset:0 sc1
  buffer_load_dwordx4 a[64:67], v115, s[4:7], s27 offen offset:1024 sc1
  buffer_load_dwordx4 a[68:71], v115, s[4:7], s27 offen offset:2048 sc1
  buffer_load_dwordx4 a[72:75], v115, s[4:7], s27 offen offset:3072 sc1
  s_add_u32 s27, s27, 4096
  buffer_load_dwordx4 a[76:79], v115, s[4:7], s27 offen offset:0 sc1
  buffer_load_dwordx4 a[80:83], v115, s[4:7], s27 offen offset:1024 sc1
  buffer_load_dwordx4 a[84:87], v115, s[4:7], s27 offen offset:2048 sc1
  s_add_u32 s27, s27, 10240
  buffer_load_dwordx4 a[116:119], v115, s[4:7], s27 offen offset:0 sc1
  buffer_load_dwordx4 a[120:123], v115, s[4:7], s27 offen offset:1024 sc1
  buffer_load_dwordx4 a[124:127], v115, s[4:7], s27 offen offset:2048 sc1
  buffer_load_dwordx4 a[128:131], v115, s[4:7], s27 offen offset:3072 sc1
  s_add_u32 s27, s27, 4096
  buffer_load_dwordx4 a[132:135], v115, s[4:7], s27 offen offset:0 sc1
  buffer_load_dwordx4 a[136:139], v115, s[4:7], s27 offen offset:1024 sc1
  buffer_load_dwordx4 a[140:143], v115, s[4:7], s27 offen offset:2048 sc1
  s_add_u32 s27, s27, 10240
  buffer_load_dwordx4 a[172:175], v115, s[4:7], s27 offen offset:0 sc1
  buffer_load_dwordx4 a[176:179], v115, s[4:7], s27 offen offset:1024 sc1
  buffer_load_dwordx4 a[180:183], v115, s[4:7], s27 offen offset:2048 sc1
  buffer_load_dwordx4 a[184:187], v115, s[4:7], s27 offen offset:3072 sc1
  s_add_u32 s27, s27, 4096
  buffer_load_dwordx4 a[188:191], v115, s[4:7], s27 offen offset:0 sc1
  buffer_load_dwordx4 a[192:195], v115, s[4:7], s27 offen offset:1024 sc1
  buffer_load_dwordx4 a[196:199], v115, s[4:7], s27 offen offset:2048 sc1
  s_add_u32 s27, s27, 10240
  buffer_load_dwordx4 a[228:231], v115, s[4:7], s27 offen offset:0 sc1
  buffer_load_dwordx4 a[232:235], v115, s[4:7], s27 offen offset:1024 sc1
  buffer_load_dwordx4 a[236:239], v115, s[4:7], s27 offen offset:2048 sc1
  buffer_load_dwordx4 a[240:243], v115, s[4:7], s27 offen offset:3072 sc1
  s_add_u32 s27, s27, 4096
  buffer_load_dwordx4 a[244:247], v115, s[4:7], s27 offen offset:0 sc1
  buffer_load_dwordx4 a[248:251], v115, s[4:7], s27 offen offset:1024 sc1
  buffer_load_dwordx4 a[252:255], v115, s[4:7], s27 offen offset:2048 sc1
  v_mov_b32 v60, 0
  v_mov_b32 v61, 0
  v_mov_b32 v62, 0
  v_mov_b32 v63, 0
  s_lshl_b32 s26, s20, 10
  v_add_u32 v3, s26, v115
  ds_write_b128 v3, v[60:63] offset:0
  ds_write_b128 v3, v[60:63] offset:4096
  ds_write_b128 v3, v[60:63] offset:8192
  ds_write_b128 v3, v[60:63] offset:12288
  ds_write_b128 v3, v[60:63] offset:16384
  ds_write_b128 v3, v[60:63] offset:20480
  ds_write_b128 v3, v[60:63] offset:24576
  ds_write_b128 v3, v[60:63] offset:28672
  ds_write_b128 v3, v[60:63] offset:32768
  ds_write_b128 v3, v[60:63] offset:36864
  ds_write_b128 v3, v[60:63] offset:40960
  ds_write_b128 v3, v[60:63] offset:45056
  ds_write_b128 v3, v[60:63] offset:49152
  ds_write_b128 v3, v[60:63] offset:53248
  v_lshlrev_b32 v4, 7, v0
  v_mov_b32 v5, 0x40000000
  v_cmp_gt_u32 vcc, 56, v0
  s_nop 1
  v_cndmask_b32 v96, v5, v4, vcc
  s_mul_i32 s42, s22, 1835008
  s_mul_i32 s26, s20, 7168
  s_add_u32 s42, s42, s26
  s_add_u32 s42, s42, 42233856
  s_lshl_b32 s44, s22, 8
  s_add_u32 s44, s44, 72538112
  s_mov_b32 s43, 0
  s_mul_i32 s45, s22, 1792
  s_add_u32 s45, s45, 28672
  v_lshrrev_b32 v4, 1, v1
  v_lshlrev_b32 v4, 5, v4
  v_lshl_add_u32 v4, v2, 3, v4
  v_and_b32 v5, 1, v1
  v_lshl_add_u32 v114, v5, 2, v4
  v_bfe_u32 v4, v1, 2, 1
  v_lshlrev_b32 v4, 3, v4
  v_lshrrev_b32 v6, 3, v1
  v_lshl_add_u32 v4, v6, 1, v4
  v_add_u32 v4, v4, v5
  v_bfe_u32 v5, v1, 1, 1
  v_lshl_add_u32 v4, v5, 2, v4
  v_mul_u32_u24 v4, 928, v4
  v_lshl_add_u32 v116, v2, 4, v4
  s_mul_i32 s26, s20, 224
  s_add_u32 s26, s26, 192
  v_add_u32 v4, s26, v116
  v_mov_b32 v5, 896
  v_cmp_gt_u32 vcc, 2, v2
  s_nop 1
  v_cndmask_b32 v117, v5, v4, vcc
  s_mul_i32 s26, s20, 1792
  s_add_u32 s26, s26, 1024
  v_add_u32 v4, s26, v113
  v_mov_b32 v5, 7168
  v_cmp_gt_u32 vcc, 3, v2
  s_nop 1
  v_cndmask_b32 v119, v5, v4, vcc
  s_lshl_b32 s26, s20, 2
  v_add_u32 v6, s26, v2
  v_lshrrev_b32 v7, 1, v6
  v_lshlrev_b32 v7, 6, v7
  v_and_b32 v4, 1, v6
  v_lshl_add_u32 v7, v4, 4, v7
  s_lshl_b32 s26, s22, 9
  s_add_u32 s26, s26, 8192
  v_lshrrev_b32 v4, 3, v1
  v_lshl_add_u32 v4, v4, 8, v7
  v_bfe_u32 v5, v1, 2, 1
  v_lshl_add_u32 v4, v5, 5, v4
  v_and_b32 v5, 3, v1
  v_lshl_add_u32 v4, v5, 2, v4
  v_add_u32 v98, s26, v4
  s_lshr_b32 s26, s22, 1
  s_lshl_b32 s26, s26, 8
  s_and_b32 s27, s22, 1
  s_lshl_b32 s27, s27, 3
  s_add_u32 s26, s26, s27
  s_add_u32 s26, s26, 16384
  v_bfe_u32 v4, v1, 1, 1
  v_lshl_add_u32 v4, v4, 5, v7
  v_lshrrev_b32 v5, 2, v1
  v_lshl_add_u32 v4, v5, 2, v4
  v_add_u32 v4, s26, v4
  v_mov_b32 v5, 0x40000000
  v_and_b32 v8, 9, v1
  v_cmp_eq_u32 vcc, 0, v8
  s_nop 1
  v_cndmask_b32 v99, v5, v4, vcc
  v_bfe_u32 v9, v1, 1, 2
  v_and_b32 v8, 1, v1
  v_lshl_add_u32 v9, v9, 2, v8
  s_mul_i32 s26, s20, 1792
  s_add_u32 s26, s26, 15360
  v_mul_u32_u24 v4, 448, v2
  v_lshl_add_u32 v4, v1, 2, v4
  v_add_u32 v0, s26, v4
  v_lshrrev_b32 v4, 1, v6
  v_mul_u32_u24 v4, 448, v4
  v_and_b32 v5, 1, v6
  v_lshl_add_u32 v7, v5, 6, v4
  v_lshl_add_u32 v4, v5, 7, v4
  v_lshl_add_u32 v2, v9, 2, v7
  v_lshl_add_u32 v1, v1, 3, v4
  s_mul_i32 s41, s20, 7424
  s_add_u32 s41, s41, 24576
  s_mul_i32 s40, s20, 7168
  s_mov_b32 s32, -1
  s_mov_b32 s33, 0xffffff
  s_mov_b32 s34, 0x42800000
  s_waitcnt lgkmcnt(0)
  s_barrier
  s_mov_b64 exec, s[32:33]
  s_add_u32 m0, s41, 0
  s_nop 0
  buffer_load_dwordx4 v115, s[8:11], s40 offen offset:0 lds
  s_add_u32 m0, s41, 32
  s_nop 0
  buffer_load_dwordx4 v115, s[8:11], s40 offen offset:896 lds
  s_add_u32 m0, s41, 64
  s_nop 0
  buffer_load_dwordx4 v115, s[8:11], s40 offen offset:1792 lds
  s_add_u32 m0, s41, 96
  s_nop 0
  buffer_load_dwordx4 v115, s[8:11], s40 offen offset:2688 lds
  s_add_u32 s40, s40, 3584
  s_add_u32 m0, s41, 3712
  s_nop 0
  buffer_load_dwordx4 v115, s[8:11], s40 offen offset:0 lds
  s_add_u32 m0, s41, 3744
  s_nop 0
  buffer_load_dwordx4 v115, s[8:11], s40 offen offset:896 lds
  s_add_u32 m0, s41, 3776
  s_nop 0
  buffer_load_dwordx4 v115, s[8:11], s40 offen offset:1792 lds
  s_add_u32 m0, s41, 3808
  s_nop 0
  buffer_load_dwordx4 v115, s[8:11], s40 offen offset:2688 lds
  s_mov_b64 exec, -1
  s_add_u32 s40, s40, 25088
  s_mov_b32 s24, 0
  s_mov_b32 s25, 72024064
  s_mov_b32 s50, 72042496
  s_mov_b32 s51, 72060928
  v_lshrrev_b32 v6, 2, v115
  buffer_load_dword v7, v6, s[4:7], s44 offen sc1
  s_lshl_b32 s26, s20, 13
  s_add_u32 s26, s26, 72024064
  v_lshlrev_b32 v8, 3, v115
  buffer_load_dword v9, v8, s[4:7], s26 offen sc1
  s_waitcnt vmcnt(0)
  v_cmp_ne_u32 vcc, 0, v7
  s_ff0_i32_b64 s43, vcc
  s_waitcnt vmcnt(0)
  s_cmp_eq_u32 s20, 1
  s_cbranch_scc1 Ls_w_27
  s_cmp_eq_u32 s20, 2
  s_cbranch_scc1 Ls_w_28
  s_cmp_eq_u32 s20, 3
  s_cbranch_scc1 Ls_w_29
Ls_w_26:
Ls_loop_30:
  v_mov_b32 v32, 0
  v_mov_b32 v33, 0
  v_mov_b32 v34, 0
  v_mov_b32 v35, 0
  v_mov_b32 v36, 0
  v_mov_b32 v37, 0
  v_mov_b32 v38, 0
  v_mov_b32 v39, 0
  v_mov_b32 v40, 0
  v_mov_b32 v41, 0
  v_mov_b32 v42, 0
  v_mov_b32 v43, 0
  v_mov_b32 v44, 0
  v_mov_b32 v45, 0
  v_mov_b32 v46, 0
  v_mov_b32 v47, 0
  v_mov_b32 v48, 0
  v_mov_b32 v49, 0
  v_mov_b32 v50, 0
  v_mov_b32 v51, 0
  v_mov_b32 v52, 0
  v_mov_b32 v53, 0
  v_mov_b32 v54, 0
  v_mov_b32 v55, 0
  v_mov_b32 v56, 0
  v_mov_b32 v57, 0
  v_mov_b32 v58, 0
  v_mov_b32 v59, 0
  v_mov_b32 v100, 0
  v_mov_b32 v101, 0
  v_mov_b32 v102, 0
  v_mov_b32 v103, 0
  v_mov_b32 v104, 0
  v_mov_b32 v105, 0
  v_mov_b32 v106, 0
  v_mov_b32 v107, 0
  s_add_u32 s29, s24, 1
  v_lshrrev_b32 v4, 2, v115
  s_cmp_lt_u32 s29, s43
  s_cbranch_scc1 Luwd_32
  s_mov_b32 s30, 1048576
Luw_31:
  buffer_load_dword v5, v4, s[4:7], s44 offen sc1
  s_waitcnt vmcnt(0)
  v_cmp_ne_u32 vcc, 0, v5
  s_ff0_i32_b64 s43, vcc
  s_cmp_lt_u32 s29, s43
  s_cbranch_scc1 Luwd_32
  s_sleep 2
  s_sub_u32 s30, s30, 1
  s_cbranch_scc0 Luw_31
  s_branch Lk1_exit
Luwd_32:
  s_mov_b32 s30, 1048576
  buffer_load_dwordx4 v[76:79], v115, s[4:7], s25 offen offset:0 sc1
  buffer_load_dwordx4 v[80:83], v115, s[4:7], s25 offen offset:1024 sc1
  s_sleep 2
  buffer_load_dwordx4 v[84:87], v115, s[4:7], s25 offen offset:0 sc1
  buffer_load_dwordx4 v[88:91], v115, s[4:7], s25 offen offset:1024 sc1
Lpoll_33:
  s_waitcnt vmcnt(2)
  v_max_u32 v3, v79, v83
  v_cmp_eq_u32 vcc, -1, v3
  s_cbranch_vccnz Lfail_35
  ds_write_b128 v115, v[76:79] offset:0
  v_max3_u32 v3, v76, v77, v78
  ds_write_b128 v115, v[80:83] offset:1024
  v_max3_u32 v3, v3, v79, v80
  ds_read_b64_tr_b16 v[4:5], v113 offset:0
  v_max3_u32 v3, v3, v81, v82
  ds_read_b64_tr_b16 v[6:7], v113 offset:128
  v_max_u32 v3, v3, v83
  ds_read_b64_tr_b16 v[8:9], v113 offset:1024
  v_cmp_eq_u32 vcc, -1, v3
  ds_read_b64_tr_b16 v[10:11], v113 offset:1152
  s_cbranch_vccz Ljoin_34
Lfail_35:
  buffer_load_dwordx4 v[76:79], v115, s[4:7], s25 offen offset:0 sc1
  buffer_load_dwordx4 v[80:83], v115, s[4:7], s25 offen offset:1024 sc1
  s_waitcnt vmcnt(2)
  v_max_u32 v3, v87, v91
  v_cmp_eq_u32 vcc, -1, v3
  s_cbranch_vccnz Lfail_36
  ds_write_b128 v115, v[84:87] offset:0
  v_max3_u32 v3, v84, v85, v86
  ds_write_b128 v115, v[88:91] offset:1024
  v_max3_u32 v3, v3, v87, v88
  ds_read_b64_tr_b16 v[4:5], v113 offset:0
  v_max3_u32 v3, v3, v89, v90
  ds_read_b64_tr_b16 v[6:7], v113 offset:128
  v_max_u32 v3, v3, v91
  ds_read_b64_tr_b16 v[8:9], v113 offset:1024
  v_cmp_eq_u32 vcc, -1, v3
  ds_read_b64_tr_b16 v[10:11], v113 offset:1152
  s_cbranch_vccz Ljoin_34
Lfail_36:
  buffer_load_dwordx4 v[84:87], v115, s[4:7], s25 offen offset:0 sc1
  buffer_load_dwordx4 v[88:91], v115, s[4:7], s25 offen offset:1024 sc1
  s_sub_u32 s30, s30, 1
  s_cbranch_scc0 Lpoll_33
  s_branch Lk1_exit
Ljoin_34:
  s_waitcnt lgkmcnt(4)
  s_barrier
  s_waitcnt lgkmcnt(0)
  v_smfmac_f32_16x16x64_bf16 v[32:35], v[4:7], v[120:127], v112
  ds_read_b64_tr_b16 v[12:13], v113 offset:2048
  v_smfmac_f32_16x16x64_bf16 v[36:39], v[4:7], v[176:183], v112
  ds_read_b64_tr_b16 v[14:15], v113 offset:2176
  v_smfmac_f32_16x16x64_bf16 v[40:43], v[4:7], v[232:239], v112
  ds_read_b64_tr_b16 v[16:17], v113 offset:3072
  v_smfmac_f32_16x16x64_bf16 v[44:47], v[4:7], a[32:39], v112
  ds_read_b64_tr_b16 v[18:19], v113 offset:3200
  v_smfmac_f32_16x16x64_bf16 v[48:51], v[4:7], a[88:95], v112
  ds_read_b64_tr_b16 v[20:21], v113 offset:4096
  v_smfmac_f32_16x16x64_bf16 v[52:55], v[4:7], a[144:151], v112
  ds_read_b64_tr_b16 v[22:23], v113 offset:4224
  v_smfmac_f32_16x16x64_bf16 v[56:59], v[4:7], a[200:207], v112
  ds_read_b64_tr_b16 v[24:25], v113 offset:5120
  v_smfmac_f32_16x16x64_bf16 v[32:35], v[8:11], v[128:135], v112
  ds_read_b64_tr_b16 v[26:27], v113 offset:5248
  v_smfmac_f32_16x16x64_bf16 v[36:39], v[8:11], v[184:191], v112
  ds_read_b64_tr_b16 v[28:29], v113 offset:6144
  v_smfmac_f32_16x16x64_bf16 v[40:43], v[8:11], v[240:247], v112
  ds_read_b64_tr_b16 v[30:31], v113 offset:6272
  v_smfmac_f32_16x16x64_bf16 v[44:47], v[8:11], a[40:47], v112
  s_waitcnt vmcnt(0)
  ds_read_b64_tr_b16 v[76:77], v113 offset:0
  v_smfmac_f32_16x16x64_bf16 v[48:51], v[8:11], a[96:103], v112
  buffer_load_dword v95, v96, s[4:7], s42 offen sc1
  v_smfmac_f32_16x16x64_bf16 v[52:55], v[8:11], a[152:159], v112
  ds_read_b64_tr_b16 v[78:79], v113 offset:128
  v_smfmac_f32_16x16x64_bf16 v[56:59], v[8:11], a[208:215], v112
  ds_read_b64_tr_b16 v[80:81], v119 offset:0
  s_waitcnt lgkmcnt(10)
  v_smfmac_f32_16x16x64_bf16 v[32:35], v[12:15], v[136:143], v112
  ds_read_b64_tr_b16 v[82:83], v119 offset:128
  s_waitcnt lgkmcnt(9)
  v_smfmac_f32_16x16x64_bf16 v[32:35], v[16:19], v[144:151], v112
  ds_read_b128 v[60:63], v116 offset:24576
  s_waitcnt lgkmcnt(8)
  v_smfmac_f32_16x16x64_bf16 v[32:35], v[20:23], v[152:159], v112
  ds_read_b128 v[64:67], v116 offset:24640
  s_waitcnt lgkmcnt(7)
  v_smfmac_f32_16x16x64_bf16 v[32:35], v[24:27], v[160:167], v112
  ds_read_b128 v[68:71], v116 offset:39424
  s_waitcnt lgkmcnt(6)
  v_smfmac_f32_16x16x64_bf16 v[32:35], v[28:31], v[168:175], v112
  ds_read_b128 v[72:75], v116 offset:39488
  v_smfmac_f32_16x16x64_bf16 v[36:39], v[12:15], v[192:199], v112
  v_smfmac_f32_16x16x64_bf16 v[36:39], v[16:19], v[200:207], v112
  v_smfmac_f32_16x16x64_bf16 v[36:39], v[20:23], v[208:215], v112
  v_smfmac_f32_16x16x64_bf16 v[36:39], v[24:27], v[216:223], v112
  s_nop 2
  v_add_f32 v32, v32, v34
  v_smfmac_f32_16x16x64_bf16 v[36:39], v[28:31], v[224:231], v112
  v_add_f32 v33, v33, v35
  v_smfmac_f32_16x16x64_bf16 v[40:43], v[12:15], v[248:255], v112
  v_cvt_pk_bf16_f32 v32, v32, v33
  v_smfmac_f32_16x16x64_bf16 v[40:43], v[16:19], a[0:7], v112
  ds_write_b32 v114, v32 offset:7680
  v_smfmac_f32_16x16x64_bf16 v[40:43], v[20:23], a[8:15], v112
  ds_read_b128 v[32:35], v116 offset:24704
  v_smfmac_f32_16x16x64_bf16 v[40:43], v[24:27], a[16:23], v112
  v_add_f32 v36, v36, v38
  v_smfmac_f32_16x16x64_bf16 v[40:43], v[28:31], a[24:31], v112
  v_add_f32 v37, v37, v39
  v_smfmac_f32_16x16x64_bf16 v[44:47], v[12:15], a[48:55], v112
  v_cvt_pk_bf16_f32 v36, v36, v37
  v_smfmac_f32_16x16x64_bf16 v[44:47], v[16:19], a[56:63], v112
  ds_write_b32 v114, v36 offset:7936
  v_smfmac_f32_16x16x64_bf16 v[44:47], v[20:23], a[64:71], v112
  ds_read_b128 v[36:39], v117 offset:24576
  v_smfmac_f32_16x16x64_bf16 v[44:47], v[24:27], a[72:79], v112
  v_add_f32 v40, v40, v42
  v_smfmac_f32_16x16x64_bf16 v[44:47], v[28:31], a[80:87], v112
  v_add_f32 v41, v41, v43
  v_smfmac_f32_16x16x64_bf16 v[48:51], v[12:15], a[104:111], v112
  v_cvt_pk_bf16_f32 v40, v40, v41
  v_smfmac_f32_16x16x64_bf16 v[48:51], v[16:19], a[112:119], v112
  ds_write_b32 v114, v40 offset:8192
  v_smfmac_f32_16x16x64_bf16 v[48:51], v[20:23], a[120:127], v112
  ds_read_b128 v[40:43], v116 offset:39552
  v_smfmac_f32_16x16x64_bf16 v[48:51], v[24:27], a[128:135], v112
  v_add_f32 v44, v44, v46
  v_smfmac_f32_16x16x64_bf16 v[48:51], v[28:31], a[136:143], v112
  v_add_f32 v45, v45, v47
  v_smfmac_f32_16x16x64_bf16 v[52:55], v[12:15], a[160:167], v112
  v_cvt_pk_bf16_f32 v44, v44, v45
  v_smfmac_f32_16x16x64_bf16 v[52:55], v[16:19], a[168:175], v112
  ds_write_b32 v114, v44 offset:8448
  v_smfmac_f32_16x16x64_bf16 v[52:55], v[20:23], a[176:183], v112
  ds_read_b128 v[44:47], v117 offset:39424
  v_smfmac_f32_16x16x64_bf16 v[52:55], v[24:27], a[184:191], v112
  v_add_f32 v48, v48, v50
  v_smfmac_f32_16x16x64_bf16 v[52:55], v[28:31], a[192:199], v112
  v_add_f32 v49, v49, v51
  v_smfmac_f32_16x16x64_bf16 v[56:59], v[12:15], a[216:223], v112
  v_cvt_pk_bf16_f32 v48, v48, v49
  v_smfmac_f32_16x16x64_bf16 v[56:59], v[16:19], a[224:231], v112
  ds_write_b32 v114, v48 offset:8704
  v_smfmac_f32_16x16x64_bf16 v[56:59], v[20:23], a[232:239], v112
  ds_read_b64_tr_b16 v[84:85], v113 offset:7680
  ds_read_b64_tr_b16 v[86:87], v113 offset:7808
  v_smfmac_f32_16x16x64_bf16 v[56:59], v[24:27], a[240:247], v112
  v_add_f32 v52, v52, v54
  v_smfmac_f32_16x16x64_bf16 v[56:59], v[28:31], a[248:255], v112
  v_add_f32 v53, v53, v55
  v_cvt_pk_bf16_f32 v52, v52, v53
  ds_write_b32 v114, v52 offset:8960
  s_nop 4
  v_add_f32 v56, v56, v58
  v_add_f32 v57, v57, v59
  v_cvt_pk_bf16_f32 v56, v56, v57
  ds_write_b32 v114, v56 offset:9216
  ds_read_b64_tr_b16 v[16:17], v113 offset:8704
  ds_read_b64_tr_b16 v[18:19], v113 offset:8832
  s_waitcnt lgkmcnt(4)
  v_mfma_f32_16x16x32_bf16 v[108:111], v[84:87], v[76:79], 0
  v_smfmac_f32_16x16x64_bf16 v[100:103], v[84:87], v[60:67], v112
  v_smfmac_f32_16x16x64_bf16 v[104:107], v[84:87], v[68:75], v112
  s_waitcnt lgkmcnt(0)
  v_mfma_f32_16x16x32_bf16 v[108:111], v[16:19], v[80:83], v[108:111]
  v_smfmac_f32_16x16x64_bf16 v[100:103], v[16:19], v[32:39], v112
  s_waitcnt lgkmcnt(0)
  v_smfmac_f32_16x16x64_bf16 v[104:107], v[16:19], v[40:47], v112
  s_nop 4
  v_add_f32_dpp v108, v110, v108 quad_perm:[2,3,0,1] row_mask:0xf bank_mask:0xf
  v_add_f32_dpp v109, v111, v109 quad_perm:[2,3,0,1] row_mask:0xf bank_mask:0xf
  ds_write2_b32 v0, v108, v109 offset0:64 offset1:80
  v_add_f32 v100, v100, v102
  v_add_f32 v101, v101, v103
  ds_write2_b32 v0, v100, v101 offset0:0 offset1:32
  v_add_f32 v104, v104, v106
  v_add_f32 v105, v105, v107
  ds_write2_b32 v0, v104, v105 offset0:16 offset1:48
  s_waitcnt lgkmcnt(0)
  s_barrier
  ds_read_b64 v[4:5], v1 offset:15360
  ds_read_b64 v[6:7], v1 offset:17152
  ds_read_b64 v[8:9], v1 offset:18944
  ds_read_b64 v[10:11], v1 offset:20736
  ds_read_b32 v12, v2 offset:15616
  ds_read_b32 v13, v2 offset:17408
  ds_read_b32 v14, v2 offset:19200
  ds_read_b32 v15, v2 offset:20992
  s_waitcnt lgkmcnt(6)
  v_pk_add_f32 v[4:5], v[4:5], v[6:7]
  s_waitcnt lgkmcnt(4)
  v_pk_add_f32 v[8:9], v[8:9], v[10:11]
  v_pk_add_f32 v[4:5], v[4:5], v[8:9]
  v_exp_f32 v16, v4
  v_exp_f32 v17, v5
  s_waitcnt lgkmcnt(0)
  v_pk_add_f32 v[12:13], v[12:13], v[14:15]
  v_add_f32 v21, v16, v17
  v_add_f32 v12, v12, v13
  v_exp_f32 v18, v12
  v_max3_f32 v20, |v4|, |v5|, |v12|
  v_cmp_nge_f32 vcc, s34, v20
Lnorm_38:
  v_fma_f32 v21, 0.5, v18, v21
  s_nop 1
  v_add_f32_dpp v21, v21, v21 quad_perm:[1,0,3,2] row_mask:0xf bank_mask:0xf
  s_nop 1
  v_add_f32_dpp v21, v21, v21 quad_perm:[2,3,0,1] row_mask:0xf bank_mask:0xf
  s_nop 1
  v_add_f32_dpp v21, v21, v21 row_half_mirror row_mask:0xf bank_mask:0xf
  s_nop 1
  v_add_f32_dpp v21, v21, v21 row_mirror row_mask:0xf bank_mask:0xf
  v_rcp_f32 v21, v21
  s_nop 0
  v_mul_f32_e64 v18, v18, v21 clamp
  v_mul_f32_e64 v16, v16, v21 clamp
  v_mul_f32_e64 v17, v17, v21 clamp
  s_cbranch_vccnz Lslow_37
  v_mov_b32_dpp v20, v18 quad_perm:[1,0,3,2] row_mask:0xf bank_mask:0xf
  v_cvt_pk_bf16_f32 v16, v16, v17
  buffer_store_dword v16, v98, s[4:7], s25 offen
  v_cvt_pk_bf16_f32 v18, v18, v20
  buffer_store_dword v18, v99, s[4:7], s25 offen
  s_barrier
  v_mov_b32 v6, -1
  buffer_store_dword v6, v98, s[4:7], s51 offen
  buffer_store_dword v6, v99, s[4:7], s51 offen
  s_sleep 6
  s_mov_b64 exec, s[32:33]
  s_add_u32 m0, s41, 0
  s_nop 0
  buffer_load_dwordx4 v115, s[8:11], s40 offen offset:0 lds
  s_add_u32 m0, s41, 32
  s_nop 0
  buffer_load_dwordx4 v115, s[8:11], s40 offen offset:896 lds
  s_add_u32 m0, s41, 64
  s_nop 0
  buffer_load_dwordx4 v115, s[8:11], s40 offen offset:1792 lds
  s_add_u32 m0, s41, 96
  s_nop 0
  buffer_load_dwordx4 v115, s[8:11], s40 offen offset:2688 lds
  s_add_u32 s40, s40, 3584
  s_add_u32 m0, s41, 3712
  s_nop 0
  buffer_load_dwordx4 v115, s[8:11], s40 offen offset:0 lds
  s_add_u32 m0, s41, 3744
  s_nop 0
  buffer_load_dwordx4 v115, s[8:11], s40 offen offset:896 lds
  s_add_u32 m0, s41, 3776
  s_nop 0
  buffer_load_dwordx4 v115, s[8:11], s40 offen offset:1792 lds
  s_add_u32 m0, s41, 3808
  s_nop 0
  buffer_load_dwordx4 v115, s[8:11], s40 offen offset:2688 lds
  s_mov_b64 exec, -1
  s_add_u32 s40, s40, 25088
  s_add_u32 s42, s42, 28672
  s_mov_b32 s26, s25
  s_mov_b32 s25, s50
  s_mov_b32 s50, s51
  s_mov_b32 s51, s26
  s_add_u32 s24, s24, 1
  s_cmp_lt_u32 s24, 63
  s_cbranch_scc1 Ls_loop_30
  s_endpgm
Lslow_37:
  v_max3_f32 v20, v4, v5, v12
  s_nop 1
  v_max_f32_dpp v20, v20, v20 quad_perm:[1,0,3,2] row_mask:0xf bank_mask:0xf
  s_nop 1
  v_max_f32_dpp v20, v20, v20 quad_perm:[2,3,0,1] row_mask:0xf bank_mask:0xf
  s_nop 1
  v_max_f32_dpp v20, v20, v20 row_half_mirror row_mask:0xf bank_mask:0xf
  s_nop 1
  v_max_f32_dpp v20, v20, v20 row_mirror row_mask:0xf bank_mask:0xf
  v_sub_f32 v16, v4, v20
  v_sub_f32 v17, v5, v20
  v_sub_f32 v18, v12, v20
  v_exp_f32 v16, v16
  v_exp_f32 v17, v17
  v_exp_f32 v18, v18
  s_mov_b64 vcc, 0
  v_add_f32 v21, v16, v17
  s_branch Lnorm_38
Ls_w_27:
Ls_loop_39:
  v_mov_b32 v32, 0
  v_mov_b32 v33, 0
  v_mov_b32 v34, 0
  v_mov_b32 v35, 0
  v_mov_b32 v36, 0
  v_mov_b32 v37, 0
  v_mov_b32 v38, 0
  v_mov_b32 v39, 0
  v_mov_b32 v40, 0
  v_mov_b32 v41, 0
  v_mov_b32 v42, 0
  v_mov_b32 v43, 0
  v_mov_b32 v44, 0
  v_mov_b32 v45, 0
  v_mov_b32 v46, 0
  v_mov_b32 v47, 0
  v_mov_b32 v48, 0
  v_mov_b32 v49, 0
  v_mov_b32 v50, 0
  v_mov_b32 v51, 0
  v_mov_b32 v52, 0
  v_mov_b32 v53, 0
  v_mov_b32 v54, 0
  v_mov_b32 v55, 0
  v_mov_b32 v56, 0
  v_mov_b32 v57, 0
  v_mov_b32 v58, 0
  v_mov_b32 v59, 0
  v_mov_b32 v100, 0
  v_mov_b32 v101, 0
  v_mov_b32 v102, 0
  v_mov_b32 v103, 0
  v_mov_b32 v104, 0
  v_mov_b32 v105, 0
  v_mov_b32 v106, 0
  v_mov_b32 v107, 0
  s_add_u32 s29, s24, 1
  v_lshrrev_b32 v4, 2, v115
  s_cmp_lt_u32 s29, s43
  s_cbranch_scc1 Luwd_41
  s_mov_b32 s30, 1048576
Luw_40:
  buffer_load_dword v5, v4, s[4:7], s44 offen sc1
  s_waitcnt vmcnt(0)
  v_cmp_ne_u32 vcc, 0, v5
  s_ff0_i32_b64 s43, vcc
  s_cmp_lt_u32 s29, s43
  s_cbranch_scc1 Luwd_41
  s_sleep 2
  s_sub_u32 s30, s30, 1
  s_cbranch_scc0 Luw_40
  s_branch Lk1_exit
Luwd_41:
  s_mov_b32 s30, 1048576
  buffer_load_dwordx4 v[76:79], v115, s[4:7], s25 offen offset:2048 sc1
  buffer_load_dwordx4 v[80:83], v115, s[4:7], s25 offen offset:3072 sc1
  s_sleep 2
  buffer_load_dwordx4 v[84:87], v115, s[4:7], s25 offen offset:2048 sc1
  buffer_load_dwordx4 v[88:91], v115, s[4:7], s25 offen offset:3072 sc1
Lpoll_42:
  s_waitcnt vmcnt(2)
  v_max_u32 v3, v79, v83
  v_cmp_eq_u32 vcc, -1, v3
  s_cbranch_vccnz Lfail_44
  ds_write_b128 v115, v[76:79] offset:2048
  v_max3_u32 v3, v76, v77, v78
  ds_write_b128 v115, v[80:83] offset:3072
  v_max3_u32 v3, v3, v79, v80
  ds_read_b64_tr_b16 v[12:13], v113 offset:2048
  v_max3_u32 v3, v3, v81, v82
  ds_read_b64_tr_b16 v[14:15], v113 offset:2176
  v_max_u32 v3, v3, v83
  ds_read_b64_tr_b16 v[16:17], v113 offset:3072
  v_cmp_eq_u32 vcc, -1, v3
  ds_read_b64_tr_b16 v[18:19], v113 offset:3200
  s_cbranch_vccz Ljoin_43
Lfail_44:
  buffer_load_dwordx4 v[76:79], v115, s[4:7], s25 offen offset:2048 sc1
  buffer_load_dwordx4 v[80:83], v115, s[4:7], s25 offen offset:3072 sc1
  s_waitcnt vmcnt(2)
  v_max_u32 v3, v87, v91
  v_cmp_eq_u32 vcc, -1, v3
  s_cbranch_vccnz Lfail_45
  ds_write_b128 v115, v[84:87] offset:2048
  v_max3_u32 v3, v84, v85, v86
  ds_write_b128 v115, v[88:91] offset:3072
  v_max3_u32 v3, v3, v87, v88
  ds_read_b64_tr_b16 v[12:13], v113 offset:2048
  v_max3_u32 v3, v3, v89, v90
  ds_read_b64_tr_b16 v[14:15], v113 offset:2176
  v_max_u32 v3, v3, v91
  ds_read_b64_tr_b16 v[16:17], v113 offset:3072
  v_cmp_eq_u32 vcc, -1, v3
  ds_read_b64_tr_b16 v[18:19], v113 offset:3200
  s_cbranch_vccz Ljoin_43
Lfail_45:
  buffer_load_dwordx4 v[84:87], v115, s[4:7], s25 offen offset:2048 sc1
  buffer_load_dwordx4 v[88:91], v115, s[4:7], s25 offen offset:3072 sc1
  s_sub_u32 s30, s30, 1
  s_cbranch_scc0 Lpoll_42
  s_branch Lk1_exit
Ljoin_43:
  s_waitcnt lgkmcnt(4)
  s_barrier
  s_waitcnt lgkmcnt(0)
  v_smfmac_f32_16x16x64_bf16 v[32:35], v[12:15], v[136:143], v112
  ds_read_b64_tr_b16 v[4:5], v113 offset:0
  v_smfmac_f32_16x16x64_bf16 v[36:39], v[12:15], v[192:199], v112
  ds_read_b64_tr_b16 v[6:7], v113 offset:128
  v_smfmac_f32_16x16x64_bf16 v[40:43], v[12:15], v[248:255], v112
  ds_read_b64_tr_b16 v[8:9], v113 offset:1024
  v_smfmac_f32_16x16x64_bf16 v[44:47], v[12:15], a[48:55], v112
  ds_read_b64_tr_b16 v[10:11], v113 offset:1152
  v_smfmac_f32_16x16x64_bf16 v[48:51], v[12:15], a[104:111], v112
  ds_read_b64_tr_b16 v[20:21], v113 offset:4096
  v_smfmac_f32_16x16x64_bf16 v[52:55], v[12:15], a[160:167], v112
  ds_read_b64_tr_b16 v[22:23], v113 offset:4224
  v_smfmac_f32_16x16x64_bf16 v[56:59], v[12:15], a[216:223], v112
  ds_read_b64_tr_b16 v[24:25], v113 offset:5120
  v_smfmac_f32_16x16x64_bf16 v[32:35], v[16:19], v[144:151], v112
  ds_read_b64_tr_b16 v[26:27], v113 offset:5248
  v_smfmac_f32_16x16x64_bf16 v[36:39], v[16:19], v[200:207], v112
  ds_read_b64_tr_b16 v[28:29], v113 offset:6144
  v_smfmac_f32_16x16x64_bf16 v[40:43], v[16:19], a[0:7], v112
  ds_read_b64_tr_b16 v[30:31], v113 offset:6272
  v_smfmac_f32_16x16x64_bf16 v[44:47], v[16:19], a[56:63], v112
  s_waitcnt vmcnt(0)
  ds_read_b64_tr_b16 v[76:77], v113 offset:1792
  v_smfmac_f32_16x16x64_bf16 v[48:51], v[16:19], a[112:119], v112
  buffer_load_dword v95, v96, s[4:7], s42 offen sc1
  v_smfmac_f32_16x16x64_bf16 v[52:55], v[16:19], a[168:175], v112
  ds_read_b64_tr_b16 v[78:79], v113 offset:1920
  v_smfmac_f32_16x16x64_bf16 v[56:59], v[16:19], a[224:231], v112
  ds_read_b64_tr_b16 v[80:81], v119 offset:0
  s_waitcnt lgkmcnt(10)
  v_smfmac_f32_16x16x64_bf16 v[32:35], v[4:7], v[120:127], v112
  ds_read_b64_tr_b16 v[82:83], v119 offset:128
  s_waitcnt lgkmcnt(9)
  v_smfmac_f32_16x16x64_bf16 v[32:35], v[8:11], v[128:135], v112
  ds_read_b128 v[60:63], v116 offset:24800
  s_waitcnt lgkmcnt(8)
  v_smfmac_f32_16x16x64_bf16 v[32:35], v[20:23], v[152:159], v112
  ds_read_b128 v[64:67], v116 offset:24864
  s_waitcnt lgkmcnt(7)
  v_smfmac_f32_16x16x64_bf16 v[32:35], v[24:27], v[160:167], v112
  ds_read_b128 v[68:71], v116 offset:39648
  s_waitcnt lgkmcnt(6)
  v_smfmac_f32_16x16x64_bf16 v[32:35], v[28:31], v[168:175], v112
  ds_read_b128 v[72:75], v116 offset:39712
  v_smfmac_f32_16x16x64_bf16 v[36:39], v[4:7], v[176:183], v112
  v_smfmac_f32_16x16x64_bf16 v[36:39], v[8:11], v[184:191], v112
  v_smfmac_f32_16x16x64_bf16 v[36:39], v[20:23], v[208:215], v112
  v_smfmac_f32_16x16x64_bf16 v[36:39], v[24:27], v[216:223], v112
  s_nop 2
  v_add_f32 v32, v32, v34
  v_smfmac_f32_16x16x64_bf16 v[36:39], v[28:31], v[224:231], v112
  v_add_f32 v33, v33, v35
  v_smfmac_f32_16x16x64_bf16 v[40:43], v[4:7], v[232:239], v112
  v_cvt_pk_bf16_f32 v32, v32, v33
  v_smfmac_f32_16x16x64_bf16 v[40:43], v[8:11], v[240:247], v112
  ds_write_b32 v114, v32 offset:9472
  v_smfmac_f32_16x16x64_bf16 v[40:43], v[20:23], a[8:15], v112
  ds_read_b128 v[32:35], v116 offset:24928
  v_smfmac_f32_16x16x64_bf16 v[40:43], v[24:27], a[16:23], v112
  v_add_f32 v36, v36, v38
  v_smfmac_f32_16x16x64_bf16 v[40:43], v[28:31], a[24:31], v112
  v_add_f32 v37, v37, v39
  v_smfmac_f32_16x16x64_bf16 v[44:47], v[4:7], a[32:39], v112
  v_cvt_pk_bf16_f32 v36, v36, v37
  v_smfmac_f32_16x16x64_bf16 v[44:47], v[8:11], a[40:47], v112
  ds_write_b32 v114, v36 offset:9728
  v_smfmac_f32_16x16x64_bf16 v[44:47], v[20:23], a[64:71], v112
  ds_read_b128 v[36:39], v117 offset:24576
  v_smfmac_f32_16x16x64_bf16 v[44:47], v[24:27], a[72:79], v112
  v_add_f32 v40, v40, v42
  v_smfmac_f32_16x16x64_bf16 v[44:47], v[28:31], a[80:87], v112
  v_add_f32 v41, v41, v43
  v_smfmac_f32_16x16x64_bf16 v[48:51], v[4:7], a[88:95], v112
  v_cvt_pk_bf16_f32 v40, v40, v41
  v_smfmac_f32_16x16x64_bf16 v[48:51], v[8:11], a[96:103], v112
  ds_write_b32 v114, v40 offset:9984
  v_smfmac_f32_16x16x64_bf16 v[48:51], v[20:23], a[120:127], v112
  ds_read_b128 v[40:43], v116 offset:39776
  v_smfmac_f32_16x16x64_bf16 v[48:51], v[24:27], a[128:135], v112
  v_add_f32 v44, v44, v46
  v_smfmac_f32_16x16x64_bf16 v[48:51], v[28:31], a[136:143], v112
  v_add_f32 v45, v45, v47
  v_smfmac_f32_16x16x64_bf16 v[52:55], v[4:7], a[144:151], v112
  v_cvt_pk_bf16_f32 v44, v44, v45
  v_smfmac_f32_16x16x64_bf16 v[52:55], v[8:11], a[152:159], v112
  ds_write_b32 v114, v44 offset:10240
  v_smfmac_f32_16x16x64_bf16 v[52:55], v[20:23], a[176:183], v112
  ds_read_b128 v[44:47], v117 offset:39424
  v_smfmac_f32_16x16x64_bf16 v[52:55], v[24:27], a[184:191], v112
  v_add_f32 v48, v48, v50
  v_smfmac_f32_16x16x64_bf16 v[52:55], v[28:31], a[192:199], v112
  v_add_f32 v49, v49, v51
  v_smfmac_f32_16x16x64_bf16 v[56:59], v[4:7], a[200:207], v112
  v_cvt_pk_bf16_f32 v48, v48, v49
  v_smfmac_f32_16x16x64_bf16 v[56:59], v[8:11], a[208:215], v112
  ds_write_b32 v114, v48 offset:10496
  v_smfmac_f32_16x16x64_bf16 v[56:59], v[20:23], a[232:239], v112
  ds_read_b64_tr_b16 v[84:85], v113 offset:9472
  ds_read_b64_tr_b16 v[86:87], v113 offset:9600
  v_smfmac_f32_16x16x64_bf16 v[56:59], v[24:27], a[240:247], v112
  v_add_f32 v52, v52, v54
  v_smfmac_f32_16x16x64_bf16 v[56:59], v[28:31], a[248:255], v112
  v_add_f32 v53, v53, v55
  v_cvt_pk_bf16_f32 v52, v52, v53
  ds_write_b32 v114, v52 offset:10752
  s_nop 4
  v_add_f32 v56, v56, v58
  v_add_f32 v57, v57, v59
  v_cvt_pk_bf16_f32 v56, v56, v57
  ds_write_b32 v114, v56 offset:11008
  ds_read_b64_tr_b16 v[8:9], v113 offset:10496
  ds_read_b64_tr_b16 v[10:11], v113 offset:10624
  s_waitcnt lgkmcnt(4)
  v_mfma_f32_16x16x32_bf16 v[108:111], v[84:87], v[76:79], 0
  v_smfmac_f32_16x16x64_bf16 v[100:103], v[84:87], v[60:67], v112
  v_smfmac_f32_16x16x64_bf16 v[104:107], v[84:87], v[68:75], v112
  s_waitcnt lgkmcnt(0)
  v_mfma_f32_16x16x32_bf16 v[108:111], v[8:11], v[80:83], v[108:111]
  v_smfmac_f32_16x16x64_bf16 v[100:103], v[8:11], v[32:39], v112
  s_waitcnt lgkmcnt(0)
  v_smfmac_f32_16x16x64_bf16 v[104:107], v[8:11], v[40:47], v112
  s_nop 4
  v_add_f32_dpp v108, v110, v108 quad_perm:[2,3,0,1] row_mask:0xf bank_mask:0xf
  v_add_f32_dpp v109, v111, v109 quad_perm:[2,3,0,1] row_mask:0xf bank_mask:0xf
  ds_write2_b32 v0, v108, v109 offset0:64 offset1:80
  v_add_f32 v100, v100, v102
  v_add_f32 v101, v101, v103
  ds_write2_b32 v0, v100, v101 offset0:0 offset1:32
  v_add_f32 v104, v104, v106
  v_add_f32 v105, v105, v107
  ds_write2_b32 v0, v104, v105 offset0:16 offset1:48
  s_waitcnt lgkmcnt(0)
  s_barrier
  ds_read_b64 v[4:5], v1 offset:15360
  ds_read_b64 v[6:7], v1 offset:17152
  ds_read_b64 v[8:9], v1 offset:18944
  ds_read_b64 v[10:11], v1 offset:20736
  ds_read_b32 v12, v2 offset:15616
  ds_read_b32 v13, v2 offset:17408
  ds_read_b32 v14, v2 offset:19200
  ds_read_b32 v15, v2 offset:20992
  s_waitcnt lgkmcnt(6)
  v_pk_add_f32 v[4:5], v[4:5], v[6:7]
  s_waitcnt lgkmcnt(4)
  v_pk_add_f32 v[8:9], v[8:9], v[10:11]
  v_pk_add_f32 v[4:5], v[4:5], v[8:9]
  v_exp_f32 v16, v4
  v_exp_f32 v17, v5
  s_waitcnt lgkmcnt(0)
  v_pk_add_f32 v[12:13], v[12:13], v[14:15]
  v_add_f32 v21, v16, v17
  v_add_f32 v12, v12, v13
  v_exp_f32 v18, v12
  v_max3_f32 v20, |v4|, |v5|, |v12|
  v_cmp_nge_f32 vcc, s34, v20
Lnorm_47:
  v_fma_f32 v21, 0.5, v18, v21
  s_nop 1
  v_add_f32_dpp v21, v21, v21 quad_perm:[1,0,3,2] row_mask:0xf bank_mask:0xf
  s_nop 1
  v_add_f32_dpp v21, v21, v21 quad_perm:[2,3,0,1] row_mask:0xf bank_mask:0xf
  s_nop 1
  v_add_f32_dpp v21, v21, v21 row_half_mirror row_mask:0xf bank_mask:0xf
  s_nop 1
  v_add_f32_dpp v21, v21, v21 row_mirror row_mask:0xf bank_mask:0xf
  v_rcp_f32 v21, v21
  s_nop 0
  v_mul_f32_e64 v18, v18, v21 clamp
  v_mul_f32_e64 v16, v16, v21 clamp
  v_mul_f32_e64 v17, v17, v21 clamp
  s_cbranch_vccnz Lslow_46
  v_mov_b32_dpp v20, v18 quad_perm:[1,0,3,2] row_mask:0xf bank_mask:0xf
  v_cvt_pk_bf16_f32 v16, v16, v17
  buffer_store_dword v16, v98, s[4:7], s25 offen
  v_cvt_pk_bf16_f32 v18, v18, v20
  buffer_store_dword v18, v99, s[4:7], s25 offen
  s_barrier
  v_mov_b32 v6, -1
  buffer_store_dword v6, v98, s[4:7], s51 offen
  buffer_store_dword v6, v99, s[4:7], s51 offen
  s_sleep 6
  s_mov_b64 exec, s[32:33]
  s_add_u32 m0, s41, 0
  s_nop 0
  buffer_load_dwordx4 v115, s[8:11], s40 offen offset:0 lds
  s_add_u32 m0, s41, 32
  s_nop 0
  buffer_load_dwordx4 v115, s[8:11], s40 offen offset:896 lds
  s_add_u32 m0, s41, 64
  s_nop 0
  buffer_load_dwordx4 v115, s[8:11], s40 offen offset:1792 lds
  s_add_u32 m0, s41, 96
  s_nop 0
  buffer_load_dwordx4 v115, s[8:11], s40 offen offset:2688 lds
  s_add_u32 s40, s40, 3584
  s_add_u32 m0, s41, 3712
  s_nop 0
  buffer_load_dwordx4 v115, s[8:11], s40 offen offset:0 lds
  s_add_u32 m0, s41, 3744
  s_nop 0
  buffer_load_dwordx4 v115, s[8:11], s40 offen offset:896 lds
  s_add_u32 m0, s41, 3776
  s_nop 0
  buffer_load_dwordx4 v115, s[8:11], s40 offen offset:1792 lds
  s_add_u32 m0, s41, 3808
  s_nop 0
  buffer_load_dwordx4 v115, s[8:11], s40 offen offset:2688 lds
  s_mov_b64 exec, -1
  s_add_u32 s40, s40, 25088
  s_add_u32 s42, s42, 28672
  s_mov_b32 s26, s25
  s_mov_b32 s25, s50
  s_mov_b32 s50, s51
  s_mov_b32 s51, s26
  s_add_u32 s24, s24, 1
  s_cmp_lt_u32 s24, 63
  s_cbranch_scc1 Ls_loop_39
  s_endpgm
Lslow_46:
  v_max3_f32 v20, v4, v5, v12
  s_nop 1
  v_max_f32_dpp v20, v20, v20 quad_perm:[1,0,3,2] row_mask:0xf bank_mask:0xf
  s_nop 1
  v_max_f32_dpp v20, v20, v20 quad_perm:[2,3,0,1] row_mask:0xf bank_mask:0xf
  s_nop 1
  v_max_f32_dpp v20, v20, v20 row_half_mirror row_mask:0xf bank_mask:0xf
  s_nop 1
  v_max_f32_dpp v20, v20, v20 row_mirror row_mask:0xf bank_mask:0xf
  v_sub_f32 v16, v4, v20
  v_sub_f32 v17, v5, v20
  v_sub_f32 v18, v12, v20
  v_exp_f32 v16, v16
  v_exp_f32 v17, v17
  v_exp_f32 v18, v18
  s_mov_b64 vcc, 0
  v_add_f32 v21, v16, v17
  s_branch Lnorm_47
Ls_w_28:
Ls_loop_48:
  v_mov_b32 v32, 0
  v_mov_b32 v33, 0
  v_mov_b32 v34, 0
  v_mov_b32 v35, 0
  v_mov_b32 v36, 0
  v_mov_b32 v37, 0
  v_mov_b32 v38, 0
  v_mov_b32 v39, 0
  v_mov_b32 v40, 0
  v_mov_b32 v41, 0
  v_mov_b32 v42, 0
  v_mov_b32 v43, 0
  v_mov_b32 v44, 0
  v_mov_b32 v45, 0
  v_mov_b32 v46, 0
  v_mov_b32 v47, 0
  v_mov_b32 v48, 0
  v_mov_b32 v49, 0
  v_mov_b32 v50, 0
  v_mov_b32 v51, 0
  v_mov_b32 v52, 0
  v_mov_b32 v53, 0
  v_mov_b32 v54, 0
  v_mov_b32 v55, 0
  v_mov_b32 v56, 0
  v_mov_b32 v57, 0
  v_mov_b32 v58, 0
  v_mov_b32 v59, 0
  v_mov_b32 v100, 0
  v_mov_b32 v101, 0
  v_mov_b32 v102, 0
  v_mov_b32 v103, 0
  v_mov_b32 v104, 0
  v_mov_b32 v105, 0
  v_mov_b32 v106, 0
  v_mov_b32 v107, 0
  s_add_u32 s29, s24, 1
  v_lshrrev_b32 v4, 2, v115
  s_cmp_lt_u32 s29, s43
  s_cbranch_scc1 Luwd_50
  s_mov_b32 s30, 1048576
Luw_49:
  buffer_load_dword v5, v4, s[4:7], s44 offen sc1
  s_waitcnt vmcnt(0)
  v_cmp_ne_u32 vcc, 0, v5
  s_ff0_i32_b64 s43, vcc
  s_cmp_lt_u32 s29, s43
  s_cbranch_scc1 Luwd_50
  s_sleep 2
  s_sub_u32 s30, s30, 1
  s_cbranch_scc0 Luw_49
  s_branch Lk1_exit
Luwd_50:
  s_add_u32 s31, s25, 4096
  s_mov_b32 s30, 1048576
  buffer_load_dwordx4 v[76:79], v115, s[4:7], s31 offen offset:0 sc1
  buffer_load_dwordx4 v[80:83], v115, s[4:7], s31 offen offset:1024 sc1
  s_sleep 2
  buffer_load_dwordx4 v[84:87], v115, s[4:7], s31 offen offset:0 sc1
  buffer_load_dwordx4 v[88:91], v115, s[4:7], s31 offen offset:1024 sc1
Lpoll_51:
  s_waitcnt vmcnt(2)
  v_max_u32 v3, v79, v83
  v_cmp_eq_u32 vcc, -1, v3
  s_cbranch_vccnz Lfail_53
  ds_write_b128 v115, v[76:79] offset:4096
  v_max3_u32 v3, v76, v77, v78
  ds_write_b128 v115, v[80:83] offset:5120
  v_max3_u32 v3, v3, v79, v80
  ds_read_b64_tr_b16 v[20:21], v113 offset:4096
  v_max3_u32 v3, v3, v81, v82
  ds_read_b64_tr_b16 v[22:23], v113 offset:4224
  v_max_u32 v3, v3, v83
  ds_read_b64_tr_b16 v[24:25], v113 offset:5120
  v_cmp_eq_u32 vcc, -1, v3
  ds_read_b64_tr_b16 v[26:27], v113 offset:5248
  s_cbranch_vccz Ljoin_52
Lfail_53:
  buffer_load_dwordx4 v[76:79], v115, s[4:7], s31 offen offset:0 sc1
  buffer_load_dwordx4 v[80:83], v115, s[4:7], s31 offen offset:1024 sc1
  s_waitcnt vmcnt(2)
  v_max_u32 v3, v87, v91
  v_cmp_eq_u32 vcc, -1, v3
  s_cbranch_vccnz Lfail_54
  ds_write_b128 v115, v[84:87] offset:4096
  v_max3_u32 v3, v84, v85, v86
  ds_write_b128 v115, v[88:91] offset:5120
  v_max3_u32 v3, v3, v87, v88
  ds_read_b64_tr_b16 v[20:21], v113 offset:4096
  v_max3_u32 v3, v3, v89, v90
  ds_read_b64_tr_b16 v[22:23], v113 offset:4224
  v_max_u32 v3, v3, v91
  ds_read_b64_tr_b16 v[24:25], v113 offset:5120
  v_cmp_eq_u32 vcc, -1, v3
  ds_read_b64_tr_b16 v[26:27], v113 offset:5248
  s_cbranch_vccz Ljoin_52
Lfail_54:
  buffer_load_dwordx4 v[84:87], v115, s[4:7], s31 offen offset:0 sc1
  buffer_load_dwordx4 v[88:91], v115, s[4:7], s31 offen offset:1024 sc1
  s_sub_u32 s30, s30, 1
  s_cbranch_scc0 Lpoll_51
  s_branch Lk1_exit
Ljoin_52:
  s_waitcnt lgkmcnt(4)
  s_barrier
  s_waitcnt lgkmcnt(0)
  v_smfmac_f32_16x16x64_bf16 v[32:35], v[20:23], v[152:159], v112
  ds_read_b64_tr_b16 v[4:5], v113 offset:0
  v_smfmac_f32_16x16x64_bf16 v[36:39], v[20:23], v[208:215], v112
  ds_read_b64_tr_b16 v[6:7], v113 offset:128
  v_smfmac_f32_16x16x64_bf16 v[40:43], v[20:23], a[8:15], v112
  ds_read_b64_tr_b16 v[8:9], v113 offset:1024
  v_smfmac_f32_16x16x64_bf16 v[44:47], v[20:23], a[64:71], v112
  ds_read_b64_tr_b16 v[10:11], v113 offset:1152
  v_smfmac_f32_16x16x64_bf16 v[48:51], v[20:23], a[120:127], v112
  ds_read_b64_tr_b16 v[12:13], v113 offset:2048
  v_smfmac_f32_16x16x64_bf16 v[52:55], v[20:23], a[176:183], v112
  ds_read_b64_tr_b16 v[14:15], v113 offset:2176
  v_smfmac_f32_16x16x64_bf16 v[56:59], v[20:23], a[232:239], v112
  ds_read_b64_tr_b16 v[16:17], v113 offset:3072
  v_smfmac_f32_16x16x64_bf16 v[32:35], v[24:27], v[160:167], v112
  ds_read_b64_tr_b16 v[18:19], v113 offset:3200
  v_smfmac_f32_16x16x64_bf16 v[36:39], v[24:27], v[216:223], v112
  ds_read_b64_tr_b16 v[28:29], v113 offset:6144
  v_smfmac_f32_16x16x64_bf16 v[40:43], v[24:27], a[16:23], v112
  ds_read_b64_tr_b16 v[30:31], v113 offset:6272
  v_smfmac_f32_16x16x64_bf16 v[44:47], v[24:27], a[72:79], v112
  s_waitcnt vmcnt(0)
  ds_read_b64_tr_b16 v[76:77], v113 offset:3584
  v_smfmac_f32_16x16x64_bf16 v[48:51], v[24:27], a[128:135], v112
  buffer_load_dword v95, v96, s[4:7], s42 offen sc1
  v_smfmac_f32_16x16x64_bf16 v[52:55], v[24:27], a[184:191], v112
  ds_read_b64_tr_b16 v[78:79], v113 offset:3712
  v_smfmac_f32_16x16x64_bf16 v[56:59], v[24:27], a[240:247], v112
  ds_read_b64_tr_b16 v[80:81], v119 offset:0
  s_waitcnt lgkmcnt(10)
  v_smfmac_f32_16x16x64_bf16 v[32:35], v[4:7], v[120:127], v112
  ds_read_b64_tr_b16 v[82:83], v119 offset:128
  s_waitcnt lgkmcnt(9)
  v_smfmac_f32_16x16x64_bf16 v[32:35], v[8:11], v[128:135], v112
  ds_read_b128 v[60:63], v116 offset:25024
  s_waitcnt lgkmcnt(8)
  v_smfmac_f32_16x16x64_bf16 v[32:35], v[12:15], v[136:143], v112
  ds_read_b128 v[64:67], v116 offset:25088
  s_waitcnt lgkmcnt(7)
  v_smfmac_f32_16x16x64_bf16 v[32:35], v[16:19], v[144:151], v112
  ds_read_b128 v[68:71], v116 offset:39872
  s_waitcnt lgkmcnt(6)
  v_smfmac_f32_16x16x64_bf16 v[32:35], v[28:31], v[168:175], v112
  ds_read_b128 v[72:75], v116 offset:39936
  v_smfmac_f32_16x16x64_bf16 v[36:39], v[4:7], v[176:183], v112
  v_smfmac_f32_16x16x64_bf16 v[36:39], v[8:11], v[184:191], v112
  v_smfmac_f32_16x16x64_bf16 v[36:39], v[12:15], v[192:199], v112
  v_smfmac_f32_16x16x64_bf16 v[36:39], v[16:19], v[200:207], v112
  s_nop 2
  v_add_f32 v32, v32, v34
  v_smfmac_f32_16x16x64_bf16 v[36:39], v[28:31], v[224:231], v112
  v_add_f32 v33, v33, v35
  v_smfmac_f32_16x16x64_bf16 v[40:43], v[4:7], v[232:239], v112
  v_cvt_pk_bf16_f32 v32, v32, v33
  v_smfmac_f32_16x16x64_bf16 v[40:43], v[8:11], v[240:247], v112
  ds_write_b32 v114, v32 offset:11264
  v_smfmac_f32_16x16x64_bf16 v[40:43], v[12:15], v[248:255], v112
  ds_read_b128 v[32:35], v116 offset:25152
  v_smfmac_f32_16x16x64_bf16 v[40:43], v[16:19], a[0:7], v112
  v_add_f32 v36, v36, v38
  v_smfmac_f32_16x16x64_bf16 v[40:43], v[28:31], a[24:31], v112
  v_add_f32 v37, v37, v39
  v_smfmac_f32_16x16x64_bf16 v[44:47], v[4:7], a[32:39], v112
  v_cvt_pk_bf16_f32 v36, v36, v37
  v_smfmac_f32_16x16x64_bf16 v[44:47], v[8:11], a[40:47], v112
  ds_write_b32 v114, v36 offset:11520
  v_smfmac_f32_16x16x64_bf16 v[44:47], v[12:15], a[48:55], v112
  ds_read_b128 v[36:39], v117 offset:24576
  v_smfmac_f32_16x16x64_bf16 v[44:47], v[16:19], a[56:63], v112
  v_add_f32 v40, v40, v42
  v_smfmac_f32_16x16x64_bf16 v[44:47], v[28:31], a[80:87], v112
  v_add_f32 v41, v41, v43
  v_smfmac_f32_16x16x64_bf16 v[48:51], v[4:7], a[88:95], v112
  v_cvt_pk_bf16_f32 v40, v40, v41
  v_smfmac_f32_16x16x64_bf16 v[48:51], v[8:11], a[96:103], v112
  ds_write_b32 v114, v40 offset:11776
  v_smfmac_f32_16x16x64_bf16 v[48:51], v[12:15], a[104:111], v112
  ds_read_b128 v[40:43], v116 offset:40000
  v_smfmac_f32_16x16x64_bf16 v[48:51], v[16:19], a[112:119], v112
  v_add_f32 v44, v44, v46
  v_smfmac_f32_16x16x64_bf16 v[48:51], v[28:31], a[136:143], v112
  v_add_f32 v45, v45, v47
  v_smfmac_f32_16x16x64_bf16 v[52:55], v[4:7], a[144:151], v112
  v_cvt_pk_bf16_f32 v44, v44, v45
  v_smfmac_f32_16x16x64_bf16 v[52:55], v[8:11], a[152:159], v112
  ds_write_b32 v114, v44 offset:12032
  v_smfmac_f32_16x16x64_bf16 v[52:55], v[12:15], a[160:167], v112
  ds_read_b128 v[44:47], v117 offset:39424
  v_smfmac_f32_16x16x64_bf16 v[52:55], v[16:19], a[168:175], v112
  v_add_f32 v48, v48, v50
  v_smfmac_f32_16x16x64_bf16 v[52:55], v[28:31], a[192:199], v112
  v_add_f32 v49, v49, v51
  v_smfmac_f32_16x16x64_bf16 v[56:59], v[4:7], a[200:207], v112
  v_cvt_pk_bf16_f32 v48, v48, v49
  v_smfmac_f32_16x16x64_bf16 v[56:59], v[8:11], a[208:215], v112
  ds_write_b32 v114, v48 offset:12288
  v_smfmac_f32_16x16x64_bf16 v[56:59], v[12:15], a[216:223], v112
  ds_read_b64_tr_b16 v[84:85], v113 offset:11264
  ds_read_b64_tr_b16 v[86:87], v113 offset:11392
  v_smfmac_f32_16x16x64_bf16 v[56:59], v[16:19], a[224:231], v112
  v_add_f32 v52, v52, v54
  v_smfmac_f32_16x16x64_bf16 v[56:59], v[28:31], a[248:255], v112
  v_add_f32 v53, v53, v55
  v_cvt_pk_bf16_f32 v52, v52, v53
  ds_write_b32 v114, v52 offset:12544
  s_nop 4
  v_add_f32 v56, v56, v58
  v_add_f32 v57, v57, v59
  v_cvt_pk_bf16_f32 v56, v56, v57
  ds_write_b32 v114, v56 offset:12800
  ds_read_b64_tr_b16 v[8:9], v113 offset:12288
  ds_read_b64_tr_b16 v[10:11], v113 offset:12416
  s_waitcnt lgkmcnt(4)
  v_mfma_f32_16x16x32_bf16 v[108:111], v[84:87], v[76:79], 0
  v_smfmac_f32_16x16x64_bf16 v[100:103], v[84:87], v[60:67], v112
  v_smfmac_f32_16x16x64_bf16 v[104:107], v[84:87], v[68:75], v112
  s_waitcnt lgkmcnt(0)
  v_mfma_f32_16x16x32_bf16 v[108:111], v[8:11], v[80:83], v[108:111]
  v_smfmac_f32_16x16x64_bf16 v[100:103], v[8:11], v[32:39], v112
  s_waitcnt lgkmcnt(0)
  v_smfmac_f32_16x16x64_bf16 v[104:107], v[8:11], v[40:47], v112
  s_nop 4
  v_add_f32_dpp v108, v110, v108 quad_perm:[2,3,0,1] row_mask:0xf bank_mask:0xf
  v_add_f32_dpp v109, v111, v109 quad_perm:[2,3,0,1] row_mask:0xf bank_mask:0xf
  ds_write2_b32 v0, v108, v109 offset0:64 offset1:80
  v_add_f32 v100, v100, v102
  v_add_f32 v101, v101, v103
  ds_write2_b32 v0, v100, v101 offset0:0 offset1:32
  v_add_f32 v104, v104, v106
  v_add_f32 v105, v105, v107
  ds_write2_b32 v0, v104, v105 offset0:16 offset1:48
  s_waitcnt lgkmcnt(0)
  s_barrier
  s_barrier
  s_sleep 6
  s_mov_b64 exec, s[32:33]
  s_add_u32 m0, s41, 0
  s_nop 0
  buffer_load_dwordx4 v115, s[8:11], s40 offen offset:0 lds
  s_add_u32 m0, s41, 32
  s_nop 0
  buffer_load_dwordx4 v115, s[8:11], s40 offen offset:896 lds
  s_add_u32 m0, s41, 64
  s_nop 0
  buffer_load_dwordx4 v115, s[8:11], s40 offen offset:1792 lds
  s_add_u32 m0, s41, 96
  s_nop 0
  buffer_load_dwordx4 v115, s[8:11], s40 offen offset:2688 lds
  s_add_u32 s40, s40, 3584
  s_add_u32 m0, s41, 3712
  s_nop 0
  buffer_load_dwordx4 v115, s[8:11], s40 offen offset:0 lds
  s_add_u32 m0, s41, 3744
  s_nop 0
  buffer_load_dwordx4 v115, s[8:11], s40 offen offset:896 lds
  s_add_u32 m0, s41, 3776
  s_nop 0
  buffer_load_dwordx4 v115, s[8:11], s40 offen offset:1792 lds
  s_add_u32 m0, s41, 3808
  s_nop 0
  buffer_load_dwordx4 v115, s[8:11], s40 offen offset:2688 lds
  s_mov_b64 exec, -1
  s_add_u32 s40, s40, 25088
  s_add_u32 s42, s42, 28672
  s_mov_b32 s26, s25
  s_mov_b32 s25, s50
  s_mov_b32 s50, s51
  s_mov_b32 s51, s26
  s_add_u32 s24, s24, 1
  s_cmp_lt_u32 s24, 63
  s_cbranch_scc1 Ls_loop_48
  s_endpgm
Ls_w_29:
Ls_loop_55:
  v_mov_b32 v32, 0
  v_mov_b32 v33, 0
  v_mov_b32 v34, 0
  v_mov_b32 v35, 0
  v_mov_b32 v36, 0
  v_mov_b32 v37, 0
  v_mov_b32 v38, 0
  v_mov_b32 v39, 0
  v_mov_b32 v40, 0
  v_mov_b32 v41, 0
  v_mov_b32 v42, 0
  v_mov_b32 v43, 0
  v_mov_b32 v44, 0
  v_mov_b32 v45, 0
  v_mov_b32 v46, 0
  v_mov_b32 v47, 0
  v_mov_b32 v48, 0
  v_mov_b32 v49, 0
  v_mov_b32 v50, 0
  v_mov_b32 v51, 0
  v_mov_b32 v52, 0
  v_mov_b32 v53, 0
  v_mov_b32 v54, 0
  v_mov_b32 v55, 0
  v_mov_b32 v56, 0
  v_mov_b32 v57, 0
  v_mov_b32 v58, 0
  v_mov_b32 v59, 0
  v_mov_b32 v100, 0
  v_mov_b32 v101, 0
  v_mov_b32 v102, 0
  v_mov_b32 v103, 0
  v_mov_b32 v104, 0
  v_mov_b32 v105, 0
  v_mov_b32 v106, 0
  v_mov_b32 v107, 0
  s_add_u32 s29, s24, 1
  v_lshrrev_b32 v4, 2, v115
  s_cmp_lt_u32 s29, s43
  s_cbranch_scc1 Luwd_57
  s_mov_b32 s30, 1048576
Luw_56:
  buffer_load_dword v5, v4, s[4:7], s44 offen sc1
  s_waitcnt vmcnt(0)
  v_cmp_ne_u32 vcc, 0, v5
  s_ff0_i32_b64 s43, vcc
  s_cmp_lt_u32 s29, s43
  s_cbranch_scc1 Luwd_57
  s_sleep 2
  s_sub_u32 s30, s30, 1
  s_cbranch_scc0 Luw_56
  s_branch Lk1_exit
Luwd_57:
  s_add_u32 s31, s25, 4096
  s_mov_b32 s30, 1048576
  buffer_load_dwordx4 v[76:79], v115, s[4:7], s31 offen offset:2048 sc1
  s_sleep 2
  buffer_load_dwordx4 v[80:83], v115, s[4:7], s31 offen offset:2048 sc1
Lpoll_58:
  s_waitcnt vmcnt(1)
  v_cmp_eq_u32 vcc, -1, v79
  s_cbranch_vccnz Lfail_60
  ds_write_b128 v115, v[76:79] offset:6144
  v_max3_u32 v3, v76, v77, v78
  ds_read_b64_tr_b16 v[28:29], v113 offset:6144
  v_max_u32 v3, v3, v79
  ds_read_b64_tr_b16 v[30:31], v113 offset:6272
  v_cmp_eq_u32 vcc, -1, v3
  s_cbranch_vccz Ljoin_59
Lfail_60:
  buffer_load_dwordx4 v[76:79], v115, s[4:7], s31 offen offset:2048 sc1
  s_waitcnt vmcnt(1)
  v_cmp_eq_u32 vcc, -1, v83
  s_cbranch_vccnz Lfail_61
  ds_write_b128 v115, v[80:83] offset:6144
  v_max3_u32 v3, v80, v81, v82
  ds_read_b64_tr_b16 v[28:29], v113 offset:6144
  v_max_u32 v3, v3, v83
  ds_read_b64_tr_b16 v[30:31], v113 offset:6272
  v_cmp_eq_u32 vcc, -1, v3
  s_cbranch_vccz Ljoin_59
Lfail_61:
  buffer_load_dwordx4 v[80:83], v115, s[4:7], s31 offen offset:2048 sc1
  s_sub_u32 s30, s30, 1
  s_cbranch_scc0 Lpoll_58
  s_branch Lk1_exit
Ljoin_59:
  s_waitcnt lgkmcnt(2)
  s_barrier
  s_waitcnt lgkmcnt(0)
  v_smfmac_f32_16x16x64_bf16 v[32:35], v[28:31], v[168:175], v112
  ds_read_b64_tr_b16 v[4:5], v113 offset:0
  ds_read_b64_tr_b16 v[6:7], v113 offset:128
  v_smfmac_f32_16x16x64_bf16 v[36:39], v[28:31], v[224:231], v112
  ds_read_b64_tr_b16 v[8:9], v113 offset:1024
  ds_read_b64_tr_b16 v[10:11], v113 offset:1152
  v_smfmac_f32_16x16x64_bf16 v[40:43], v[28:31], a[24:31], v112
  ds_read_b64_tr_b16 v[12:13], v113 offset:2048
  ds_read_b64_tr_b16 v[14:15], v113 offset:2176
  v_smfmac_f32_16x16x64_bf16 v[44:47], v[28:31], a[80:87], v112
  ds_read_b64_tr_b16 v[16:17], v113 offset:3072
  ds_read_b64_tr_b16 v[18:19], v113 offset:3200
  v_smfmac_f32_16x16x64_bf16 v[48:51], v[28:31], a[136:143], v112
  ds_read_b64_tr_b16 v[20:21], v113 offset:4096
  ds_read_b64_tr_b16 v[22:23], v113 offset:4224
  v_smfmac_f32_16x16x64_bf16 v[52:55], v[28:31], a[192:199], v112
  ds_read_b64_tr_b16 v[24:25], v113 offset:5120
  ds_read_b64_tr_b16 v[26:27], v113 offset:5248
  v_smfmac_f32_16x16x64_bf16 v[56:59], v[28:31], a[248:255], v112
  s_waitcnt vmcnt(0)
  ds_read_b64_tr_b16 v[76:77], v113 offset:5376
  s_waitcnt lgkmcnt(10)
  v_smfmac_f32_16x16x64_bf16 v[32:35], v[4:7], v[120:127], v112
  buffer_load_dword v95, v96, s[4:7], s42 offen sc1
  s_waitcnt lgkmcnt(8)
  v_smfmac_f32_16x16x64_bf16 v[32:35], v[8:11], v[128:135], v112
  s_mov_b64 exec, 0x3fff
  buffer_load_dword v95, v96, s[8:11], s45 offen
  s_mov_b64 exec, -1
  s_add_u32 s45, s45, 28672
  s_waitcnt lgkmcnt(6)
  v_smfmac_f32_16x16x64_bf16 v[32:35], v[12:15], v[136:143], v112
  ds_read_b64_tr_b16 v[78:79], v113 offset:5504
  s_waitcnt lgkmcnt(5)
  v_smfmac_f32_16x16x64_bf16 v[32:35], v[16:19], v[144:151], v112
  ds_read_b64_tr_b16 v[80:81], v119 offset:0
  s_waitcnt lgkmcnt(4)
  v_smfmac_f32_16x16x64_bf16 v[32:35], v[20:23], v[152:159], v112
  ds_read_b64_tr_b16 v[82:83], v119 offset:128
  s_waitcnt lgkmcnt(3)
  v_smfmac_f32_16x16x64_bf16 v[32:35], v[24:27], v[160:167], v112
  ds_read_b128 v[60:63], v116 offset:25248
  v_smfmac_f32_16x16x64_bf16 v[36:39], v[4:7], v[176:183], v112
  ds_read_b128 v[64:67], v116 offset:25312
  v_smfmac_f32_16x16x64_bf16 v[36:39], v[8:11], v[184:191], v112
  ds_read_b128 v[68:71], v116 offset:40096
  v_smfmac_f32_16x16x64_bf16 v[36:39], v[12:15], v[192:199], v112
  ds_read_b128 v[72:75], v116 offset:40160
  v_smfmac_f32_16x16x64_bf16 v[36:39], v[16:19], v[200:207], v112
  v_add_f32 v32, v32, v34
  v_smfmac_f32_16x16x64_bf16 v[36:39], v[20:23], v[208:215], v112
  v_add_f32 v33, v33, v35
  v_smfmac_f32_16x16x64_bf16 v[36:39], v[24:27], v[216:223], v112
  v_cvt_pk_bf16_f32 v32, v32, v33
  v_smfmac_f32_16x16x64_bf16 v[40:43], v[4:7], v[232:239], v112
  ds_write_b32 v114, v32 offset:13056
  v_smfmac_f32_16x16x64_bf16 v[40:43], v[8:11], v[240:247], v112
  ds_read_b128 v[32:35], v116 offset:25376
  v_smfmac_f32_16x16x64_bf16 v[40:43], v[12:15], v[248:255], v112
  v_smfmac_f32_16x16x64_bf16 v[40:43], v[16:19], a[0:7], v112
  s_nop 0
  v_add_f32 v36, v36, v38
  v_smfmac_f32_16x16x64_bf16 v[40:43], v[20:23], a[8:15], v112
  v_add_f32 v37, v37, v39
  v_smfmac_f32_16x16x64_bf16 v[40:43], v[24:27], a[16:23], v112
  v_cvt_pk_bf16_f32 v36, v36, v37
  v_smfmac_f32_16x16x64_bf16 v[44:47], v[4:7], a[32:39], v112
  ds_write_b32 v114, v36 offset:13312
  v_smfmac_f32_16x16x64_bf16 v[44:47], v[8:11], a[40:47], v112
  ds_read_b128 v[36:39], v117 offset:24576
  v_smfmac_f32_16x16x64_bf16 v[44:47], v[12:15], a[48:55], v112
  v_smfmac_f32_16x16x64_bf16 v[44:47], v[16:19], a[56:63], v112
  s_nop 0
  v_add_f32 v40, v40, v42
  v_smfmac_f32_16x16x64_bf16 v[44:47], v[20:23], a[64:71], v112
  v_add_f32 v41, v41, v43
  v_smfmac_f32_16x16x64_bf16 v[44:47], v[24:27], a[72:79], v112
  v_cvt_pk_bf16_f32 v40, v40, v41
  v_smfmac_f32_16x16x64_bf16 v[48:51], v[4:7], a[88:95], v112
  ds_write_b32 v114, v40 offset:13568
  v_smfmac_f32_16x16x64_bf16 v[48:51], v[8:11], a[96:103], v112
  ds_read_b128 v[40:43], v116 offset:40224
  v_smfmac_f32_16x16x64_bf16 v[48:51], v[12:15], a[104:111], v112
  v_smfmac_f32_16x16x64_bf16 v[48:51], v[16:19], a[112:119], v112
  s_nop 0
  v_add_f32 v44, v44, v46
  v_smfmac_f32_16x16x64_bf16 v[48:51], v[20:23], a[120:127], v112
  v_add_f32 v45, v45, v47
  v_smfmac_f32_16x16x64_bf16 v[48:51], v[24:27], a[128:135], v112
  v_cvt_pk_bf16_f32 v44, v44, v45
  v_smfmac_f32_16x16x64_bf16 v[52:55], v[4:7], a[144:151], v112
  ds_write_b32 v114, v44 offset:13824
  v_smfmac_f32_16x16x64_bf16 v[52:55], v[8:11], a[152:159], v112
  ds_read_b128 v[44:47], v117 offset:39424
  v_smfmac_f32_16x16x64_bf16 v[52:55], v[12:15], a[160:167], v112
  ds_read_b64_tr_b16 v[84:85], v113 offset:13056
  ds_read_b64_tr_b16 v[86:87], v113 offset:13184
  v_smfmac_f32_16x16x64_bf16 v[52:55], v[16:19], a[168:175], v112
  v_add_f32 v48, v48, v50
  v_smfmac_f32_16x16x64_bf16 v[52:55], v[20:23], a[176:183], v112
  v_add_f32 v49, v49, v51
  v_smfmac_f32_16x16x64_bf16 v[52:55], v[24:27], a[184:191], v112
  v_cvt_pk_bf16_f32 v48, v48, v49
  v_smfmac_f32_16x16x64_bf16 v[56:59], v[4:7], a[200:207], v112
  ds_write_b32 v114, v48 offset:14080
  v_smfmac_f32_16x16x64_bf16 v[56:59], v[8:11], a[208:215], v112
  v_smfmac_f32_16x16x64_bf16 v[56:59], v[12:15], a[216:223], v112
  v_smfmac_f32_16x16x64_bf16 v[56:59], v[16:19], a[224:231], v112
  s_nop 1
  v_add_f32 v52, v52, v54
  v_smfmac_f32_16x16x64_bf16 v[56:59], v[20:23], a[232:239], v112
  v_add_f32 v53, v53, v55
  v_smfmac_f32_16x16x64_bf16 v[56:59], v[24:27], a[240:247], v112
  v_cvt_pk_bf16_f32 v52, v52, v53
  ds_write_b32 v114, v52 offset:14336
  s_nop 5
  v_add_f32 v56, v56, v58
  v_add_f32 v57, v57, v59
  v_cvt_pk_bf16_f32 v56, v56, v57
  ds_write_b32 v114, v56 offset:14592
  ds_read_b64_tr_b16 v[8:9], v113 offset:14080
  ds_read_b64_tr_b16 v[10:11], v113 offset:14208
  s_waitcnt lgkmcnt(4)
  v_mfma_f32_16x16x32_bf16 v[108:111], v[84:87], v[76:79], 0
  v_smfmac_f32_16x16x64_bf16 v[100:103], v[84:87], v[60:67], v112
  v_smfmac_f32_16x16x64_bf16 v[104:107], v[84:87], v[68:75], v112
  s_waitcnt lgkmcnt(0)
  v_mfma_f32_16x16x32_bf16 v[108:111], v[8:11], v[80:83], v[108:111]
  v_smfmac_f32_16x16x64_bf16 v[100:103], v[8:11], v[32:39], v112
  s_waitcnt lgkmcnt(0)
  v_smfmac_f32_16x16x64_bf16 v[104:107], v[8:11], v[40:47], v112
  s_nop 4
  v_add_f32_dpp v108, v110, v108 quad_perm:[2,3,0,1] row_mask:0xf bank_mask:0xf
  v_add_f32_dpp v109, v111, v109 quad_perm:[2,3,0,1] row_mask:0xf bank_mask:0xf
  ds_write2_b32 v0, v108, v109 offset0:64 offset1:80
  v_add_f32 v100, v100, v102
  v_add_f32 v101, v101, v103
  ds_write2_b32 v0, v100, v101 offset0:0 offset1:32
  v_add_f32 v104, v104, v106
  v_add_f32 v105, v105, v107
  ds_write2_b32 v0, v104, v105 offset0:16 offset1:48
  s_waitcnt lgkmcnt(0)
  s_barrier
  s_barrier
  s_sleep 6
  s_mov_b64 exec, s[32:33]
  s_add_u32 m0, s41, 0
  s_nop 0
  buffer_load_dwordx4 v115, s[8:11], s40 offen offset:0 lds
  s_add_u32 m0, s41, 32
  s_nop 0
  buffer_load_dwordx4 v115, s[8:11], s40 offen offset:896 lds
  s_add_u32 m0, s41, 64
  s_nop 0
  buffer_load_dwordx4 v115, s[8:11], s40 offen offset:1792 lds
  s_add_u32 m0, s41, 96
  s_nop 0
  buffer_load_dwordx4 v115, s[8:11], s40 offen offset:2688 lds
  s_add_u32 s40, s40, 3584
  s_add_u32 m0, s41, 3712
  s_nop 0
  buffer_load_dwordx4 v115, s[8:11], s40 offen offset:0 lds
  s_add_u32 m0, s41, 3744
  s_nop 0
  buffer_load_dwordx4 v115, s[8:11], s40 offen offset:896 lds
  s_add_u32 m0, s41, 3776
  s_nop 0
  buffer_load_dwordx4 v115, s[8:11], s40 offen offset:1792 lds
  s_add_u32 m0, s41, 3808
  s_nop 0
  buffer_load_dwordx4 v115, s[8:11], s40 offen offset:2688 lds
  s_mov_b64 exec, -1
  s_add_u32 s40, s40, 25088
  s_add_u32 s42, s42, 28672
  s_mov_b32 s26, s25
  s_mov_b32 s25, s50
  s_mov_b32 s50, s51
  s_mov_b32 s51, s26
  s_add_u32 s24, s24, 1
  s_cmp_lt_u32 s24, 63
  s_cbranch_scc1 Ls_loop_55
  s_endpgm
Locu:
  s_sub_u32 s22, s22, 16
  v_and_b32 v1, 15, v0
  v_lshrrev_b32 v2, 4, v0
  v_lshlrev_b32 v115, 4, v0
  v_and_b32 v3, 2, v0
  v_cmp_eq_u32 vcc, 0, v3
  v_mov_b32 v112, 0xdddd
  v_mov_b32 v3, 0x8888
  v_cndmask_b32 v112, v112, v3, vcc
  v_lshlrev_b32 v113, 3, v1
  v_lshl_add_u32 v113, v2, 8, v113
  v_and_b32 v3, 2, v0
  v_cmp_eq_u32 vcc, 0, v3
  v_mov_b32 v116, 0xeeee
  v_mov_b32 v3, 0x4444
  v_cndmask_b32 v116, v116, v3, vcc
  s_add_u32 s48, s22, 16
  s_and_b32 s26, s48, 15
  s_lshl_b32 s27, s26, 4
  s_lshl_b32 s28, s20, 1
  s_add_u32 s27, s27, s28
  s_lshr_b32 s26, s26, 2
  s_lshl_b32 s26, s26, 1
  s_lshl_b32 s28, s20, 6
  s_add_u32 s26, s26, s28
  s_add_u32 s26, s26, 8
  s_cmp_lt_u32 s48, 16
  s_cselect_b32 s26, s27, s26
  s_cselect_b32 s27, 0, 16
  v_bfe_u32 v4, v0, 1, 2
  v_mul_lo_u32 v4, v4, s27
  v_and_b32 v5, 0, v0
  v_add3_u32 v4, v4, v5, s26
  v_lshlrev_b32 v4, 2, v4
  s_mov_b32 s30, 1048576
  s_mov_b32 s29, 88659968
Lgo_62:
  buffer_load_dword v5, v4, s[4:7], s29 offen sc1
  s_waitcnt vmcnt(0)
  v_cmp_ne_u32 vcc, s72, v5
  s_cbranch_vccz Lgod_63
  s_sleep 4
  s_sub_u32 s30, s30, 1
  s_cbranch_scc0 Lgo_62
  s_branch Lk1_exit
Lgod_63:
  s_mul_i32 s26, s22, 401408
  s_mul_i32 s27, s20, 100352
  s_add_u32 s26, s26, s27
  s_add_u32 s28, s26, 6422528
  s_add_u32 s27, s28, 0
  buffer_load_dwordx4 v[120:123], v115, s[4:7], s27 offen offset:0 sc1
  buffer_load_dwordx4 v[124:127], v115, s[4:7], s27 offen offset:1024 sc1
  buffer_load_dwordx4 v[128:131], v115, s[4:7], s27 offen offset:2048 sc1
  buffer_load_dwordx4 v[132:135], v115, s[4:7], s27 offen offset:3072 sc1
  s_add_u32 s27, s27, 4096
  buffer_load_dwordx4 v[136:139], v115, s[4:7], s27 offen offset:0 sc1
  buffer_load_dwordx4 v[140:143], v115, s[4:7], s27 offen offset:1024 sc1
  buffer_load_dwordx4 v[144:147], v115, s[4:7], s27 offen offset:2048 sc1
  s_add_u32 s27, s27, 10240
  buffer_load_dwordx4 v[176:179], v115, s[4:7], s27 offen offset:0 sc1
  buffer_load_dwordx4 v[180:183], v115, s[4:7], s27 offen offset:1024 sc1
  buffer_load_dwordx4 v[184:187], v115, s[4:7], s27 offen offset:2048 sc1
  buffer_load_dwordx4 v[188:191], v115, s[4:7], s27 offen offset:3072 sc1
  s_add_u32 s27, s27, 4096
  buffer_load_dwordx4 v[192:195], v115, s[4:7], s27 offen offset:0 sc1
  buffer_load_dwordx4 v[196:199], v115, s[4:7], s27 offen offset:1024 sc1
  buffer_load_dwordx4 v[200:203], v115, s[4:7], s27 offen offset:2048 sc1
  s_add_u32 s27, s27, 10240
  buffer_load_dwordx4 v[232:235], v115, s[4:7], s27 offen offset:0 sc1
  buffer_load_dwordx4 v[236:239], v115, s[4:7], s27 offen offset:1024 sc1
  buffer_load_dwordx4 v[240:243], v115, s[4:7], s27 offen offset:2048 sc1
  buffer_load_dwordx4 v[244:247], v115, s[4:7], s27 offen offset:3072 sc1
  s_add_u32 s27, s27, 4096
  buffer_load_dwordx4 v[248:251], v115, s[4:7], s27 offen offset:0 sc1
  buffer_load_dwordx4 v[252:255], v115, s[4:7], s27 offen offset:1024 sc1
  buffer_load_dwordx4 a[0:3], v115, s[4:7], s27 offen offset:2048 sc1
  s_add_u32 s27, s27, 10240
  buffer_load_dwordx4 a[32:35], v115, s[4:7], s27 offen offset:0 sc1
  buffer_load_dwordx4 a[36:39], v115, s[4:7], s27 offen offset:1024 sc1
  buffer_load_dwordx4 a[40:43], v115, s[4:7], s27 offen offset:2048 sc1
  buffer_load_dwordx4 a[44:47], v115, s[4:7], s27 offen offset:3072 sc1
  s_add_u32 s27, s27, 4096
  buffer_load_dwordx4 a[48:51], v115, s[4:7], s27 offen offset:0 sc1
  buffer_load_dwordx4 a[52:55], v115, s[4:7], s27 offen offset:1024 sc1
  buffer_load_dwordx4 a[56:59], v115, s[4:7], s27 offen offset:2048 sc1
  s_add_u32 s27, s27, 10240
  buffer_load_dwordx4 a[88:91], v115, s[4:7], s27 offen offset:0 sc1
  buffer_load_dwordx4 a[92:95], v115, s[4:7], s27 offen offset:1024 sc1
  buffer_load_dwordx4 a[96:99], v115, s[4:7], s27 offen offset:2048 sc1
  buffer_load_dwordx4 a[100:103], v115, s[4:7], s27 offen offset:3072 sc1
  s_add_u32 s27, s27, 4096
  buffer_load_dwordx4 a[104:107], v115, s[4:7], s27 offen offset:0 sc1
  buffer_load_dwordx4 a[108:111], v115, s[4:7], s27 offen offset:1024 sc1
  buffer_load_dwordx4 a[112:115], v115, s[4:7], s27 offen offset:2048 sc1
  s_add_u32 s27, s27, 10240
  buffer_load_dwordx4 a[144:147], v115, s[4:7], s27 offen offset:0 sc1
  buffer_load_dwordx4 a[148:151], v115, s[4:7], s27 offen offset:1024 sc1
  buffer_load_dwordx4 a[152:155], v115, s[4:7], s27 offen offset:2048 sc1
  buffer_load_dwordx4 a[156:159], v115, s[4:7], s27 offen offset:3072 sc1
  s_add_u32 s27, s27, 4096
  buffer_load_dwordx4 a[160:163], v115, s[4:7], s27 offen offset:0 sc1
  buffer_load_dwordx4 a[164:167], v115, s[4:7], s27 offen offset:1024 sc1
  buffer_load_dwordx4 a[168:171], v115, s[4:7], s27 offen offset:2048 sc1
  s_add_u32 s27, s27, 10240
  buffer_load_dwordx4 a[200:203], v115, s[4:7], s27 offen offset:0 sc1
  buffer_load_dwordx4 a[204:207], v115, s[4:7], s27 offen offset:1024 sc1
  buffer_load_dwordx4 a[208:211], v115, s[4:7], s27 offen offset:2048 sc1
  buffer_load_dwordx4 a[212:215], v115, s[4:7], s27 offen offset:3072 sc1
  s_add_u32 s27, s27, 4096
  buffer_load_dwordx4 a[216:219], v115, s[4:7], s27 offen offset:0 sc1
  buffer_load_dwordx4 a[220:223], v115, s[4:7], s27 offen offset:1024 sc1
  buffer_load_dwordx4 a[224:227], v115, s[4:7], s27 offen offset:2048 sc1
  s_mov_b32 s30, 1048576
  s_mov_b32 s29, 88659968
Lgo_64:
  buffer_load_dwordx4 v[8:11], v115, s[4:7], s29 offen sc1
  buffer_load_dword v12, off, s[68:71], 0 offset:64 sc1
  s_waitcnt vmcnt(0)
  v_xor_b32 v8, s72, v8
  v_xor_b32 v9, s72, v9
  v_xor_b32 v10, s72, v10
  v_xor_b32 v11, s72, v11
  v_or3_b32 v8, v8, v9, v10
  v_or_b32 v8, v8, v11
  v_cmp_ne_u32 vcc, 0, v8
  s_cbranch_vccz Lgod_65
  s_sleep 4
  s_sub_u32 s30, s30, 1
  s_cbranch_scc0 Lgo_64
  s_branch Lk1_exit
Lgod_65:
  v_readfirstlane_b32 s27, v12
  s_nop 0
  s_cmp_lg_u32 s27, s79
  s_cbranch_scc1 Lfallback
  s_add_u32 s27, s28, 7168
  buffer_load_dwordx4 v[148:151], v115, s[4:7], s27 offen offset:0 sc1
  buffer_load_dwordx4 v[152:155], v115, s[4:7], s27 offen offset:1024 sc1
  buffer_load_dwordx4 v[156:159], v115, s[4:7], s27 offen offset:2048 sc1
  buffer_load_dwordx4 v[160:163], v115, s[4:7], s27 offen offset:3072 sc1
  s_add_u32 s27, s27, 4096
  buffer_load_dwordx4 v[164:167], v115, s[4:7], s27 offen offset:0 sc1
  buffer_load_dwordx4 v[168:171], v115, s[4:7], s27 offen offset:1024 sc1
  buffer_load_dwordx4 v[172:175], v115, s[4:7], s27 offen offset:2048 sc1
  s_add_u32 s27, s27, 10240
  buffer_load_dwordx4 v[204:207], v115, s[4:7], s27 offen offset:0 sc1
  buffer_load_dwordx4 v[208:211], v115, s[4:7], s27 offen offset:1024 sc1
  buffer_load_dwordx4 v[212:215], v115, s[4:7], s27 offen offset:2048 sc1
  buffer_load_dwordx4 v[216:219], v115, s[4:7], s27 offen offset:3072 sc1
  s_add_u32 s27, s27, 4096
  buffer_load_dwordx4 v[220:223], v115, s[4:7], s27 offen offset:0 sc1
  buffer_load_dwordx4 v[224:227], v115, s[4:7], s27 offen offset:1024 sc1
  buffer_load_dwordx4 v[228:231], v115, s[4:7], s27 offen offset:2048 sc1
  s_add_u32 s27, s27, 10240
  buffer_load_dwordx4 a[4:7], v115, s[4:7], s27 offen offset:0 sc1
  buffer_load_dwordx4 a[8:11], v115, s[4:7], s27 offen offset:1024 sc1
  buffer_load_dwordx4 a[12:15], v115, s[4:7], s27 offen offset:2048 sc1
  buffer_load_dwordx4 a[16:19], v115, s[4:7], s27 offen offset:3072 sc1
  s_add_u32 s27, s27, 4096
  buffer_load_dwordx4 a[20:23], v115, s[4:7], s27 offen offset:0 sc1
  buffer_load_dwordx4 a[24:27], v115, s[4:7], s27 offen offset:1024 sc1
  buffer_load_dwordx4 a[28:31], v115, s[4:7], s27 offen offset:2048 sc1
  s_add_u32 s27, s27, 10240
  buffer_load_dwordx4 a[60:63], v115, s[4:7], s27 offen offset:0 sc1
  buffer_load_dwordx4 a[64:67], v115, s[4:7], s27 offen offset:1024 sc1
  buffer_load_dwordx4 a[68:71], v115, s[4:7], s27 offen offset:2048 sc1
  buffer_load_dwordx4 a[72:75], v115, s[4:7], s27 offen offset:3072 sc1
  s_add_u32 s27, s27, 4096
  buffer_load_dwordx4 a[76:79], v115, s[4:7], s27 offen offset:0 sc1
  buffer_load_dwordx4 a[80:83], v115, s[4:7], s27 offen offset:1024 sc1
  buffer_load_dwordx4 a[84:87], v115, s[4:7], s27 offen offset:2048 sc1
  s_add_u32 s27, s27, 10240
  buffer_load_dwordx4 a[116:119], v115, s[4:7], s27 offen offset:0 sc1
  buffer_load_dwordx4 a[120:123], v115, s[4:7], s27 offen offset:1024 sc1
  buffer_load_dwordx4 a[124:127], v115, s[4:7], s27 offen offset:2048 sc1
  buffer_load_dwordx4 a[128:131], v115, s[4:7], s27 offen offset:3072 sc1
  s_add_u32 s27, s27, 4096
  buffer_load_dwordx4 a[132:135], v115, s[4:7], s27 offen offset:0 sc1
  buffer_load_dwordx4 a[136:139], v115, s[4:7], s27 offen offset:1024 sc1
  buffer_load_dwordx4 a[140:143], v115, s[4:7], s27 offen offset:2048 sc1
  s_add_u32 s27, s27, 10240
  buffer_load_dwordx4 a[172:175], v115, s[4:7], s27 offen offset:0 sc1
  buffer_load_dwordx4 a[176:179], v115, s[4:7], s27 offen offset:1024 sc1
  buffer_load_dwordx4 a[180:183], v115, s[4:7], s27 offen offset:2048 sc1
  buffer_load_dwordx4 a[184:187], v115, s[4:7], s27 offen offset:3072 sc1
  s_add_u32 s27, s27, 4096
  buffer_load_dwordx4 a[188:191], v115, s[4:7], s27 offen offset:0 sc1
  buffer_load_dwordx4 a[192:195], v115, s[4:7], s27 offen offset:1024 sc1
  buffer_load_dwordx4 a[196:199], v115, s[4:7], s27 offen offset:2048 sc1
  s_add_u32 s27, s27, 10240
  buffer_load_dwordx4 a[228:231], v115, s[4:7], s27 offen offset:0 sc1
  buffer_load_dwordx4 a[232:235], v115, s[4:7], s27 offen offset:1024 sc1
  buffer_load_dwordx4 a[236:239], v115, s[4:7], s27 offen offset:2048 sc1
  buffer_load_dwordx4 a[240:243], v115, s[4:7], s27 offen offset:3072 sc1
  s_add_u32 s27, s27, 4096
  buffer_load_dwordx4 a[244:247], v115, s[4:7], s27 offen offset:0 sc1
  buffer_load_dwordx4 a[248:251], v115, s[4:7], s27 offen offset:1024 sc1
  buffer_load_dwordx4 a[252:255], v115, s[4:7], s27 offen offset:2048 sc1
  v_lshlrev_b32 v4, 4, v1
  v_lshl_add_u32 v114, v2, 2, v4
  v_mul_u32_u24 v4, 28, v2
  v_add_u32 v4, v4, v1
  v_lshlrev_b32 v106, 4, v4
  v_mov_b32 v5, 0x40000000
  v_cmp_gt_u32 vcc, 14, v1
  s_nop 1
  v_cndmask_b32 v105, v5, v106, vcc
  s_mul_i32 s26, s20, 224
  s_mul_i32 s27, s22, 448
  s_add_u32 s26, s26, s27
  v_lshrrev_b32 v4, 1, v1
  v_lshlrev_b32 v4, 5, v4
  v_lshl_add_u32 v4, v2, 3, v4
  v_and_b32 v6, 1, v1
  v_lshl_add_u32 v4, v6, 2, v4
  v_add_u32 v4, s26, v4
  v_cndmask_b32 v107, v5, v4, vcc
  v_lshlrev_b32 v6, 7, v0
  s_mul_i32 s26, s22, 1792
  v_add_u32 v4, s26, v6
  v_cmp_gt_u32 vcc, 14, v0
  s_nop 1
  v_cndmask_b32 v119, v5, v4, vcc
  v_add_u32 v4, s27, v115
  v_cmp_gt_u32 vcc, 28, v0
  s_nop 1
  v_cndmask_b32 v118, v5, v4, vcc
  v_lshlrev_b32 v117, 3, v0
  v_mov_b32 v0, -1
  s_mov_b32 s24, 0
  s_mov_b32 s25, 72024064
  s_mov_b32 s50, 72042496
  s_mov_b32 s51, 72060928
  s_mul_i32 s42, s22, 1835008
  s_mul_i32 s26, s20, 7168
  s_add_u32 s42, s42, s26
  s_add_u32 s42, s42, 42205184
  s_lshl_b32 s46, s22, 8
  s_add_u32 s46, s46, 72538112
  s_mov_b32 s48, 72079360
  s_mov_b32 s49, 28672
  s_mov_b32 s43, 0
  v_lshrrev_b32 v6, 2, v115
  buffer_load_dword v7, v6, s[4:7], s46 offen sc1
  s_lshl_b32 s26, s20, 13
  s_add_u32 s26, s26, 72046592
  v_lshlrev_b32 v8, 3, v115
  buffer_load_dword v9, v8, s[4:7], s26 offen sc1
  s_waitcnt vmcnt(0)
  v_cmp_ne_u32 vcc, 0, v7
  s_ff0_i32_b64 s43, vcc
  s_cmp_lt_u32 s24, s43
  s_cbranch_scc1 Luwd_67
  s_mov_b32 s30, 1048576
Luw_66:
  buffer_load_dword v7, v6, s[4:7], s46 offen sc1
  s_waitcnt vmcnt(0)
  v_cmp_ne_u32 vcc, 0, v7
  s_ff0_i32_b64 s43, vcc
  s_cmp_lt_u32 s24, s43
  s_cbranch_scc1 Luwd_67
  s_sleep 2
  s_sub_u32 s30, s30, 1
  s_cbranch_scc0 Luw_66
  s_branch Lk1_exit
Luwd_67:
  s_mov_b32 exec_hi, 0xffffff
  buffer_load_dword v9, v8, s[4:7], s42 offen sc1
  s_mov_b32 exec_hi, -1
  s_waitcnt vmcnt(0)
  s_cmp_eq_u32 s20, 1
  s_cbranch_scc1 Lo_w_69
  s_cmp_eq_u32 s20, 2
  s_cbranch_scc1 Lo_w_70
  s_cmp_eq_u32 s20, 3
  s_cbranch_scc1 Lo_w_71
Lo_w_68:
Lo_loop_72:
  v_mov_b32 v32, 0
  v_mov_b32 v33, 0
  v_mov_b32 v34, 0
  v_mov_b32 v35, 0
  v_mov_b32 v36, 0
  v_mov_b32 v37, 0
  v_mov_b32 v38, 0
  v_mov_b32 v39, 0
  v_mov_b32 v40, 0
  v_mov_b32 v41, 0
  v_mov_b32 v42, 0
  v_mov_b32 v43, 0
  v_mov_b32 v44, 0
  v_mov_b32 v45, 0
  v_mov_b32 v46, 0
  v_mov_b32 v47, 0
  v_mov_b32 v48, 0
  v_mov_b32 v49, 0
  v_mov_b32 v50, 0
  v_mov_b32 v51, 0
  v_mov_b32 v52, 0
  v_mov_b32 v53, 0
  v_mov_b32 v54, 0
  v_mov_b32 v55, 0
  v_mov_b32 v56, 0
  v_mov_b32 v57, 0
  v_mov_b32 v58, 0
  v_mov_b32 v59, 0
  v_lshrrev_b32 v4, 2, v115
  s_add_u32 s29, s24, 1
  s_cmp_lt_u32 s24, s43
  s_cbranch_scc1 Luwd_74
  s_mov_b32 s30, 1048576
Luw_73:
  buffer_load_dword v5, v4, s[4:7], s46 offen sc1
  s_waitcnt vmcnt(0)
  v_cmp_ne_u32 vcc, 0, v5
  s_ff0_i32_b64 s43, vcc
  s_cmp_lt_u32 s24, s43
  s_cbranch_scc1 Luwd_74
  s_sleep 2
  s_sub_u32 s30, s30, 1
  s_cbranch_scc0 Luw_73
  s_branch Lk1_exit
Luwd_74:
  s_add_u32 s28, s42, 3584
  s_mov_b32 s30, 1048576
  buffer_load_dwordx4 v[92:95], v115, s[4:7], s25 offen offset:0 sc1
  buffer_load_dwordx4 v[96:99], v115, s[4:7], s25 offen offset:1024 sc1
Lpoll_75:
  s_waitcnt vmcnt(0)
  v_max_u32 v3, v95, v99
  v_cmp_eq_u32 vcc, -1, v3
  s_cbranch_vccnz Lfail_77
  ds_write_b128 v115, v[92:95] offset:0
  v_max3_u32 v3, v92, v93, v94
  ds_write_b128 v115, v[96:99] offset:1024
  v_max3_u32 v3, v3, v95, v96
  ds_read_b64_tr_b16 v[4:5], v113 offset:0
  v_max3_u32 v3, v3, v97, v98
  ds_read_b64_tr_b16 v[6:7], v113 offset:128
  v_max_u32 v3, v3, v99
  ds_read_b64_tr_b16 v[8:9], v113 offset:1024
  v_cmp_eq_u32 vcc, -1, v3
  ds_read_b64_tr_b16 v[10:11], v113 offset:1152
  s_cbranch_vccz Ljoin_76
Lfail_77:
  buffer_load_dwordx4 v[92:95], v115, s[4:7], s25 offen offset:0 sc1
  buffer_load_dwordx4 v[96:99], v115, s[4:7], s25 offen offset:1024 sc1
  s_sub_u32 s30, s30, 1
  s_cbranch_scc0 Lpoll_75
  s_branch Lk1_exit
Ljoin_76:
  s_waitcnt lgkmcnt(4)
  s_barrier
  s_waitcnt lgkmcnt(0)
  v_smfmac_f32_16x16x64_bf16 v[32:35], v[4:7], v[120:127], v112
  ds_read_b64_tr_b16 v[12:13], v113 offset:2048
  buffer_load_dwordx4 v[60:63], v105, s[4:7], s42 offen offset:0 sc1
  v_smfmac_f32_16x16x64_bf16 v[36:39], v[4:7], v[176:183], v112
  ds_read_b64_tr_b16 v[14:15], v113 offset:2176
  v_smfmac_f32_16x16x64_bf16 v[40:43], v[4:7], v[232:239], v112
  ds_read_b64_tr_b16 v[16:17], v113 offset:3072
  v_smfmac_f32_16x16x64_bf16 v[44:47], v[4:7], a[32:39], v112
  ds_read_b64_tr_b16 v[18:19], v113 offset:3200
  buffer_load_dwordx4 v[64:67], v105, s[4:7], s42 offen offset:1792 sc1
  v_smfmac_f32_16x16x64_bf16 v[48:51], v[4:7], a[88:95], v112
  ds_read_b64_tr_b16 v[20:21], v113 offset:4096
  v_smfmac_f32_16x16x64_bf16 v[52:55], v[4:7], a[144:151], v112
  ds_read_b64_tr_b16 v[22:23], v113 offset:4224
  v_smfmac_f32_16x16x64_bf16 v[56:59], v[4:7], a[200:207], v112
  ds_read_b64_tr_b16 v[24:25], v113 offset:5120
  buffer_load_dwordx4 v[68:71], v105, s[4:7], s42 offen offset:224 sc1
  v_smfmac_f32_16x16x64_bf16 v[32:35], v[8:11], v[128:135], v112
  ds_read_b64_tr_b16 v[26:27], v113 offset:5248
  v_smfmac_f32_16x16x64_bf16 v[36:39], v[8:11], v[184:191], v112
  ds_read_b64_tr_b16 v[28:29], v113 offset:6144
  v_smfmac_f32_16x16x64_bf16 v[40:43], v[8:11], v[240:247], v112
  ds_read_b64_tr_b16 v[30:31], v113 offset:6272
  buffer_load_dwordx4 v[72:75], v105, s[4:7], s42 offen offset:2016 sc1
  v_smfmac_f32_16x16x64_bf16 v[44:47], v[8:11], a[40:47], v112
  v_smfmac_f32_16x16x64_bf16 v[48:51], v[8:11], a[96:103], v112
  v_smfmac_f32_16x16x64_bf16 v[52:55], v[8:11], a[152:159], v112
  buffer_load_dwordx4 v[76:79], v105, s[4:7], s28 offen offset:0 sc1
  v_smfmac_f32_16x16x64_bf16 v[56:59], v[8:11], a[208:215], v112
  s_waitcnt lgkmcnt(8)
  v_smfmac_f32_16x16x64_bf16 v[32:35], v[12:15], v[136:143], v112
  s_waitcnt lgkmcnt(6)
  v_smfmac_f32_16x16x64_bf16 v[32:35], v[16:19], v[144:151], v112
  buffer_load_dwordx4 v[80:83], v105, s[4:7], s28 offen offset:1792 sc1
  s_waitcnt lgkmcnt(4)
  v_smfmac_f32_16x16x64_bf16 v[32:35], v[20:23], v[152:159], v112
  s_waitcnt lgkmcnt(2)
  v_smfmac_f32_16x16x64_bf16 v[32:35], v[24:27], v[160:167], v112
  s_waitcnt lgkmcnt(0)
  v_smfmac_f32_16x16x64_bf16 v[32:35], v[28:31], v[168:175], v112
  buffer_load_dwordx4 v[84:87], v105, s[4:7], s28 offen offset:224 sc1
  v_smfmac_f32_16x16x64_bf16 v[36:39], v[12:15], v[192:199], v112
  v_smfmac_f32_16x16x64_bf16 v[36:39], v[16:19], v[200:207], v112
  v_smfmac_f32_16x16x64_bf16 v[36:39], v[20:23], v[208:215], v112
  buffer_load_dwordx4 v[88:91], v105, s[4:7], s28 offen offset:2016 sc1
  v_smfmac_f32_16x16x64_bf16 v[36:39], v[24:27], v[216:223], v112
  s_nop 1
  v_add_f32 v32, v32, v34
  v_smfmac_f32_16x16x64_bf16 v[36:39], v[28:31], v[224:231], v112
  v_add_f32 v33, v33, v35
  v_smfmac_f32_16x16x64_bf16 v[40:43], v[12:15], v[248:255], v112
  v_cvt_pk_bf16_f32 v32, v32, v33
  buffer_store_dword v0, v107, s[4:7], s51 offen
  v_smfmac_f32_16x16x64_bf16 v[40:43], v[16:19], a[0:7], v112
  ds_write_b32 v114, v32 offset:7680
  v_smfmac_f32_16x16x64_bf16 v[40:43], v[20:23], a[8:15], v112
  v_smfmac_f32_16x16x64_bf16 v[40:43], v[24:27], a[16:23], v112
  v_add_f32 v36, v36, v38
  v_smfmac_f32_16x16x64_bf16 v[40:43], v[28:31], a[24:31], v112
  v_add_f32 v37, v37, v39
  v_smfmac_f32_16x16x64_bf16 v[44:47], v[12:15], a[48:55], v112
  v_cvt_pk_bf16_f32 v36, v36, v37
  v_smfmac_f32_16x16x64_bf16 v[44:47], v[16:19], a[56:63], v112
  ds_write_b32 v114, v36 offset:7936
  v_smfmac_f32_16x16x64_bf16 v[44:47], v[20:23], a[64:71], v112
  v_smfmac_f32_16x16x64_bf16 v[44:47], v[24:27], a[72:79], v112
  s_nop 0
  v_add_f32 v40, v40, v42
  v_smfmac_f32_16x16x64_bf16 v[44:47], v[28:31], a[80:87], v112
  v_add_f32 v41, v41, v43
  v_smfmac_f32_16x16x64_bf16 v[48:51], v[12:15], a[104:111], v112
  v_cvt_pk_bf16_f32 v40, v40, v41
  v_smfmac_f32_16x16x64_bf16 v[48:51], v[16:19], a[112:119], v112
  ds_write_b32 v114, v40 offset:8192
  v_smfmac_f32_16x16x64_bf16 v[48:51], v[20:23], a[120:127], v112
  v_smfmac_f32_16x16x64_bf16 v[48:51], v[24:27], a[128:135], v112
  s_nop 0
  v_add_f32 v44, v44, v46
  v_smfmac_f32_16x16x64_bf16 v[48:51], v[28:31], a[136:143], v112
  v_add_f32 v45, v45, v47
  v_smfmac_f32_16x16x64_bf16 v[52:55], v[12:15], a[160:167], v112
  v_cvt_pk_bf16_f32 v44, v44, v45
  v_smfmac_f32_16x16x64_bf16 v[52:55], v[16:19], a[168:175], v112
  ds_write_b32 v114, v44 offset:8448
  v_smfmac_f32_16x16x64_bf16 v[52:55], v[20:23], a[176:183], v112
  v_smfmac_f32_16x16x64_bf16 v[52:55], v[24:27], a[184:191], v112
  s_nop 0
  v_add_f32 v48, v48, v50
  v_smfmac_f32_16x16x64_bf16 v[52:55], v[28:31], a[192:199], v112
  v_add_f32 v49, v49, v51
  v_smfmac_f32_16x16x64_bf16 v[56:59], v[12:15], a[216:223], v112
  v_cvt_pk_bf16_f32 v48, v48, v49
  v_smfmac_f32_16x16x64_bf16 v[56:59], v[16:19], a[224:231], v112
  ds_write_b32 v114, v48 offset:8704
  v_smfmac_f32_16x16x64_bf16 v[56:59], v[20:23], a[232:239], v112
  v_smfmac_f32_16x16x64_bf16 v[56:59], v[24:27], a[240:247], v112
  s_nop 0
  v_add_f32 v52, v52, v54
  v_smfmac_f32_16x16x64_bf16 v[56:59], v[28:31], a[248:255], v112
  v_add_f32 v53, v53, v55
  v_cvt_pk_bf16_f32 v52, v52, v53
  ds_write_b32 v114, v52 offset:8960
  s_nop 4
  v_add_f32 v56, v56, v58
  v_add_f32 v57, v57, v59
  v_cvt_pk_bf16_f32 v56, v56, v57
  ds_write_b32 v114, v56 offset:9216
  s_add_u32 s42, s42, 28672
  s_waitcnt lgkmcnt(0)
  s_barrier
  v_mov_b32 v44, 0
  v_mov_b32 v45, 0
  v_mov_b32 v46, 0
  v_mov_b32 v47, 0
  v_mov_b32 v48, 0
  v_mov_b32 v49, 0
  v_mov_b32 v50, 0
  v_mov_b32 v51, 0
  s_add_u32 s31, s25, 8192
  s_waitcnt lgkmcnt(0)
  s_mov_b32 s30, 1048576
  buffer_load_dwordx4 v[4:7], v115, s[4:7], s31 offen offset:0 sc1
  buffer_load_dwordx4 v[8:11], v115, s[4:7], s31 offen offset:1024 sc1
  s_sleep 2
  buffer_load_dwordx4 v[12:15], v115, s[4:7], s31 offen offset:0 sc1
  buffer_load_dwordx4 v[16:19], v115, s[4:7], s31 offen offset:1024 sc1
Lpoll_78:
  s_waitcnt vmcnt(2)
  v_max_u32 v3, v7, v11
  v_cmp_eq_u32 vcc, -1, v3
  s_cbranch_vccnz Lfail_80
  v_smfmac_f32_16x16x64_bf16 v[44:47], v[4:7], v[60:67], v116
  v_max3_u32 v3, v4, v5, v6
  v_smfmac_f32_16x16x64_bf16 v[44:47], v[8:11], v[76:83], v116
  v_max3_u32 v3, v3, v8, v9
  v_smfmac_f32_16x16x64_bf16 v[48:51], v[4:7], v[68:75], v116
  v_max_u32 v3, v3, v10
  v_smfmac_f32_16x16x64_bf16 v[48:51], v[8:11], v[84:91], v116
  v_cmp_eq_u32 vcc, -1, v3
  s_cbranch_vccz Ljoin_79
  s_nop 1
  v_mov_b32 v44, 0
  v_mov_b32 v45, 0
  v_mov_b32 v46, 0
  v_mov_b32 v47, 0
  v_mov_b32 v48, 0
  v_mov_b32 v49, 0
  v_mov_b32 v50, 0
  v_mov_b32 v51, 0
Lfail_80:
  buffer_load_dwordx4 v[4:7], v115, s[4:7], s31 offen offset:0 sc1
  buffer_load_dwordx4 v[8:11], v115, s[4:7], s31 offen offset:1024 sc1
  s_waitcnt vmcnt(2)
  v_max_u32 v3, v15, v19
  v_cmp_eq_u32 vcc, -1, v3
  s_cbranch_vccnz Lfail_81
  v_smfmac_f32_16x16x64_bf16 v[44:47], v[12:15], v[60:67], v116
  v_max3_u32 v3, v12, v13, v14
  v_smfmac_f32_16x16x64_bf16 v[44:47], v[16:19], v[76:83], v116
  v_max3_u32 v3, v3, v16, v17
  v_smfmac_f32_16x16x64_bf16 v[48:51], v[12:15], v[68:75], v116
  v_max_u32 v3, v3, v18
  v_smfmac_f32_16x16x64_bf16 v[48:51], v[16:19], v[84:91], v116
  v_cmp_eq_u32 vcc, -1, v3
  s_cbranch_vccz Ljoin_79
  s_nop 1
  v_mov_b32 v44, 0
  v_mov_b32 v45, 0
  v_mov_b32 v46, 0
  v_mov_b32 v47, 0
  v_mov_b32 v48, 0
  v_mov_b32 v49, 0
  v_mov_b32 v50, 0
  v_mov_b32 v51, 0
Lfail_81:
  buffer_load_dwordx4 v[12:15], v115, s[4:7], s31 offen offset:0 sc1
  buffer_load_dwordx4 v[16:19], v115, s[4:7], s31 offen offset:1024 sc1
  s_sub_u32 s30, s30, 1
  s_cbranch_scc0 Lpoll_78
  s_branch Lk1_exit
Ljoin_79:
  s_nop 1
  v_add_f32 v44, v44, v46
  v_add_f32 v45, v45, v47
  ds_write_b64 v117, v[44:45] offset:15360
  s_nop 0
  v_add_f32 v48, v48, v50
  v_add_f32 v49, v49, v51
  ds_write_b64 v117, v[48:49] offset:15872
  s_waitcnt lgkmcnt(0)
  s_barrier
  ds_read_b64 v[52:53], v117 offset:15360
  ds_read_b64 v[54:55], v117 offset:16384
  ds_read_b64 v[56:57], v117 offset:17408
  ds_read_b64 v[58:59], v117 offset:18432
  s_waitcnt lgkmcnt(2)
  v_pk_add_f32 v[52:53], v[52:53], v[54:55]
  s_waitcnt lgkmcnt(0)
  v_pk_add_f32 v[56:57], v[56:57], v[58:59]
  v_pk_add_f32 v[52:53], v[52:53], v[56:57]
  v_cvt_pk_bf16_f32 v52, v52, v53
  v_min_u32 v52, -2, v52
  buffer_store_dword v52, v107, s[4:7], s50 offen
  s_waitcnt vmcnt(1)
  s_add_u32 s48, s48, 7168
  s_mov_b32 s26, s25
  s_mov_b32 s25, s50
  s_mov_b32 s50, s51
  s_mov_b32 s51, s26
  s_add_u32 s24, s24, 1
  s_cmp_lt_u32 s24, 63
  s_cbranch_scc1 Lo_loop_72
  v_mov_b32_dpp v53, v52 quad_perm:[1,1,3,3] row_mask:0xf bank_mask:0xf
  s_mov_b32 exec_lo, 0x55555555
  s_mov_b32 exec_hi, 0x55555555
  buffer_store_dwordx2 v[52:53], v107, s[4:7], s48 offen sc1
  s_mov_b64 exec, -1
  s_endpgm
Lo_w_69:
Lo_loop_82:
  v_mov_b32 v32, 0
  v_mov_b32 v33, 0
  v_mov_b32 v34, 0
  v_mov_b32 v35, 0
  v_mov_b32 v36, 0
  v_mov_b32 v37, 0
  v_mov_b32 v38, 0
  v_mov_b32 v39, 0
  v_mov_b32 v40, 0
  v_mov_b32 v41, 0
  v_mov_b32 v42, 0
  v_mov_b32 v43, 0
  v_mov_b32 v44, 0
  v_mov_b32 v45, 0
  v_mov_b32 v46, 0
  v_mov_b32 v47, 0
  v_mov_b32 v48, 0
  v_mov_b32 v49, 0
  v_mov_b32 v50, 0
  v_mov_b32 v51, 0
  v_mov_b32 v52, 0
  v_mov_b32 v53, 0
  v_mov_b32 v54, 0
  v_mov_b32 v55, 0
  v_mov_b32 v56, 0
  v_mov_b32 v57, 0
  v_mov_b32 v58, 0
  v_mov_b32 v59, 0
  v_lshrrev_b32 v4, 2, v115
  s_add_u32 s29, s24, 1
  s_cmp_lt_u32 s24, s43
  s_cbranch_scc1 Luwd_84
  s_mov_b32 s30, 1048576
Luw_83:
  buffer_load_dword v5, v4, s[4:7], s46 offen sc1
  s_waitcnt vmcnt(0)
  v_cmp_ne_u32 vcc, 0, v5
  s_ff0_i32_b64 s43, vcc
  s_cmp_lt_u32 s24, s43
  s_cbranch_scc1 Luwd_84
  s_sleep 2
  s_sub_u32 s30, s30, 1
  s_cbranch_scc0 Luw_83
  s_branch Lk1_exit
Luwd_84:
  s_add_u32 s28, s42, 3584
  s_mov_b32 s30, 1048576
  buffer_load_dwordx4 v[92:95], v115, s[4:7], s25 offen offset:2048 sc1
  buffer_load_dwordx4 v[96:99], v115, s[4:7], s25 offen offset:3072 sc1
Lpoll_85:
  s_waitcnt vmcnt(0)
  v_max_u32 v3, v95, v99
  v_cmp_eq_u32 vcc, -1, v3
  s_cbranch_vccnz Lfail_87
  ds_write_b128 v115, v[92:95] offset:2048
  v_max3_u32 v3, v92, v93, v94
  ds_write_b128 v115, v[96:99] offset:3072
  v_max3_u32 v3, v3, v95, v96
  ds_read_b64_tr_b16 v[12:13], v113 offset:2048
  v_max3_u32 v3, v3, v97, v98
  ds_read_b64_tr_b16 v[14:15], v113 offset:2176
  v_max_u32 v3, v3, v99
  ds_read_b64_tr_b16 v[16:17], v113 offset:3072
  v_cmp_eq_u32 vcc, -1, v3
  ds_read_b64_tr_b16 v[18:19], v113 offset:3200
  s_cbranch_vccz Ljoin_86
Lfail_87:
  buffer_load_dwordx4 v[92:95], v115, s[4:7], s25 offen offset:2048 sc1
  buffer_load_dwordx4 v[96:99], v115, s[4:7], s25 offen offset:3072 sc1
  s_sub_u32 s30, s30, 1
  s_cbranch_scc0 Lpoll_85
  s_branch Lk1_exit
Ljoin_86:
  s_waitcnt lgkmcnt(4)
  s_barrier
  s_waitcnt lgkmcnt(0)
  v_smfmac_f32_16x16x64_bf16 v[32:35], v[12:15], v[136:143], v112
  ds_read_b64_tr_b16 v[4:5], v113 offset:0
  v_smfmac_f32_16x16x64_bf16 v[36:39], v[12:15], v[192:199], v112
  ds_read_b64_tr_b16 v[6:7], v113 offset:128
  buffer_load_dwordx4 v[60:63], v105, s[4:7], s42 offen offset:0 sc1
  v_smfmac_f32_16x16x64_bf16 v[40:43], v[12:15], v[248:255], v112
  ds_read_b64_tr_b16 v[8:9], v113 offset:1024
  v_smfmac_f32_16x16x64_bf16 v[44:47], v[12:15], a[48:55], v112
  ds_read_b64_tr_b16 v[10:11], v113 offset:1152
  v_smfmac_f32_16x16x64_bf16 v[48:51], v[12:15], a[104:111], v112
  ds_read_b64_tr_b16 v[20:21], v113 offset:4096
  buffer_load_dwordx4 v[64:67], v105, s[4:7], s42 offen offset:1792 sc1
  v_smfmac_f32_16x16x64_bf16 v[52:55], v[12:15], a[160:167], v112
  ds_read_b64_tr_b16 v[22:23], v113 offset:4224
  v_smfmac_f32_16x16x64_bf16 v[56:59], v[12:15], a[216:223], v112
  ds_read_b64_tr_b16 v[24:25], v113 offset:5120
  v_smfmac_f32_16x16x64_bf16 v[32:35], v[16:19], v[144:151], v112
  ds_read_b64_tr_b16 v[26:27], v113 offset:5248
  buffer_load_dwordx4 v[68:71], v105, s[4:7], s42 offen offset:224 sc1
  v_smfmac_f32_16x16x64_bf16 v[36:39], v[16:19], v[200:207], v112
  ds_read_b64_tr_b16 v[28:29], v113 offset:6144
  v_smfmac_f32_16x16x64_bf16 v[40:43], v[16:19], a[0:7], v112
  ds_read_b64_tr_b16 v[30:31], v113 offset:6272
  v_smfmac_f32_16x16x64_bf16 v[44:47], v[16:19], a[56:63], v112
  buffer_load_dwordx4 v[72:75], v105, s[4:7], s42 offen offset:2016 sc1
  v_smfmac_f32_16x16x64_bf16 v[48:51], v[16:19], a[112:119], v112
  v_smfmac_f32_16x16x64_bf16 v[52:55], v[16:19], a[168:175], v112
  v_smfmac_f32_16x16x64_bf16 v[56:59], v[16:19], a[224:231], v112
  buffer_load_dwordx4 v[76:79], v105, s[4:7], s28 offen offset:0 sc1
  s_waitcnt lgkmcnt(8)
  v_smfmac_f32_16x16x64_bf16 v[32:35], v[4:7], v[120:127], v112
  s_waitcnt lgkmcnt(6)
  v_smfmac_f32_16x16x64_bf16 v[32:35], v[8:11], v[128:135], v112
  s_waitcnt lgkmcnt(4)
  v_smfmac_f32_16x16x64_bf16 v[32:35], v[20:23], v[152:159], v112
  buffer_load_dwordx4 v[80:83], v105, s[4:7], s28 offen offset:1792 sc1
  s_waitcnt lgkmcnt(2)
  v_smfmac_f32_16x16x64_bf16 v[32:35], v[24:27], v[160:167], v112
  s_waitcnt lgkmcnt(0)
  v_smfmac_f32_16x16x64_bf16 v[32:35], v[28:31], v[168:175], v112
  v_smfmac_f32_16x16x64_bf16 v[36:39], v[4:7], v[176:183], v112
  buffer_load_dwordx4 v[84:87], v105, s[4:7], s28 offen offset:224 sc1
  v_smfmac_f32_16x16x64_bf16 v[36:39], v[8:11], v[184:191], v112
  v_smfmac_f32_16x16x64_bf16 v[36:39], v[20:23], v[208:215], v112
  v_smfmac_f32_16x16x64_bf16 v[36:39], v[24:27], v[216:223], v112
  s_nop 2
  v_add_f32 v32, v32, v34
  buffer_load_dwordx4 v[88:91], v105, s[4:7], s28 offen offset:2016 sc1
  v_smfmac_f32_16x16x64_bf16 v[36:39], v[28:31], v[224:231], v112
  v_add_f32 v33, v33, v35
  v_smfmac_f32_16x16x64_bf16 v[40:43], v[4:7], v[232:239], v112
  v_cvt_pk_bf16_f32 v32, v32, v33
  v_smfmac_f32_16x16x64_bf16 v[40:43], v[8:11], v[240:247], v112
  ds_write_b32 v114, v32 offset:9472
  buffer_store_dword v0, v107, s[4:7], s51 offen
  v_smfmac_f32_16x16x64_bf16 v[40:43], v[20:23], a[8:15], v112
  v_smfmac_f32_16x16x64_bf16 v[40:43], v[24:27], a[16:23], v112
  v_add_f32 v36, v36, v38
  v_smfmac_f32_16x16x64_bf16 v[40:43], v[28:31], a[24:31], v112
  v_add_f32 v37, v37, v39
  v_smfmac_f32_16x16x64_bf16 v[44:47], v[4:7], a[32:39], v112
  v_cvt_pk_bf16_f32 v36, v36, v37
  v_smfmac_f32_16x16x64_bf16 v[44:47], v[8:11], a[40:47], v112
  ds_write_b32 v114, v36 offset:9728
  v_smfmac_f32_16x16x64_bf16 v[44:47], v[20:23], a[64:71], v112
  v_smfmac_f32_16x16x64_bf16 v[44:47], v[24:27], a[72:79], v112
  s_nop 0
  v_add_f32 v40, v40, v42
  v_smfmac_f32_16x16x64_bf16 v[44:47], v[28:31], a[80:87], v112
  v_add_f32 v41, v41, v43
  v_smfmac_f32_16x16x64_bf16 v[48:51], v[4:7], a[88:95], v112
  v_cvt_pk_bf16_f32 v40, v40, v41
  v_smfmac_f32_16x16x64_bf16 v[48:51], v[8:11], a[96:103], v112
  ds_write_b32 v114, v40 offset:9984
  v_smfmac_f32_16x16x64_bf16 v[48:51], v[20:23], a[120:127], v112
  v_smfmac_f32_16x16x64_bf16 v[48:51], v[24:27], a[128:135], v112
  s_nop 0
  v_add_f32 v44, v44, v46
  v_smfmac_f32_16x16x64_bf16 v[48:51], v[28:31], a[136:143], v112
  v_add_f32 v45, v45, v47
  v_smfmac_f32_16x16x64_bf16 v[52:55], v[4:7], a[144:151], v112
  v_cvt_pk_bf16_f32 v44, v44, v45
  v_smfmac_f32_16x16x64_bf16 v[52:55], v[8:11], a[152:159], v112
  ds_write_b32 v114, v44 offset:10240
  v_smfmac_f32_16x16x64_bf16 v[52:55], v[20:23], a[176:183], v112
  v_smfmac_f32_16x16x64_bf16 v[52:55], v[24:27], a[184:191], v112
  s_nop 0
  v_add_f32 v48, v48, v50
  v_smfmac_f32_16x16x64_bf16 v[52:55], v[28:31], a[192:199], v112
  v_add_f32 v49, v49, v51
  v_smfmac_f32_16x16x64_bf16 v[56:59], v[4:7], a[200:207], v112
  v_cvt_pk_bf16_f32 v48, v48, v49
  v_smfmac_f32_16x16x64_bf16 v[56:59], v[8:11], a[208:215], v112
  ds_write_b32 v114, v48 offset:10496
  v_smfmac_f32_16x16x64_bf16 v[56:59], v[20:23], a[232:239], v112
  v_smfmac_f32_16x16x64_bf16 v[56:59], v[24:27], a[240:247], v112
  s_nop 0
  v_add_f32 v52, v52, v54
  v_smfmac_f32_16x16x64_bf16 v[56:59], v[28:31], a[248:255], v112
  v_add_f32 v53, v53, v55
  v_cvt_pk_bf16_f32 v52, v52, v53
  ds_write_b32 v114, v52 offset:10752
  s_nop 4
  v_add_f32 v56, v56, v58
  v_add_f32 v57, v57, v59
  v_cvt_pk_bf16_f32 v56, v56, v57
  ds_write_b32 v114, v56 offset:11008
  s_add_u32 s42, s42, 28672
  s_waitcnt lgkmcnt(0)
  s_barrier
  v_mov_b32 v44, 0
  v_mov_b32 v45, 0
  v_mov_b32 v46, 0
  v_mov_b32 v47, 0
  v_mov_b32 v48, 0
  v_mov_b32 v49, 0
  v_mov_b32 v50, 0
  v_mov_b32 v51, 0
  s_add_u32 s31, s25, 10240
  s_waitcnt lgkmcnt(0)
  s_mov_b32 s30, 1048576
  buffer_load_dwordx4 v[4:7], v115, s[4:7], s31 offen offset:0 sc1
  buffer_load_dwordx4 v[8:11], v115, s[4:7], s31 offen offset:1024 sc1
  s_sleep 2
  buffer_load_dwordx4 v[12:15], v115, s[4:7], s31 offen offset:0 sc1
  buffer_load_dwordx4 v[16:19], v115, s[4:7], s31 offen offset:1024 sc1
Lpoll_88:
  s_waitcnt vmcnt(2)
  v_max_u32 v3, v7, v11
  v_cmp_eq_u32 vcc, -1, v3
  s_cbranch_vccnz Lfail_90
  v_smfmac_f32_16x16x64_bf16 v[44:47], v[4:7], v[60:67], v116
  v_max3_u32 v3, v4, v5, v6
  v_smfmac_f32_16x16x64_bf16 v[44:47], v[8:11], v[76:83], v116
  v_max3_u32 v3, v3, v8, v9
  v_smfmac_f32_16x16x64_bf16 v[48:51], v[4:7], v[68:75], v116
  v_max_u32 v3, v3, v10
  v_smfmac_f32_16x16x64_bf16 v[48:51], v[8:11], v[84:91], v116
  v_cmp_eq_u32 vcc, -1, v3
  s_cbranch_vccz Ljoin_89
  s_nop 1
  v_mov_b32 v44, 0
  v_mov_b32 v45, 0
  v_mov_b32 v46, 0
  v_mov_b32 v47, 0
  v_mov_b32 v48, 0
  v_mov_b32 v49, 0
  v_mov_b32 v50, 0
  v_mov_b32 v51, 0
Lfail_90:
  buffer_load_dwordx4 v[4:7], v115, s[4:7], s31 offen offset:0 sc1
  buffer_load_dwordx4 v[8:11], v115, s[4:7], s31 offen offset:1024 sc1
  s_waitcnt vmcnt(2)
  v_max_u32 v3, v15, v19
  v_cmp_eq_u32 vcc, -1, v3
  s_cbranch_vccnz Lfail_91
  v_smfmac_f32_16x16x64_bf16 v[44:47], v[12:15], v[60:67], v116
  v_max3_u32 v3, v12, v13, v14
  v_smfmac_f32_16x16x64_bf16 v[44:47], v[16:19], v[76:83], v116
  v_max3_u32 v3, v3, v16, v17
  v_smfmac_f32_16x16x64_bf16 v[48:51], v[12:15], v[68:75], v116
  v_max_u32 v3, v3, v18
  v_smfmac_f32_16x16x64_bf16 v[48:51], v[16:19], v[84:91], v116
  v_cmp_eq_u32 vcc, -1, v3
  s_cbranch_vccz Ljoin_89
  s_nop 1
  v_mov_b32 v44, 0
  v_mov_b32 v45, 0
  v_mov_b32 v46, 0
  v_mov_b32 v47, 0
  v_mov_b32 v48, 0
  v_mov_b32 v49, 0
  v_mov_b32 v50, 0
  v_mov_b32 v51, 0
Lfail_91:
  buffer_load_dwordx4 v[12:15], v115, s[4:7], s31 offen offset:0 sc1
  buffer_load_dwordx4 v[16:19], v115, s[4:7], s31 offen offset:1024 sc1
  s_sub_u32 s30, s30, 1
  s_cbranch_scc0 Lpoll_88
  s_branch Lk1_exit
Ljoin_89:
  s_nop 1
  v_add_f32 v44, v44, v46
  v_add_f32 v45, v45, v47
  ds_write_b64 v117, v[44:45] offset:16384
  s_nop 0
  v_add_f32 v48, v48, v50
  v_add_f32 v49, v49, v51
  ds_write_b64 v117, v[48:49] offset:16896
  s_waitcnt lgkmcnt(0)
  s_barrier
  ds_read_b64 v[52:53], v117 offset:15872
  ds_read_b64 v[54:55], v117 offset:16896
  ds_read_b64 v[56:57], v117 offset:17920
  ds_read_b64 v[58:59], v117 offset:18944
  s_waitcnt lgkmcnt(2)
  v_pk_add_f32 v[52:53], v[52:53], v[54:55]
  s_waitcnt lgkmcnt(0)
  v_pk_add_f32 v[56:57], v[56:57], v[58:59]
  v_pk_add_f32 v[52:53], v[52:53], v[56:57]
  v_cvt_pk_bf16_f32 v52, v52, v53
  v_min_u32 v52, -2, v52
  buffer_store_dword v52, v107, s[4:7], s50 offen
  s_waitcnt vmcnt(1)
  s_add_u32 s48, s48, 7168
  s_mov_b32 s26, s25
  s_mov_b32 s25, s50
  s_mov_b32 s50, s51
  s_mov_b32 s51, s26
  s_add_u32 s24, s24, 1
  s_cmp_lt_u32 s24, 63
  s_cbranch_scc1 Lo_loop_82
  v_mov_b32_dpp v53, v52 quad_perm:[1,1,3,3] row_mask:0xf bank_mask:0xf
  s_mov_b32 exec_lo, 0x55555555
  s_mov_b32 exec_hi, 0x55555555
  buffer_store_dwordx2 v[52:53], v107, s[4:7], s48 offen sc1
  s_mov_b64 exec, -1
  s_endpgm
Lo_w_70:
Lo_loop_92:
  v_mov_b32 v32, 0
  v_mov_b32 v33, 0
  v_mov_b32 v34, 0
  v_mov_b32 v35, 0
  v_mov_b32 v36, 0
  v_mov_b32 v37, 0
  v_mov_b32 v38, 0
  v_mov_b32 v39, 0
  v_mov_b32 v40, 0
  v_mov_b32 v41, 0
  v_mov_b32 v42, 0
  v_mov_b32 v43, 0
  v_mov_b32 v44, 0
  v_mov_b32 v45, 0
  v_mov_b32 v46, 0
  v_mov_b32 v47, 0
  v_mov_b32 v48, 0
  v_mov_b32 v49, 0
  v_mov_b32 v50, 0
  v_mov_b32 v51, 0
  v_mov_b32 v52, 0
  v_mov_b32 v53, 0
  v_mov_b32 v54, 0
  v_mov_b32 v55, 0
  v_mov_b32 v56, 0
  v_mov_b32 v57, 0
  v_mov_b32 v58, 0
  v_mov_b32 v59, 0
  v_lshrrev_b32 v4, 2, v115
  s_add_u32 s29, s24, 1
  s_cmp_lt_u32 s24, s43
  s_cbranch_scc1 Luwd_94
  s_mov_b32 s30, 1048576
Luw_93:
  buffer_load_dword v5, v4, s[4:7], s46 offen sc1
  s_waitcnt vmcnt(0)
  v_cmp_ne_u32 vcc, 0, v5
  s_ff0_i32_b64 s43, vcc
  s_cmp_lt_u32 s24, s43
  s_cbranch_scc1 Luwd_94
  s_sleep 2
  s_sub_u32 s30, s30, 1
  s_cbranch_scc0 Luw_93
  s_branch Lk1_exit
Luwd_94:
  s_add_u32 s28, s42, 3584
  s_add_u32 s31, s25, 4096
  s_mov_b32 s30, 1048576
  buffer_load_dwordx4 v[92:95], v115, s[4:7], s31 offen offset:0 sc1
  buffer_load_dwordx4 v[96:99], v115, s[4:7], s31 offen offset:1024 sc1
Lpoll_95:
  s_waitcnt vmcnt(0)
  v_max_u32 v3, v95, v99
  v_cmp_eq_u32 vcc, -1, v3
  s_cbranch_vccnz Lfail_97
  ds_write_b128 v115, v[92:95] offset:4096
  v_max3_u32 v3, v92, v93, v94
  ds_write_b128 v115, v[96:99] offset:5120
  v_max3_u32 v3, v3, v95, v96
  ds_read_b64_tr_b16 v[20:21], v113 offset:4096
  v_max3_u32 v3, v3, v97, v98
  ds_read_b64_tr_b16 v[22:23], v113 offset:4224
  v_max_u32 v3, v3, v99
  ds_read_b64_tr_b16 v[24:25], v113 offset:5120
  v_cmp_eq_u32 vcc, -1, v3
  ds_read_b64_tr_b16 v[26:27], v113 offset:5248
  s_cbranch_vccz Ljoin_96
Lfail_97:
  buffer_load_dwordx4 v[92:95], v115, s[4:7], s31 offen offset:0 sc1
  buffer_load_dwordx4 v[96:99], v115, s[4:7], s31 offen offset:1024 sc1
  s_sub_u32 s30, s30, 1
  s_cbranch_scc0 Lpoll_95
  s_branch Lk1_exit
Ljoin_96:
  s_waitcnt lgkmcnt(4)
  s_barrier
  s_waitcnt lgkmcnt(0)
  v_smfmac_f32_16x16x64_bf16 v[32:35], v[20:23], v[152:159], v112
  ds_read_b64_tr_b16 v[4:5], v113 offset:0
  v_smfmac_f32_16x16x64_bf16 v[36:39], v[20:23], v[208:215], v112
  ds_read_b64_tr_b16 v[6:7], v113 offset:128
  v_smfmac_f32_16x16x64_bf16 v[40:43], v[20:23], a[8:15], v112
  ds_read_b64_tr_b16 v[8:9], v113 offset:1024
  buffer_load_dwordx4 v[60:63], v105, s[4:7], s42 offen offset:0 sc1
  v_smfmac_f32_16x16x64_bf16 v[44:47], v[20:23], a[64:71], v112
  ds_read_b64_tr_b16 v[10:11], v113 offset:1152
  v_smfmac_f32_16x16x64_bf16 v[48:51], v[20:23], a[120:127], v112
  ds_read_b64_tr_b16 v[12:13], v113 offset:2048
  v_smfmac_f32_16x16x64_bf16 v[52:55], v[20:23], a[176:183], v112
  ds_read_b64_tr_b16 v[14:15], v113 offset:2176
  buffer_load_dwordx4 v[64:67], v105, s[4:7], s42 offen offset:1792 sc1
  v_smfmac_f32_16x16x64_bf16 v[56:59], v[20:23], a[232:239], v112
  ds_read_b64_tr_b16 v[16:17], v113 offset:3072
  v_smfmac_f32_16x16x64_bf16 v[32:35], v[24:27], v[160:167], v112
  ds_read_b64_tr_b16 v[18:19], v113 offset:3200
  v_smfmac_f32_16x16x64_bf16 v[36:39], v[24:27], v[216:223], v112
  ds_read_b64_tr_b16 v[28:29], v113 offset:6144
  buffer_load_dwordx4 v[68:71], v105, s[4:7], s42 offen offset:224 sc1
  v_smfmac_f32_16x16x64_bf16 v[40:43], v[24:27], a[16:23], v112
  ds_read_b64_tr_b16 v[30:31], v113 offset:6272
  v_smfmac_f32_16x16x64_bf16 v[44:47], v[24:27], a[72:79], v112
  v_smfmac_f32_16x16x64_bf16 v[48:51], v[24:27], a[128:135], v112
  buffer_load_dwordx4 v[72:75], v105, s[4:7], s42 offen offset:2016 sc1
  v_smfmac_f32_16x16x64_bf16 v[52:55], v[24:27], a[184:191], v112
  v_smfmac_f32_16x16x64_bf16 v[56:59], v[24:27], a[240:247], v112
  s_waitcnt lgkmcnt(8)
  v_smfmac_f32_16x16x64_bf16 v[32:35], v[4:7], v[120:127], v112
  buffer_load_dwordx4 v[76:79], v105, s[4:7], s28 offen offset:0 sc1
  s_waitcnt lgkmcnt(6)
  v_smfmac_f32_16x16x64_bf16 v[32:35], v[8:11], v[128:135], v112
  s_waitcnt lgkmcnt(4)
  v_smfmac_f32_16x16x64_bf16 v[32:35], v[12:15], v[136:143], v112
  s_waitcnt lgkmcnt(2)
  v_smfmac_f32_16x16x64_bf16 v[32:35], v[16:19], v[144:151], v112
  buffer_load_dwordx4 v[80:83], v105, s[4:7], s28 offen offset:1792 sc1
  s_waitcnt lgkmcnt(0)
  v_smfmac_f32_16x16x64_bf16 v[32:35], v[28:31], v[168:175], v112
  v_smfmac_f32_16x16x64_bf16 v[36:39], v[4:7], v[176:183], v112
  v_smfmac_f32_16x16x64_bf16 v[36:39], v[8:11], v[184:191], v112
  buffer_load_dwordx4 v[84:87], v105, s[4:7], s28 offen offset:224 sc1
  v_smfmac_f32_16x16x64_bf16 v[36:39], v[12:15], v[192:199], v112
  v_smfmac_f32_16x16x64_bf16 v[36:39], v[16:19], v[200:207], v112
  s_nop 2
  v_add_f32 v32, v32, v34
  v_smfmac_f32_16x16x64_bf16 v[36:39], v[28:31], v[224:231], v112
  v_add_f32 v33, v33, v35
  buffer_load_dwordx4 v[88:91], v105, s[4:7], s28 offen offset:2016 sc1
  v_smfmac_f32_16x16x64_bf16 v[40:43], v[4:7], v[232:239], v112
  v_cvt_pk_bf16_f32 v32, v32, v33
  v_smfmac_f32_16x16x64_bf16 v[40:43], v[8:11], v[240:247], v112
  ds_write_b32 v114, v32 offset:11264
  v_smfmac_f32_16x16x64_bf16 v[40:43], v[12:15], v[248:255], v112
  v_smfmac_f32_16x16x64_bf16 v[40:43], v[16:19], a[0:7], v112
  v_add_f32 v36, v36, v38
  v_smfmac_f32_16x16x64_bf16 v[40:43], v[28:31], a[24:31], v112
  v_add_f32 v37, v37, v39
  v_smfmac_f32_16x16x64_bf16 v[44:47], v[4:7], a[32:39], v112
  v_cvt_pk_bf16_f32 v36, v36, v37
  v_smfmac_f32_16x16x64_bf16 v[44:47], v[8:11], a[40:47], v112
  ds_write_b32 v114, v36 offset:11520
  v_smfmac_f32_16x16x64_bf16 v[44:47], v[12:15], a[48:55], v112
  v_smfmac_f32_16x16x64_bf16 v[44:47], v[16:19], a[56:63], v112
  s_nop 0
  v_add_f32 v40, v40, v42
  v_smfmac_f32_16x16x64_bf16 v[44:47], v[28:31], a[80:87], v112
  v_add_f32 v41, v41, v43
  v_smfmac_f32_16x16x64_bf16 v[48:51], v[4:7], a[88:95], v112
  v_cvt_pk_bf16_f32 v40, v40, v41
  v_smfmac_f32_16x16x64_bf16 v[48:51], v[8:11], a[96:103], v112
  ds_write_b32 v114, v40 offset:11776
  v_smfmac_f32_16x16x64_bf16 v[48:51], v[12:15], a[104:111], v112
  v_smfmac_f32_16x16x64_bf16 v[48:51], v[16:19], a[112:119], v112
  s_nop 0
  v_add_f32 v44, v44, v46
  v_smfmac_f32_16x16x64_bf16 v[48:51], v[28:31], a[136:143], v112
  v_add_f32 v45, v45, v47
  v_smfmac_f32_16x16x64_bf16 v[52:55], v[4:7], a[144:151], v112
  v_cvt_pk_bf16_f32 v44, v44, v45
  v_smfmac_f32_16x16x64_bf16 v[52:55], v[8:11], a[152:159], v112
  ds_write_b32 v114, v44 offset:12032
  v_smfmac_f32_16x16x64_bf16 v[52:55], v[12:15], a[160:167], v112
  v_smfmac_f32_16x16x64_bf16 v[52:55], v[16:19], a[168:175], v112
  s_nop 0
  v_add_f32 v48, v48, v50
  v_smfmac_f32_16x16x64_bf16 v[52:55], v[28:31], a[192:199], v112
  v_add_f32 v49, v49, v51
  v_smfmac_f32_16x16x64_bf16 v[56:59], v[4:7], a[200:207], v112
  v_cvt_pk_bf16_f32 v48, v48, v49
  v_smfmac_f32_16x16x64_bf16 v[56:59], v[8:11], a[208:215], v112
  ds_write_b32 v114, v48 offset:12288
  v_smfmac_f32_16x16x64_bf16 v[56:59], v[12:15], a[216:223], v112
  v_smfmac_f32_16x16x64_bf16 v[56:59], v[16:19], a[224:231], v112
  s_nop 0
  v_add_f32 v52, v52, v54
  v_smfmac_f32_16x16x64_bf16 v[56:59], v[28:31], a[248:255], v112
  v_add_f32 v53, v53, v55
  v_cvt_pk_bf16_f32 v52, v52, v53
  ds_write_b32 v114, v52 offset:12544
  s_nop 4
  v_add_f32 v56, v56, v58
  v_add_f32 v57, v57, v59
  v_cvt_pk_bf16_f32 v56, v56, v57
  ds_write_b32 v114, v56 offset:12800
  s_add_u32 s42, s42, 28672
  s_waitcnt lgkmcnt(0)
  s_barrier
  ds_read_b128 v[28:31], v106 offset:7680
  ds_read_b128 v[32:35], v106 offset:9472
  ds_read_b128 v[36:39], v106 offset:7904
  ds_read_b128 v[40:43], v106 offset:9696
  v_mov_b32 v44, 0
  v_mov_b32 v45, 0
  v_mov_b32 v46, 0
  v_mov_b32 v47, 0
  v_mov_b32 v48, 0
  v_mov_b32 v49, 0
  v_mov_b32 v50, 0
  v_mov_b32 v51, 0
  s_add_u32 s31, s25, 12288
  s_add_u32 s29, s25, 16384
  s_waitcnt lgkmcnt(0)
  s_mov_b32 s30, 1048576
  buffer_load_dwordx4 v[4:7], v115, s[4:7], s31 offen offset:0 sc1
  buffer_load_dwordx4 v[8:11], v115, s[4:7], s31 offen offset:1024 sc1
  buffer_load_dwordx4 v[12:15], v115, s[4:7], s29 offen sc1
  s_sleep 2
  buffer_load_dwordx4 v[16:19], v115, s[4:7], s31 offen offset:0 sc1
  buffer_load_dwordx4 v[20:23], v115, s[4:7], s31 offen offset:1024 sc1
  buffer_load_dwordx4 v[24:27], v115, s[4:7], s29 offen sc1
Lpoll_98:
  s_waitcnt vmcnt(3)
  v_max3_u32 v3, v7, v11, v15
  v_cmp_eq_u32 vcc, -1, v3
  s_cbranch_vccnz Lfail_100
  v_smfmac_f32_16x16x64_bf16 v[44:47], v[4:7], v[60:67], v116
  v_max3_u32 v3, v4, v5, v6
  v_smfmac_f32_16x16x64_bf16 v[44:47], v[8:11], v[76:83], v116
  v_max3_u32 v3, v3, v8, v9
  v_smfmac_f32_16x16x64_bf16 v[44:47], v[12:15], v[28:35], v116
  v_max3_u32 v3, v3, v10, v12
  v_smfmac_f32_16x16x64_bf16 v[48:51], v[4:7], v[68:75], v116
  v_max3_u32 v3, v3, v13, v14
  v_smfmac_f32_16x16x64_bf16 v[48:51], v[8:11], v[84:91], v116
  v_cmp_eq_u32 vcc, -1, v3
  v_smfmac_f32_16x16x64_bf16 v[48:51], v[12:15], v[36:43], v116
  s_cbranch_vccz Ljoin_99
  s_nop 0
  v_mov_b32 v44, 0
  v_mov_b32 v45, 0
  v_mov_b32 v46, 0
  v_mov_b32 v47, 0
  s_nop 1
  v_mov_b32 v48, 0
  v_mov_b32 v49, 0
  v_mov_b32 v50, 0
  v_mov_b32 v51, 0
Lfail_100:
  buffer_load_dwordx4 v[4:7], v115, s[4:7], s31 offen offset:0 sc1
  buffer_load_dwordx4 v[8:11], v115, s[4:7], s31 offen offset:1024 sc1
  buffer_load_dwordx4 v[12:15], v115, s[4:7], s29 offen sc1
  s_waitcnt vmcnt(3)
  v_max3_u32 v3, v19, v23, v27
  v_cmp_eq_u32 vcc, -1, v3
  s_cbranch_vccnz Lfail_101
  v_smfmac_f32_16x16x64_bf16 v[44:47], v[16:19], v[60:67], v116
  v_max3_u32 v3, v16, v17, v18
  v_smfmac_f32_16x16x64_bf16 v[44:47], v[20:23], v[76:83], v116
  v_max3_u32 v3, v3, v20, v21
  v_smfmac_f32_16x16x64_bf16 v[44:47], v[24:27], v[28:35], v116
  v_max3_u32 v3, v3, v22, v24
  v_smfmac_f32_16x16x64_bf16 v[48:51], v[16:19], v[68:75], v116
  v_max3_u32 v3, v3, v25, v26
  v_smfmac_f32_16x16x64_bf16 v[48:51], v[20:23], v[84:91], v116
  v_cmp_eq_u32 vcc, -1, v3
  v_smfmac_f32_16x16x64_bf16 v[48:51], v[24:27], v[36:43], v116
  s_cbranch_vccz Ljoin_99
  s_nop 0
  v_mov_b32 v44, 0
  v_mov_b32 v45, 0
  v_mov_b32 v46, 0
  v_mov_b32 v47, 0
  s_nop 1
  v_mov_b32 v48, 0
  v_mov_b32 v49, 0
  v_mov_b32 v50, 0
  v_mov_b32 v51, 0
Lfail_101:
  buffer_load_dwordx4 v[16:19], v115, s[4:7], s31 offen offset:0 sc1
  buffer_load_dwordx4 v[20:23], v115, s[4:7], s31 offen offset:1024 sc1
  buffer_load_dwordx4 v[24:27], v115, s[4:7], s29 offen sc1
  s_sub_u32 s30, s30, 1
  s_cbranch_scc0 Lpoll_98
  s_branch Lk1_exit
Ljoin_99:
  s_nop 0
  v_add_f32 v44, v44, v46
  v_add_f32 v45, v45, v47
  ds_write_b64 v117, v[44:45] offset:17408
  s_nop 2
  v_add_f32 v48, v48, v50
  v_add_f32 v49, v49, v51
  ds_write_b64 v117, v[48:49] offset:17920
  s_waitcnt lgkmcnt(0)
  s_barrier
  s_waitcnt vmcnt(0)
  s_add_u32 s48, s48, 7168
  s_mov_b32 s26, s25
  s_mov_b32 s25, s50
  s_mov_b32 s50, s51
  s_mov_b32 s51, s26
  s_add_u32 s24, s24, 1
  s_cmp_lt_u32 s24, 63
  s_cbranch_scc1 Lo_loop_92
  s_endpgm
Lo_w_71:
Lo_loop_102:
  v_mov_b32 v32, 0
  v_mov_b32 v33, 0
  v_mov_b32 v34, 0
  v_mov_b32 v35, 0
  v_mov_b32 v36, 0
  v_mov_b32 v37, 0
  v_mov_b32 v38, 0
  v_mov_b32 v39, 0
  v_mov_b32 v40, 0
  v_mov_b32 v41, 0
  v_mov_b32 v42, 0
  v_mov_b32 v43, 0
  v_mov_b32 v44, 0
  v_mov_b32 v45, 0
  v_mov_b32 v46, 0
  v_mov_b32 v47, 0
  v_mov_b32 v48, 0
  v_mov_b32 v49, 0
  v_mov_b32 v50, 0
  v_mov_b32 v51, 0
  v_mov_b32 v52, 0
  v_mov_b32 v53, 0
  v_mov_b32 v54, 0
  v_mov_b32 v55, 0
  v_mov_b32 v56, 0
  v_mov_b32 v57, 0
  v_mov_b32 v58, 0
  v_mov_b32 v59, 0
  v_lshrrev_b32 v4, 2, v115
  s_add_u32 s29, s24, 1
  s_cmp_lt_u32 s24, s43
  s_cbranch_scc1 Luwd_104
  s_mov_b32 s30, 1048576
Luw_103:
  buffer_load_dword v5, v4, s[4:7], s46 offen sc1
  s_waitcnt vmcnt(0)
  v_cmp_ne_u32 vcc, 0, v5
  s_ff0_i32_b64 s43, vcc
  s_cmp_lt_u32 s24, s43
  s_cbranch_scc1 Luwd_104
  s_sleep 2
  s_sub_u32 s30, s30, 1
  s_cbranch_scc0 Luw_103
  s_branch Lk1_exit
Luwd_104:
  s_add_u32 s28, s42, 3584
  s_add_u32 s31, s25, 4096
  s_mov_b32 s30, 1048576
  buffer_load_dwordx4 v[92:95], v115, s[4:7], s31 offen offset:2048 sc1
Lpoll_105:
  s_waitcnt vmcnt(0)
  v_cmp_eq_u32 vcc, -1, v95
  s_cbranch_vccnz Lfail_107
  ds_write_b128 v115, v[92:95] offset:6144
  v_max3_u32 v3, v92, v93, v94
  ds_read_b64_tr_b16 v[28:29], v113 offset:6144
  v_max_u32 v3, v3, v95
  ds_read_b64_tr_b16 v[30:31], v113 offset:6272
  v_cmp_eq_u32 vcc, -1, v3
  s_cbranch_vccz Ljoin_106
Lfail_107:
  buffer_load_dwordx4 v[92:95], v115, s[4:7], s31 offen offset:2048 sc1
  s_sub_u32 s30, s30, 1
  s_cbranch_scc0 Lpoll_105
  s_branch Lk1_exit
Ljoin_106:
  s_waitcnt lgkmcnt(2)
  s_barrier
  ds_read_b128 v[108:111], v118 offset:0
  s_waitcnt lgkmcnt(0)
  v_smfmac_f32_16x16x64_bf16 v[32:35], v[28:31], v[168:175], v112
  ds_read_b64_tr_b16 v[4:5], v113 offset:0
  ds_read_b64_tr_b16 v[6:7], v113 offset:128
  v_smfmac_f32_16x16x64_bf16 v[36:39], v[28:31], v[224:231], v112
  ds_read_b64_tr_b16 v[8:9], v113 offset:1024
  ds_read_b64_tr_b16 v[10:11], v113 offset:1152
  v_smfmac_f32_16x16x64_bf16 v[40:43], v[28:31], a[24:31], v112
  ds_read_b64_tr_b16 v[12:13], v113 offset:2048
  ds_read_b64_tr_b16 v[14:15], v113 offset:2176
  v_smfmac_f32_16x16x64_bf16 v[44:47], v[28:31], a[80:87], v112
  ds_read_b64_tr_b16 v[16:17], v113 offset:3072
  ds_read_b64_tr_b16 v[18:19], v113 offset:3200
  buffer_store_dwordx4 v[108:111], v118, s[4:7], s48 offen sc1
  v_smfmac_f32_16x16x64_bf16 v[48:51], v[28:31], a[136:143], v112
  ds_read_b64_tr_b16 v[20:21], v113 offset:4096
  ds_read_b64_tr_b16 v[22:23], v113 offset:4224
  v_smfmac_f32_16x16x64_bf16 v[52:55], v[28:31], a[192:199], v112
  ds_read_b64_tr_b16 v[24:25], v113 offset:5120
  ds_read_b64_tr_b16 v[26:27], v113 offset:5248
  v_smfmac_f32_16x16x64_bf16 v[56:59], v[28:31], a[248:255], v112
  buffer_load_dwordx4 v[60:63], v105, s[4:7], s42 offen offset:0 sc1
  s_waitcnt lgkmcnt(10)
  v_smfmac_f32_16x16x64_bf16 v[32:35], v[4:7], v[120:127], v112
  s_waitcnt lgkmcnt(8)
  v_smfmac_f32_16x16x64_bf16 v[32:35], v[8:11], v[128:135], v112
  s_waitcnt lgkmcnt(6)
  v_smfmac_f32_16x16x64_bf16 v[32:35], v[12:15], v[136:143], v112
  buffer_load_dwordx4 v[64:67], v105, s[4:7], s42 offen offset:1792 sc1
  s_waitcnt lgkmcnt(4)
  v_smfmac_f32_16x16x64_bf16 v[32:35], v[16:19], v[144:151], v112
  s_waitcnt lgkmcnt(2)
  v_smfmac_f32_16x16x64_bf16 v[32:35], v[20:23], v[152:159], v112
  s_waitcnt lgkmcnt(0)
  v_smfmac_f32_16x16x64_bf16 v[32:35], v[24:27], v[160:167], v112
  buffer_load_dwordx4 v[68:71], v105, s[4:7], s42 offen offset:224 sc1
  v_smfmac_f32_16x16x64_bf16 v[36:39], v[4:7], v[176:183], v112
  v_smfmac_f32_16x16x64_bf16 v[36:39], v[8:11], v[184:191], v112
  v_smfmac_f32_16x16x64_bf16 v[36:39], v[12:15], v[192:199], v112
  buffer_load_dwordx4 v[72:75], v105, s[4:7], s42 offen offset:2016 sc1
  v_smfmac_f32_16x16x64_bf16 v[36:39], v[16:19], v[200:207], v112
  s_nop 1
  v_add_f32 v32, v32, v34
  v_smfmac_f32_16x16x64_bf16 v[36:39], v[20:23], v[208:215], v112
  v_add_f32 v33, v33, v35
  v_smfmac_f32_16x16x64_bf16 v[36:39], v[24:27], v[216:223], v112
  v_cvt_pk_bf16_f32 v32, v32, v33
  buffer_load_dwordx4 v[76:79], v105, s[4:7], s28 offen offset:0 sc1
  v_smfmac_f32_16x16x64_bf16 v[40:43], v[4:7], v[232:239], v112
  ds_write_b32 v114, v32 offset:13056
  v_smfmac_f32_16x16x64_bf16 v[40:43], v[8:11], v[240:247], v112
  v_smfmac_f32_16x16x64_bf16 v[40:43], v[12:15], v[248:255], v112
  buffer_load_dwordx4 v[80:83], v105, s[4:7], s28 offen offset:1792 sc1
  v_smfmac_f32_16x16x64_bf16 v[40:43], v[16:19], a[0:7], v112
  v_add_f32 v36, v36, v38
  v_smfmac_f32_16x16x64_bf16 v[40:43], v[20:23], a[8:15], v112
  v_add_f32 v37, v37, v39
  v_smfmac_f32_16x16x64_bf16 v[40:43], v[24:27], a[16:23], v112
  v_cvt_pk_bf16_f32 v36, v36, v37
  buffer_load_dwordx4 v[84:87], v105, s[4:7], s28 offen offset:224 sc1
  v_smfmac_f32_16x16x64_bf16 v[44:47], v[4:7], a[32:39], v112
  ds_write_b32 v114, v36 offset:13312
  v_smfmac_f32_16x16x64_bf16 v[44:47], v[8:11], a[40:47], v112
  v_smfmac_f32_16x16x64_bf16 v[44:47], v[12:15], a[48:55], v112
  buffer_load_dwordx4 v[88:91], v105, s[4:7], s28 offen offset:2016 sc1
  v_smfmac_f32_16x16x64_bf16 v[44:47], v[16:19], a[56:63], v112
  v_add_f32 v40, v40, v42
  v_smfmac_f32_16x16x64_bf16 v[44:47], v[20:23], a[64:71], v112
  v_add_f32 v41, v41, v43
  v_smfmac_f32_16x16x64_bf16 v[44:47], v[24:27], a[72:79], v112
  v_cvt_pk_bf16_f32 v40, v40, v41
  v_smfmac_f32_16x16x64_bf16 v[48:51], v[4:7], a[88:95], v112
  ds_write_b32 v114, v40 offset:13568
  v_smfmac_f32_16x16x64_bf16 v[48:51], v[8:11], a[96:103], v112
  v_smfmac_f32_16x16x64_bf16 v[48:51], v[12:15], a[104:111], v112
  v_smfmac_f32_16x16x64_bf16 v[48:51], v[16:19], a[112:119], v112
  s_nop 1
  v_add_f32 v44, v44, v46
  v_smfmac_f32_16x16x64_bf16 v[48:51], v[20:23], a[120:127], v112
  v_add_f32 v45, v45, v47
  v_smfmac_f32_16x16x64_bf16 v[48:51], v[24:27], a[128:135], v112
  v_cvt_pk_bf16_f32 v44, v44, v45
  v_smfmac_f32_16x16x64_bf16 v[52:55], v[4:7], a[144:151], v112
  ds_write_b32 v114, v44 offset:13824
  v_smfmac_f32_16x16x64_bf16 v[52:55], v[8:11], a[152:159], v112
  v_smfmac_f32_16x16x64_bf16 v[52:55], v[12:15], a[160:167], v112
  v_smfmac_f32_16x16x64_bf16 v[52:55], v[16:19], a[168:175], v112
  s_nop 1
  v_add_f32 v48, v48, v50
  v_smfmac_f32_16x16x64_bf16 v[52:55], v[20:23], a[176:183], v112
  v_add_f32 v49, v49, v51
  v_smfmac_f32_16x16x64_bf16 v[52:55], v[24:27], a[184:191], v112
  v_cvt_pk_bf16_f32 v48, v48, v49
  v_smfmac_f32_16x16x64_bf16 v[56:59], v[4:7], a[200:207], v112
  ds_write_b32 v114, v48 offset:14080
  v_smfmac_f32_16x16x64_bf16 v[56:59], v[8:11], a[208:215], v112
  v_smfmac_f32_16x16x64_bf16 v[56:59], v[12:15], a[216:223], v112
  v_smfmac_f32_16x16x64_bf16 v[56:59], v[16:19], a[224:231], v112
  s_nop 1
  v_add_f32 v52, v52, v54
  v_smfmac_f32_16x16x64_bf16 v[56:59], v[20:23], a[232:239], v112
  v_add_f32 v53, v53, v55
  v_smfmac_f32_16x16x64_bf16 v[56:59], v[24:27], a[240:247], v112
  v_cvt_pk_bf16_f32 v52, v52, v53
  ds_write_b32 v114, v52 offset:14336
  s_nop 5
  v_add_f32 v56, v56, v58
  v_add_f32 v57, v57, v59
  v_cvt_pk_bf16_f32 v56, v56, v57
  ds_write_b32 v114, v56 offset:14592
  s_add_u32 s42, s42, 28672
  s_waitcnt lgkmcnt(0)
  s_barrier
  ds_read_b128 v[28:31], v106 offset:11264
  ds_read_b128 v[32:35], v106 offset:13056
  ds_read_b128 v[36:39], v106 offset:11488
  ds_read_b128 v[40:43], v106 offset:13280
  v_mov_b32 v44, 0
  v_mov_b32 v45, 0
  v_mov_b32 v46, 0
  v_mov_b32 v47, 0
  v_mov_b32 v48, 0
  v_mov_b32 v49, 0
  v_mov_b32 v50, 0
  v_mov_b32 v51, 0
  s_add_u32 s31, s25, 14336
  s_add_u32 s29, s25, 17408
  s_waitcnt lgkmcnt(0)
  s_mov_b32 s30, 1048576
  buffer_load_dwordx4 v[4:7], v115, s[4:7], s31 offen offset:0 sc1
  buffer_load_dwordx4 v[8:11], v115, s[4:7], s31 offen offset:1024 sc1
  buffer_load_dwordx4 v[12:15], v115, s[4:7], s29 offen sc1
  s_sleep 2
  buffer_load_dwordx4 v[16:19], v115, s[4:7], s31 offen offset:0 sc1
  buffer_load_dwordx4 v[20:23], v115, s[4:7], s31 offen offset:1024 sc1
  buffer_load_dwordx4 v[24:27], v115, s[4:7], s29 offen sc1
Lpoll_108:
  s_waitcnt vmcnt(3)
  v_max3_u32 v3, v7, v11, v15
  v_cmp_eq_u32 vcc, -1, v3
  s_cbranch_vccnz Lfail_110
  v_smfmac_f32_16x16x64_bf16 v[44:47], v[4:7], v[60:67], v116
  v_max3_u32 v3, v4, v5, v6
  v_smfmac_f32_16x16x64_bf16 v[44:47], v[8:11], v[76:83], v116
  v_max3_u32 v3, v3, v8, v9
  v_smfmac_f32_16x16x64_bf16 v[44:47], v[12:15], v[28:35], v116
  v_max3_u32 v3, v3, v10, v12
  v_smfmac_f32_16x16x64_bf16 v[48:51], v[4:7], v[68:75], v116
  v_max3_u32 v3, v3, v13, v14
  v_smfmac_f32_16x16x64_bf16 v[48:51], v[8:11], v[84:91], v116
  v_cmp_eq_u32 vcc, -1, v3
  v_smfmac_f32_16x16x64_bf16 v[48:51], v[12:15], v[36:43], v116
  s_cbranch_vccz Ljoin_109
  s_nop 0
  v_mov_b32 v44, 0
  v_mov_b32 v45, 0
  v_mov_b32 v46, 0
  v_mov_b32 v47, 0
  s_nop 1
  v_mov_b32 v48, 0
  v_mov_b32 v49, 0
  v_mov_b32 v50, 0
  v_mov_b32 v51, 0
Lfail_110:
  buffer_load_dwordx4 v[4:7], v115, s[4:7], s31 offen offset:0 sc1
  buffer_load_dwordx4 v[8:11], v115, s[4:7], s31 offen offset:1024 sc1
  buffer_load_dwordx4 v[12:15], v115, s[4:7], s29 offen sc1
  s_waitcnt vmcnt(3)
  v_max3_u32 v3, v19, v23, v27
  v_cmp_eq_u32 vcc, -1, v3
  s_cbranch_vccnz Lfail_111
  v_smfmac_f32_16x16x64_bf16 v[44:47], v[16:19], v[60:67], v116
  v_max3_u32 v3, v16, v17, v18
  v_smfmac_f32_16x16x64_bf16 v[44:47], v[20:23], v[76:83], v116
  v_max3_u32 v3, v3, v20, v21
  v_smfmac_f32_16x16x64_bf16 v[44:47], v[24:27], v[28:35], v116
  v_max3_u32 v3, v3, v22, v24
  v_smfmac_f32_16x16x64_bf16 v[48:51], v[16:19], v[68:75], v116
  v_max3_u32 v3, v3, v25, v26
  v_smfmac_f32_16x16x64_bf16 v[48:51], v[20:23], v[84:91], v116
  v_cmp_eq_u32 vcc, -1, v3
  v_smfmac_f32_16x16x64_bf16 v[48:51], v[24:27], v[36:43], v116
  s_cbranch_vccz Ljoin_109
  s_nop 0
  v_mov_b32 v44, 0
  v_mov_b32 v45, 0
  v_mov_b32 v46, 0
  v_mov_b32 v47, 0
  s_nop 1
  v_mov_b32 v48, 0
  v_mov_b32 v49, 0
  v_mov_b32 v50, 0
  v_mov_b32 v51, 0
Lfail_111:
  buffer_load_dwordx4 v[16:19], v115, s[4:7], s31 offen offset:0 sc1
  buffer_load_dwordx4 v[20:23], v115, s[4:7], s31 offen offset:1024 sc1
  buffer_load_dwordx4 v[24:27], v115, s[4:7], s29 offen sc1
  s_sub_u32 s30, s30, 1
  s_cbranch_scc0 Lpoll_108
  s_branch Lk1_exit
Ljoin_109:
  s_nop 0
  v_add_f32 v44, v44, v46
  v_add_f32 v45, v45, v47
  ds_write_b64 v117, v[44:45] offset:18432
  s_nop 2
  v_add_f32 v48, v48, v50
  v_add_f32 v49, v49, v51
  ds_write_b64 v117, v[48:49] offset:18944
  s_waitcnt lgkmcnt(0)
  s_barrier
  s_waitcnt vmcnt(0)
  s_add_u32 s48, s48, 7168
  s_mov_b32 s26, s25
  s_mov_b32 s25, s50
  s_mov_b32 s50, s51
  s_mov_b32 s51, s26
  s_add_u32 s24, s24, 1
  s_cmp_lt_u32 s24, 63
  s_cbranch_scc1 Lo_loop_102
  s_endpgm
Lworker:
  s_cmp_ge_u32 s22, 32
  s_cbranch_scc1 Lk1_exit
  s_load_dwordx2 s[52:53], s[0:1], 80
  s_sub_u32 s40, s21, s23
  s_sub_u32 s40, s40, 1
  s_and_b32 s40, s40, 7
  s_lshl_b32 s40, s40, 5
  s_add_u32 s40, s40, s22
  v_lshlrev_b32 v1, 4, v0
  v_and_b32 v2, 15, v0
  v_lshrrev_b32 v3, 4, v0
  v_mov_b32 v112, 0
  v_mov_b32 v113, 1
  s_mov_b32 s56, -1
  s_mov_b32 s57, 0xffffff
  s_waitcnt lgkmcnt(0)
  s_mov_b32 s54, 896
  s_mov_b32 s55, 0x20000
  s_mul_hi_u32 s42, s40, 613566757
  s_mul_i32 s26, s42, 7
  s_sub_u32 s41, s40, s26
  s_mul_i32 s43, s20, 7424
  s_mov_b32 s47, 29696
  s_mul_i32 s44, s41, 28672
  s_mul_i32 s26, s20, 7168
  s_add_u32 s44, s44, s26
  s_mov_b64 exec, s[56:57]
  s_add_u32 m0, s43, 0
  s_nop 0
  buffer_load_dwordx4 v1, s[8:11], s44 offen offset:0 lds
  s_add_u32 m0, s43, 32
  s_nop 0
  buffer_load_dwordx4 v1, s[8:11], s44 offen offset:896 lds
  s_add_u32 m0, s43, 64
  s_nop 0
  buffer_load_dwordx4 v1, s[8:11], s44 offen offset:1792 lds
  s_add_u32 m0, s43, 96
  s_nop 0
  buffer_load_dwordx4 v1, s[8:11], s44 offen offset:2688 lds
  s_add_u32 s44, s44, 3584
  s_add_u32 m0, s43, 3712
  s_nop 0
  buffer_load_dwordx4 v1, s[8:11], s44 offen offset:0 lds
  s_add_u32 m0, s43, 3744
  s_nop 0
  buffer_load_dwordx4 v1, s[8:11], s44 offen offset:896 lds
  s_add_u32 m0, s43, 3776
  s_nop 0
  buffer_load_dwordx4 v1, s[8:11], s44 offen offset:1792 lds
  s_add_u32 m0, s43, 3808
  s_nop 0
  buffer_load_dwordx4 v1, s[8:11], s44 offen offset:2688 lds
  s_mov_b64 exec, -1
  s_cmp_ge_u32 s42, 16
  s_cbranch_scc1 Ltx_112
  s_sleep 127
  s_sleep 127
  s_sleep 127
Ltx_112:
  s_and_b32 s26, s42, 15
  s_lshl_b32 s27, s26, 4
  s_lshl_b32 s28, s20, 1
  s_add_u32 s27, s27, s28
  s_lshr_b32 s26, s26, 2
  s_lshl_b32 s26, s26, 1
  s_lshl_b32 s28, s20, 6
  s_add_u32 s26, s26, s28
  s_add_u32 s26, s26, 8
  s_cmp_lt_u32 s42, 16
  s_cselect_b32 s26, s27, s26
  s_cselect_b32 s27, 0, 16
  v_bfe_u32 v100, v0, 1, 2
  v_mul_lo_u32 v100, v100, s27
  v_and_b32 v101, 0, v0
  v_add3_u32 v100, v100, v101, s26
  v_lshlrev_b32 v100, 2, v100
  s_mov_b32 s30, 1048576
  s_mov_b32 s29, 88659968
Lgo_113:
  buffer_load_dword v101, v100, s[4:7], s29 offen sc1
  s_waitcnt vmcnt(0)
  v_cmp_ne_u32 vcc, s72, v101
  s_cbranch_vccz Lgod_114
  s_sleep 16
  s_sub_u32 s30, s30, 1
  s_cbranch_scc0 Lgo_113
  s_branch Lk1_exit
Lgod_114:
  s_mul_i32 s26, s42, 401408
  s_mul_i32 s27, s20, 100352
  s_add_u32 s28, s26, s27
  s_add_u32 s27, s28, 0
  buffer_load_dwordx4 v[120:123], v1, s[4:7], s27 offen offset:0 sc1
  buffer_load_dwordx4 v[124:127], v1, s[4:7], s27 offen offset:1024 sc1
  buffer_load_dwordx4 v[128:131], v1, s[4:7], s27 offen offset:2048 sc1
  buffer_load_dwordx4 v[132:135], v1, s[4:7], s27 offen offset:3072 sc1
  s_add_u32 s27, s27, 4096
  buffer_load_dwordx4 v[136:139], v1, s[4:7], s27 offen offset:0 sc1
  buffer_load_dwordx4 v[140:143], v1, s[4:7], s27 offen offset:1024 sc1
  buffer_load_dwordx4 v[144:147], v1, s[4:7], s27 offen offset:2048 sc1
  s_add_u32 s27, s27, 10240
  buffer_load_dwordx4 v[176:179], v1, s[4:7], s27 offen offset:0 sc1
  buffer_load_dwordx4 v[180:183], v1, s[4:7], s27 offen offset:1024 sc1
  buffer_load_dwordx4 v[184:187], v1, s[4:7], s27 offen offset:2048 sc1
  buffer_load_dwordx4 v[188:191], v1, s[4:7], s27 offen offset:3072 sc1
  s_add_u32 s27, s27, 4096
  buffer_load_dwordx4 v[192:195], v1, s[4:7], s27 offen offset:0 sc1
  buffer_load_dwordx4 v[196:199], v1, s[4:7], s27 offen offset:1024 sc1
  buffer_load_dwordx4 v[200:203], v1, s[4:7], s27 offen offset:2048 sc1
  s_add_u32 s27, s27, 10240
  buffer_load_dwordx4 v[232:235], v1, s[4:7], s27 offen offset:0 sc1
  buffer_load_dwordx4 v[236:239], v1, s[4:7], s27 offen offset:1024 sc1
  buffer_load_dwordx4 v[240:243], v1, s[4:7], s27 offen offset:2048 sc1
  buffer_load_dwordx4 v[244:247], v1, s[4:7], s27 offen offset:3072 sc1
  s_add_u32 s27, s27, 4096
  buffer_load_dwordx4 v[248:251], v1, s[4:7], s27 offen offset:0 sc1
  buffer_load_dwordx4 v[252:255], v1, s[4:7], s27 offen offset:1024 sc1
  buffer_load_dwordx4 a[0:3], v1, s[4:7], s27 offen offset:2048 sc1
  s_add_u32 s27, s27, 10240
  buffer_load_dwordx4 a[32:35], v1, s[4:7], s27 offen offset:0 sc1
  buffer_load_dwordx4 a[36:39], v1, s[4:7], s27 offen offset:1024 sc1
  buffer_load_dwordx4 a[40:43], v1, s[4:7], s27 offen offset:2048 sc1
  buffer_load_dwordx4 a[44:47], v1, s[4:7], s27 offen offset:3072 sc1
  s_add_u32 s27, s27, 4096
  buffer_load_dwordx4 a[48:51], v1, s[4:7], s27 offen offset:0 sc1
  buffer_load_dwordx4 a[52:55], v1, s[4:7], s27 offen offset:1024 sc1
  buffer_load_dwordx4 a[56:59], v1, s[4:7], s27 offen offset:2048 sc1
  s_add_u32 s27, s27, 10240
  buffer_load_dwordx4 a[88:91], v1, s[4:7], s27 offen offset:0 sc1
  buffer_load_dwordx4 a[92:95], v1, s[4:7], s27 offen offset:1024 sc1
  buffer_load_dwordx4 a[96:99], v1, s[4:7], s27 offen offset:2048 sc1
  buffer_load_dwordx4 a[100:103], v1, s[4:7], s27 offen offset:3072 sc1
  s_add_u32 s27, s27, 4096
  buffer_load_dwordx4 a[104:107], v1, s[4:7], s27 offen offset:0 sc1
  buffer_load_dwordx4 a[108:111], v1, s[4:7], s27 offen offset:1024 sc1
  buffer_load_dwordx4 a[112:115], v1, s[4:7], s27 offen offset:2048 sc1
  s_add_u32 s27, s27, 10240
  buffer_load_dwordx4 a[144:147], v1, s[4:7], s27 offen offset:0 sc1
  buffer_load_dwordx4 a[148:151], v1, s[4:7], s27 offen offset:1024 sc1
  buffer_load_dwordx4 a[152:155], v1, s[4:7], s27 offen offset:2048 sc1
  buffer_load_dwordx4 a[156:159], v1, s[4:7], s27 offen offset:3072 sc1
  s_add_u32 s27, s27, 4096
  buffer_load_dwordx4 a[160:163], v1, s[4:7], s27 offen offset:0 sc1
  buffer_load_dwordx4 a[164:167], v1, s[4:7], s27 offen offset:1024 sc1
  buffer_load_dwordx4 a[168:171], v1, s[4:7], s27 offen offset:2048 sc1
  s_add_u32 s27, s27, 10240
  buffer_load_dwordx4 a[200:203], v1, s[4:7], s27 offen offset:0 sc1
  buffer_load_dwordx4 a[204:207], v1, s[4:7], s27 offen offset:1024 sc1
  buffer_load_dwordx4 a[208:211], v1, s[4:7], s27 offen offset:2048 sc1
  buffer_load_dwordx4 a[212:215], v1, s[4:7], s27 offen offset:3072 sc1
  s_add_u32 s27, s27, 4096
  buffer_load_dwordx4 a[216:219], v1, s[4:7], s27 offen offset:0 sc1
  buffer_load_dwordx4 a[220:223], v1, s[4:7], s27 offen offset:1024 sc1
  buffer_load_dwordx4 a[224:227], v1, s[4:7], s27 offen offset:2048 sc1
  s_mov_b32 s30, 1048576
  s_mov_b32 s29, 88659968
Lgo_115:
  buffer_load_dwordx4 v[8:11], v1, s[4:7], s29 offen sc1
  buffer_load_dword v12, off, s[68:71], 0 offset:64 sc1
  s_waitcnt vmcnt(0)
  v_xor_b32 v8, s72, v8
  v_xor_b32 v9, s72, v9
  v_xor_b32 v10, s72, v10
  v_xor_b32 v11, s72, v11
  v_or3_b32 v8, v8, v9, v10
  v_or_b32 v8, v8, v11
  v_cmp_ne_u32 vcc, 0, v8
  s_cbranch_vccz Lgod_116
  s_sleep 16
  s_sub_u32 s30, s30, 1
  s_cbranch_scc0 Lgo_115
  s_branch Lk1_exit
Lgod_116:
  v_readfirstlane_b32 s27, v12
  s_nop 0
  s_cmp_lg_u32 s27, s79
  s_cbranch_scc1 Lfallback
  s_add_u32 s27, s28, 7168
  buffer_load_dwordx4 v[148:151], v1, s[4:7], s27 offen offset:0 sc1
  buffer_load_dwordx4 v[152:155], v1, s[4:7], s27 offen offset:1024 sc1
  buffer_load_dwordx4 v[156:159], v1, s[4:7], s27 offen offset:2048 sc1
  buffer_load_dwordx4 v[160:163], v1, s[4:7], s27 offen offset:3072 sc1
  s_add_u32 s27, s27, 4096
  buffer_load_dwordx4 v[164:167], v1, s[4:7], s27 offen offset:0 sc1
  buffer_load_dwordx4 v[168:171], v1, s[4:7], s27 offen offset:1024 sc1
  buffer_load_dwordx4 v[172:175], v1, s[4:7], s27 offen offset:2048 sc1
  s_add_u32 s27, s27, 10240
  buffer_load_dwordx4 v[204:207], v1, s[4:7], s27 offen offset:0 sc1
  buffer_load_dwordx4 v[208:211], v1, s[4:7], s27 offen offset:1024 sc1
  buffer_load_dwordx4 v[212:215], v1, s[4:7], s27 offen offset:2048 sc1
  buffer_load_dwordx4 v[216:219], v1, s[4:7], s27 offen offset:3072 sc1
  s_add_u32 s27, s27, 4096
  buffer_load_dwordx4 v[220:223], v1, s[4:7], s27 offen offset:0 sc1
  buffer_load_dwordx4 v[224:227], v1, s[4:7], s27 offen offset:1024 sc1
  buffer_load_dwordx4 v[228:231], v1, s[4:7], s27 offen offset:2048 sc1
  s_add_u32 s27, s27, 10240
  buffer_load_dwordx4 a[4:7], v1, s[4:7], s27 offen offset:0 sc1
  buffer_load_dwordx4 a[8:11], v1, s[4:7], s27 offen offset:1024 sc1
  buffer_load_dwordx4 a[12:15], v1, s[4:7], s27 offen offset:2048 sc1
  buffer_load_dwordx4 a[16:19], v1, s[4:7], s27 offen offset:3072 sc1
  s_add_u32 s27, s27, 4096
  buffer_load_dwordx4 a[20:23], v1, s[4:7], s27 offen offset:0 sc1
  buffer_load_dwordx4 a[24:27], v1, s[4:7], s27 offen offset:1024 sc1
  buffer_load_dwordx4 a[28:31], v1, s[4:7], s27 offen offset:2048 sc1
  s_add_u32 s27, s27, 10240
  buffer_load_dwordx4 a[60:63], v1, s[4:7], s27 offen offset:0 sc1
  buffer_load_dwordx4 a[64:67], v1, s[4:7], s27 offen offset:1024 sc1
  buffer_load_dwordx4 a[68:71], v1, s[4:7], s27 offen offset:2048 sc1
  buffer_load_dwordx4 a[72:75], v1, s[4:7], s27 offen offset:3072 sc1
  s_add_u32 s27, s27, 4096
  buffer_load_dwordx4 a[76:79], v1, s[4:7], s27 offen offset:0 sc1
  buffer_load_dwordx4 a[80:83], v1, s[4:7], s27 offen offset:1024 sc1
  buffer_load_dwordx4 a[84:87], v1, s[4:7], s27 offen offset:2048 sc1
  s_add_u32 s27, s27, 10240
  buffer_load_dwordx4 a[116:119], v1, s[4:7], s27 offen offset:0 sc1
  buffer_load_dwordx4 a[120:123], v1, s[4:7], s27 offen offset:1024 sc1
  buffer_load_dwordx4 a[124:127], v1, s[4:7], s27 offen offset:2048 sc1
  buffer_load_dwordx4 a[128:131], v1, s[4:7], s27 offen offset:3072 sc1
  s_add_u32 s27, s27, 4096
  buffer_load_dwordx4 a[132:135], v1, s[4:7], s27 offen offset:0 sc1
  buffer_load_dwordx4 a[136:139], v1, s[4:7], s27 offen offset:1024 sc1
  buffer_load_dwordx4 a[140:143], v1, s[4:7], s27 offen offset:2048 sc1
  s_add_u32 s27, s27, 10240
  buffer_load_dwordx4 a[172:175], v1, s[4:7], s27 offen offset:0 sc1
  buffer_load_dwordx4 a[176:179], v1, s[4:7], s27 offen offset:1024 sc1
  buffer_load_dwordx4 a[180:183], v1, s[4:7], s27 offen offset:2048 sc1
  buffer_load_dwordx4 a[184:187], v1, s[4:7], s27 offen offset:3072 sc1
  s_add_u32 s27, s27, 4096
  buffer_load_dwordx4 a[188:191], v1, s[4:7], s27 offen offset:0 sc1
  buffer_load_dwordx4 a[192:195], v1, s[4:7], s27 offen offset:1024 sc1
  buffer_load_dwordx4 a[196:199], v1, s[4:7], s27 offen offset:2048 sc1
  s_add_u32 s27, s27, 10240
  buffer_load_dwordx4 a[228:231], v1, s[4:7], s27 offen offset:0 sc1
  buffer_load_dwordx4 a[232:235], v1, s[4:7], s27 offen offset:1024 sc1
  buffer_load_dwordx4 a[236:239], v1, s[4:7], s27 offen offset:2048 sc1
  buffer_load_dwordx4 a[240:243], v1, s[4:7], s27 offen offset:3072 sc1
  s_add_u32 s27, s27, 4096
  buffer_load_dwordx4 a[244:247], v1, s[4:7], s27 offen offset:0 sc1
  buffer_load_dwordx4 a[248:251], v1, s[4:7], s27 offen offset:1024 sc1
  buffer_load_dwordx4 a[252:255], v1, s[4:7], s27 offen offset:2048 sc1
  s_mov_b32 s48, 0
  s_cmp_ge_u32 s42, 16
  s_cbranch_scc1 Luw_W
  v_mul_u32_u24 v92, 928, v2
  v_lshl_add_u32 v92, v3, 4, v92
  s_mul_i32 s26, s20, 7
  s_lshr_b32 s26, s26, 1
  s_lshl_b32 s26, s26, 10
  s_mul_i32 s45, s42, 28672
  s_add_u32 s45, s45, s26
  s_mul_i32 s26, s41, 458752
  s_add_u32 s45, s45, s26
  s_add_u32 s45, s45, 12845056
  s_lshl_b32 s46, s42, 2
  s_lshl_b32 s26, s41, 6
  s_add_u32 s46, s46, s26
  s_add_u32 s46, s46, 72546304
  s_waitcnt vmcnt(0)
Luw_loop_117:
  s_waitcnt vmcnt(8)
  s_barrier
  s_add_u32 s41, s41, 7
  s_add_u32 s43, s43, s47
  s_cmp_ge_u32 s41, 64
  s_cbranch_scc1 Lnx_119
  s_mul_i32 s44, s41, 28672
  s_mul_i32 s26, s20, 7168
  s_add_u32 s44, s44, s26
  s_mov_b64 exec, s[56:57]
  s_add_u32 m0, s43, 0
  s_nop 0
  buffer_load_dwordx4 v1, s[8:11], s44 offen offset:0 lds
  s_add_u32 m0, s43, 32
  s_nop 0
  buffer_load_dwordx4 v1, s[8:11], s44 offen offset:896 lds
  s_add_u32 m0, s43, 64
  s_nop 0
  buffer_load_dwordx4 v1, s[8:11], s44 offen offset:1792 lds
  s_add_u32 m0, s43, 96
  s_nop 0
  buffer_load_dwordx4 v1, s[8:11], s44 offen offset:2688 lds
  s_add_u32 s44, s44, 3584
  s_add_u32 m0, s43, 3712
  s_nop 0
  buffer_load_dwordx4 v1, s[8:11], s44 offen offset:0 lds
  s_add_u32 m0, s43, 3744
  s_nop 0
  buffer_load_dwordx4 v1, s[8:11], s44 offen offset:896 lds
  s_add_u32 m0, s43, 3776
  s_nop 0
  buffer_load_dwordx4 v1, s[8:11], s44 offen offset:1792 lds
  s_add_u32 m0, s43, 3808
  s_nop 0
  buffer_load_dwordx4 v1, s[8:11], s44 offen offset:2688 lds
  s_mov_b64 exec, -1
Lnx_119:
  ds_read_b128 v[60:63], v92 offset:0
  ds_read_b128 v[64:67], v92 offset:14848
  ds_read_b128 v[68:71], v92 offset:64
  ds_read_b128 v[72:75], v92 offset:14912
  s_waitcnt lgkmcnt(2)
  v_mfma_f32_16x16x32_bf16 v[4:7], v[120:123], v[60:63], 0
  v_mfma_f32_16x16x32_bf16 v[8:11], v[120:123], v[64:67], 0
  v_mfma_f32_16x16x32_bf16 v[12:15], v[176:179], v[60:63], 0
  v_mfma_f32_16x16x32_bf16 v[16:19], v[176:179], v[64:67], 0
  ds_read_b128 v[76:79], v92 offset:128
  ds_read_b128 v[80:83], v92 offset:14976
  v_mfma_f32_16x16x32_bf16 v[20:23], v[232:235], v[60:63], 0
  v_mfma_f32_16x16x32_bf16 v[24:27], v[232:235], v[64:67], 0
  v_mfma_f32_16x16x32_bf16 v[28:31], a[32:35], v[60:63], 0
  v_mfma_f32_16x16x32_bf16 v[32:35], a[32:35], v[64:67], 0
  v_mfma_f32_16x16x32_bf16 v[36:39], a[88:91], v[60:63], 0
  v_mfma_f32_16x16x32_bf16 v[40:43], a[88:91], v[64:67], 0
  v_mfma_f32_16x16x32_bf16 v[44:47], a[144:147], v[60:63], 0
  v_mfma_f32_16x16x32_bf16 v[48:51], a[144:147], v[64:67], 0
  v_mfma_f32_16x16x32_bf16 v[52:55], a[200:203], v[60:63], 0
  v_mfma_f32_16x16x32_bf16 v[56:59], a[200:203], v[64:67], 0
  s_waitcnt lgkmcnt(2)
  v_mfma_f32_16x16x32_bf16 v[4:7], v[124:127], v[68:71], v[4:7]
  v_mfma_f32_16x16x32_bf16 v[8:11], v[124:127], v[72:75], v[8:11]
  v_mfma_f32_16x16x32_bf16 v[12:15], v[180:183], v[68:71], v[12:15]
  v_mfma_f32_16x16x32_bf16 v[16:19], v[180:183], v[72:75], v[16:19]
  ds_read_b128 v[60:63], v92 offset:192
  ds_read_b128 v[64:67], v92 offset:15040
  v_mfma_f32_16x16x32_bf16 v[20:23], v[236:239], v[68:71], v[20:23]
  v_mfma_f32_16x16x32_bf16 v[24:27], v[236:239], v[72:75], v[24:27]
  v_mfma_f32_16x16x32_bf16 v[28:31], a[36:39], v[68:71], v[28:31]
  v_mfma_f32_16x16x32_bf16 v[32:35], a[36:39], v[72:75], v[32:35]
  v_mfma_f32_16x16x32_bf16 v[36:39], a[92:95], v[68:71], v[36:39]
  v_mfma_f32_16x16x32_bf16 v[40:43], a[92:95], v[72:75], v[40:43]
  v_mfma_f32_16x16x32_bf16 v[44:47], a[148:151], v[68:71], v[44:47]
  v_mfma_f32_16x16x32_bf16 v[48:51], a[148:151], v[72:75], v[48:51]
  v_mfma_f32_16x16x32_bf16 v[52:55], a[204:207], v[68:71], v[52:55]
  v_mfma_f32_16x16x32_bf16 v[56:59], a[204:207], v[72:75], v[56:59]
  s_waitcnt lgkmcnt(2)
  v_mfma_f32_16x16x32_bf16 v[4:7], v[128:131], v[76:79], v[4:7]
  v_mfma_f32_16x16x32_bf16 v[8:11], v[128:131], v[80:83], v[8:11]
  v_mfma_f32_16x16x32_bf16 v[12:15], v[184:187], v[76:79], v[12:15]
  v_mfma_f32_16x16x32_bf16 v[16:19], v[184:187], v[80:83], v[16:19]
  ds_read_b128 v[68:71], v92 offset:256
  ds_read_b128 v[72:75], v92 offset:15104
  v_mfma_f32_16x16x32_bf16 v[20:23], v[240:243], v[76:79], v[20:23]
  v_mfma_f32_16x16x32_bf16 v[24:27], v[240:243], v[80:83], v[24:27]
  v_mfma_f32_16x16x32_bf16 v[28:31], a[40:43], v[76:79], v[28:31]
  v_mfma_f32_16x16x32_bf16 v[32:35], a[40:43], v[80:83], v[32:35]
  v_mfma_f32_16x16x32_bf16 v[36:39], a[96:99], v[76:79], v[36:39]
  v_mfma_f32_16x16x32_bf16 v[40:43], a[96:99], v[80:83], v[40:43]
  v_mfma_f32_16x16x32_bf16 v[44:47], a[152:155], v[76:79], v[44:47]
  v_mfma_f32_16x16x32_bf16 v[48:51], a[152:155], v[80:83], v[48:51]
  v_mfma_f32_16x16x32_bf16 v[52:55], a[208:211], v[76:79], v[52:55]
  v_mfma_f32_16x16x32_bf16 v[56:59], a[208:211], v[80:83], v[56:59]
  s_waitcnt lgkmcnt(2)
  v_mfma_f32_16x16x32_bf16 v[4:7], v[132:135], v[60:63], v[4:7]
  v_mfma_f32_16x16x32_bf16 v[8:11], v[132:135], v[64:67], v[8:11]
  v_mfma_f32_16x16x32_bf16 v[12:15], v[188:191], v[60:63], v[12:15]
  v_mfma_f32_16x16x32_bf16 v[16:19], v[188:191], v[64:67], v[16:19]
  ds_read_b128 v[76:79], v92 offset:320
  ds_read_b128 v[80:83], v92 offset:15168
  v_mfma_f32_16x16x32_bf16 v[20:23], v[244:247], v[60:63], v[20:23]
  v_mfma_f32_16x16x32_bf16 v[24:27], v[244:247], v[64:67], v[24:27]
  v_mfma_f32_16x16x32_bf16 v[28:31], a[44:47], v[60:63], v[28:31]
  v_mfma_f32_16x16x32_bf16 v[32:35], a[44:47], v[64:67], v[32:35]
  v_mfma_f32_16x16x32_bf16 v[36:39], a[100:103], v[60:63], v[36:39]
  v_mfma_f32_16x16x32_bf16 v[40:43], a[100:103], v[64:67], v[40:43]
  v_mfma_f32_16x16x32_bf16 v[44:47], a[156:159], v[60:63], v[44:47]
  v_mfma_f32_16x16x32_bf16 v[48:51], a[156:159], v[64:67], v[48:51]
  v_mfma_f32_16x16x32_bf16 v[52:55], a[212:215], v[60:63], v[52:55]
  v_mfma_f32_16x16x32_bf16 v[56:59], a[212:215], v[64:67], v[56:59]
  s_waitcnt lgkmcnt(2)
  v_mfma_f32_16x16x32_bf16 v[4:7], v[136:139], v[68:71], v[4:7]
  v_mfma_f32_16x16x32_bf16 v[8:11], v[136:139], v[72:75], v[8:11]
  v_mfma_f32_16x16x32_bf16 v[12:15], v[192:195], v[68:71], v[12:15]
  v_mfma_f32_16x16x32_bf16 v[16:19], v[192:195], v[72:75], v[16:19]
  ds_read_b128 v[60:63], v92 offset:384
  ds_read_b128 v[64:67], v92 offset:15232
  v_mfma_f32_16x16x32_bf16 v[20:23], v[248:251], v[68:71], v[20:23]
  v_mfma_f32_16x16x32_bf16 v[24:27], v[248:251], v[72:75], v[24:27]
  v_mfma_f32_16x16x32_bf16 v[28:31], a[48:51], v[68:71], v[28:31]
  v_mfma_f32_16x16x32_bf16 v[32:35], a[48:51], v[72:75], v[32:35]
  v_mfma_f32_16x16x32_bf16 v[36:39], a[104:107], v[68:71], v[36:39]
  v_mfma_f32_16x16x32_bf16 v[40:43], a[104:107], v[72:75], v[40:43]
  v_mfma_f32_16x16x32_bf16 v[44:47], a[160:163], v[68:71], v[44:47]
  v_mfma_f32_16x16x32_bf16 v[48:51], a[160:163], v[72:75], v[48:51]
  v_mfma_f32_16x16x32_bf16 v[52:55], a[216:219], v[68:71], v[52:55]
  v_mfma_f32_16x16x32_bf16 v[56:59], a[216:219], v[72:75], v[56:59]
  s_waitcnt lgkmcnt(2)
  v_mfma_f32_16x16x32_bf16 v[4:7], v[140:143], v[76:79], v[4:7]
  v_mfma_f32_16x16x32_bf16 v[8:11], v[140:143], v[80:83], v[8:11]
  v_mfma_f32_16x16x32_bf16 v[12:15], v[196:199], v[76:79], v[12:15]
  v_mfma_f32_16x16x32_bf16 v[16:19], v[196:199], v[80:83], v[16:19]
  ds_read_b128 v[68:71], v92 offset:448
  ds_read_b128 v[72:75], v92 offset:15296
  v_mfma_f32_16x16x32_bf16 v[20:23], v[252:255], v[76:79], v[20:23]
  v_mfma_f32_16x16x32_bf16 v[24:27], v[252:255], v[80:83], v[24:27]
  v_mfma_f32_16x16x32_bf16 v[28:31], a[52:55], v[76:79], v[28:31]
  v_mfma_f32_16x16x32_bf16 v[32:35], a[52:55], v[80:83], v[32:35]
  v_mfma_f32_16x16x32_bf16 v[36:39], a[108:111], v[76:79], v[36:39]
  v_mfma_f32_16x16x32_bf16 v[40:43], a[108:111], v[80:83], v[40:43]
  v_mfma_f32_16x16x32_bf16 v[44:47], a[164:167], v[76:79], v[44:47]
  v_mfma_f32_16x16x32_bf16 v[48:51], a[164:167], v[80:83], v[48:51]
  v_mfma_f32_16x16x32_bf16 v[52:55], a[220:223], v[76:79], v[52:55]
  v_mfma_f32_16x16x32_bf16 v[56:59], a[220:223], v[80:83], v[56:59]
  s_waitcnt lgkmcnt(2)
  v_mfma_f32_16x16x32_bf16 v[4:7], v[144:147], v[60:63], v[4:7]
  v_mfma_f32_16x16x32_bf16 v[8:11], v[144:147], v[64:67], v[8:11]
  v_mfma_f32_16x16x32_bf16 v[12:15], v[200:203], v[60:63], v[12:15]
  v_mfma_f32_16x16x32_bf16 v[16:19], v[200:203], v[64:67], v[16:19]
  ds_read_b128 v[76:79], v92 offset:512
  ds_read_b128 v[80:83], v92 offset:15360
  v_mfma_f32_16x16x32_bf16 v[20:23], a[0:3], v[60:63], v[20:23]
  v_mfma_f32_16x16x32_bf16 v[24:27], a[0:3], v[64:67], v[24:27]
  v_mfma_f32_16x16x32_bf16 v[28:31], a[56:59], v[60:63], v[28:31]
  v_mfma_f32_16x16x32_bf16 v[32:35], a[56:59], v[64:67], v[32:35]
  v_mfma_f32_16x16x32_bf16 v[36:39], a[112:115], v[60:63], v[36:39]
  v_mfma_f32_16x16x32_bf16 v[40:43], a[112:115], v[64:67], v[40:43]
  v_mfma_f32_16x16x32_bf16 v[44:47], a[168:171], v[60:63], v[44:47]
  v_mfma_f32_16x16x32_bf16 v[48:51], a[168:171], v[64:67], v[48:51]
  v_mfma_f32_16x16x32_bf16 v[52:55], a[224:227], v[60:63], v[52:55]
  v_mfma_f32_16x16x32_bf16 v[56:59], a[224:227], v[64:67], v[56:59]
  s_cmp_eq_u32 s48, 0
  s_cbranch_scc1 Lnf_118
  s_cmp_lt_u32 s41, 64
  s_cbranch_scc1 Lnf_118a
  s_waitcnt vmcnt(0)
Lnf_118a:
  s_waitcnt vmcnt(8)
  s_barrier
  s_cmp_lg_u32 s20, 0
  s_cbranch_scc1 Lsf_121
  s_mov_b64 exec, 1
  buffer_store_dword v113, v112, s[4:7], s46 offen sc1
  s_mov_b64 exec, -1
Lsf_121:
  s_add_u32 s46, s46, 448
Lnf_118:
  s_waitcnt lgkmcnt(2)
  v_mfma_f32_16x16x32_bf16 v[4:7], v[148:151], v[68:71], v[4:7]
  v_mfma_f32_16x16x32_bf16 v[8:11], v[148:151], v[72:75], v[8:11]
  v_mfma_f32_16x16x32_bf16 v[12:15], v[204:207], v[68:71], v[12:15]
  v_mfma_f32_16x16x32_bf16 v[16:19], v[204:207], v[72:75], v[16:19]
  ds_read_b128 v[60:63], v92 offset:576
  ds_read_b128 v[64:67], v92 offset:15424
  v_mfma_f32_16x16x32_bf16 v[20:23], a[4:7], v[68:71], v[20:23]
  v_mfma_f32_16x16x32_bf16 v[24:27], a[4:7], v[72:75], v[24:27]
  v_mfma_f32_16x16x32_bf16 v[28:31], a[60:63], v[68:71], v[28:31]
  v_mfma_f32_16x16x32_bf16 v[32:35], a[60:63], v[72:75], v[32:35]
  v_mfma_f32_16x16x32_bf16 v[36:39], a[116:119], v[68:71], v[36:39]
  v_mfma_f32_16x16x32_bf16 v[40:43], a[116:119], v[72:75], v[40:43]
  v_mfma_f32_16x16x32_bf16 v[44:47], a[172:175], v[68:71], v[44:47]
  v_mfma_f32_16x16x32_bf16 v[48:51], a[172:175], v[72:75], v[48:51]
  v_mfma_f32_16x16x32_bf16 v[52:55], a[228:231], v[68:71], v[52:55]
  v_mfma_f32_16x16x32_bf16 v[56:59], a[228:231], v[72:75], v[56:59]
  s_waitcnt lgkmcnt(2)
  v_mfma_f32_16x16x32_bf16 v[4:7], v[152:155], v[76:79], v[4:7]
  v_mfma_f32_16x16x32_bf16 v[8:11], v[152:155], v[80:83], v[8:11]
  v_mfma_f32_16x16x32_bf16 v[12:15], v[208:211], v[76:79], v[12:15]
  v_mfma_f32_16x16x32_bf16 v[16:19], v[208:211], v[80:83], v[16:19]
  ds_read_b128 v[68:71], v92 offset:640
  ds_read_b128 v[72:75], v92 offset:15488
  v_mfma_f32_16x16x32_bf16 v[20:23], a[8:11], v[76:79], v[20:23]
  v_mfma_f32_16x16x32_bf16 v[24:27], a[8:11], v[80:83], v[24:27]
  v_mfma_f32_16x16x32_bf16 v[28:31], a[64:67], v[76:79], v[28:31]
  v_mfma_f32_16x16x32_bf16 v[32:35], a[64:67], v[80:83], v[32:35]
  v_mfma_f32_16x16x32_bf16 v[36:39], a[120:123], v[76:79], v[36:39]
  v_mfma_f32_16x16x32_bf16 v[40:43], a[120:123], v[80:83], v[40:43]
  v_mfma_f32_16x16x32_bf16 v[44:47], a[176:179], v[76:79], v[44:47]
  v_mfma_f32_16x16x32_bf16 v[48:51], a[176:179], v[80:83], v[48:51]
  v_mfma_f32_16x16x32_bf16 v[52:55], a[232:235], v[76:79], v[52:55]
  v_mfma_f32_16x16x32_bf16 v[56:59], a[232:235], v[80:83], v[56:59]
  s_waitcnt lgkmcnt(2)
  v_mfma_f32_16x16x32_bf16 v[4:7], v[156:159], v[60:63], v[4:7]
  v_mfma_f32_16x16x32_bf16 v[8:11], v[156:159], v[64:67], v[8:11]
  v_mfma_f32_16x16x32_bf16 v[12:15], v[212:215], v[60:63], v[12:15]
  v_mfma_f32_16x16x32_bf16 v[16:19], v[212:215], v[64:67], v[16:19]
  ds_read_b128 v[76:79], v92 offset:704
  ds_read_b128 v[80:83], v92 offset:15552
  v_mfma_f32_16x16x32_bf16 v[20:23], a[12:15], v[60:63], v[20:23]
  v_mfma_f32_16x16x32_bf16 v[24:27], a[12:15], v[64:67], v[24:27]
  v_mfma_f32_16x16x32_bf16 v[28:31], a[68:71], v[60:63], v[28:31]
  v_mfma_f32_16x16x32_bf16 v[32:35], a[68:71], v[64:67], v[32:35]
  v_mfma_f32_16x16x32_bf16 v[36:39], a[124:127], v[60:63], v[36:39]
  v_mfma_f32_16x16x32_bf16 v[40:43], a[124:127], v[64:67], v[40:43]
  v_mfma_f32_16x16x32_bf16 v[44:47], a[180:183], v[60:63], v[44:47]
  v_mfma_f32_16x16x32_bf16 v[48:51], a[180:183], v[64:67], v[48:51]
  v_mfma_f32_16x16x32_bf16 v[52:55], a[236:239], v[60:63], v[52:55]
  v_mfma_f32_16x16x32_bf16 v[56:59], a[236:239], v[64:67], v[56:59]
  s_waitcnt lgkmcnt(2)
  v_mfma_f32_16x16x32_bf16 v[4:7], v[160:163], v[68:71], v[4:7]
  v_mfma_f32_16x16x32_bf16 v[8:11], v[160:163], v[72:75], v[8:11]
  v_mfma_f32_16x16x32_bf16 v[12:15], v[216:219], v[68:71], v[12:15]
  v_mfma_f32_16x16x32_bf16 v[16:19], v[216:219], v[72:75], v[16:19]
  ds_read_b128 v[60:63], v92 offset:768
  ds_read_b128 v[64:67], v92 offset:15616
  v_mfma_f32_16x16x32_bf16 v[20:23], a[16:19], v[68:71], v[20:23]
  v_mfma_f32_16x16x32_bf16 v[24:27], a[16:19], v[72:75], v[24:27]
  v_mfma_f32_16x16x32_bf16 v[28:31], a[72:75], v[68:71], v[28:31]
  v_mfma_f32_16x16x32_bf16 v[32:35], a[72:75], v[72:75], v[32:35]
  v_mfma_f32_16x16x32_bf16 v[36:39], a[128:131], v[68:71], v[36:39]
  v_mfma_f32_16x16x32_bf16 v[40:43], a[128:131], v[72:75], v[40:43]
  v_mfma_f32_16x16x32_bf16 v[44:47], a[184:187], v[68:71], v[44:47]
  v_mfma_f32_16x16x32_bf16 v[48:51], a[184:187], v[72:75], v[48:51]
  v_mfma_f32_16x16x32_bf16 v[52:55], a[240:243], v[68:71], v[52:55]
  v_mfma_f32_16x16x32_bf16 v[56:59], a[240:243], v[72:75], v[56:59]
  s_waitcnt lgkmcnt(2)
  v_mfma_f32_16x16x32_bf16 v[4:7], v[164:167], v[76:79], v[4:7]
  v_mfma_f32_16x16x32_bf16 v[8:11], v[164:167], v[80:83], v[8:11]
  v_mfma_f32_16x16x32_bf16 v[12:15], v[220:223], v[76:79], v[12:15]
  v_mfma_f32_16x16x32_bf16 v[16:19], v[220:223], v[80:83], v[16:19]
  ds_read_b128 v[68:71], v92 offset:832
  ds_read_b128 v[72:75], v92 offset:15680
  v_mfma_f32_16x16x32_bf16 v[20:23], a[20:23], v[76:79], v[20:23]
  v_mfma_f32_16x16x32_bf16 v[24:27], a[20:23], v[80:83], v[24:27]
  v_mfma_f32_16x16x32_bf16 v[28:31], a[76:79], v[76:79], v[28:31]
  v_mfma_f32_16x16x32_bf16 v[32:35], a[76:79], v[80:83], v[32:35]
  v_mfma_f32_16x16x32_bf16 v[36:39], a[132:135], v[76:79], v[36:39]
  v_mfma_f32_16x16x32_bf16 v[40:43], a[132:135], v[80:83], v[40:43]
  v_mfma_f32_16x16x32_bf16 v[44:47], a[188:191], v[76:79], v[44:47]
  v_mfma_f32_16x16x32_bf16 v[48:51], a[188:191], v[80:83], v[48:51]
  v_mfma_f32_16x16x32_bf16 v[52:55], a[244:247], v[76:79], v[52:55]
  v_mfma_f32_16x16x32_bf16 v[56:59], a[244:247], v[80:83], v[56:59]
  s_waitcnt lgkmcnt(2)
  v_mfma_f32_16x16x32_bf16 v[4:7], v[168:171], v[60:63], v[4:7]
  v_mfma_f32_16x16x32_bf16 v[8:11], v[168:171], v[64:67], v[8:11]
  v_mfma_f32_16x16x32_bf16 v[12:15], v[224:227], v[60:63], v[12:15]
  v_mfma_f32_16x16x32_bf16 v[16:19], v[224:227], v[64:67], v[16:19]
  v_mfma_f32_16x16x32_bf16 v[20:23], a[24:27], v[60:63], v[20:23]
  v_mfma_f32_16x16x32_bf16 v[24:27], a[24:27], v[64:67], v[24:27]
  v_mfma_f32_16x16x32_bf16 v[28:31], a[80:83], v[60:63], v[28:31]
  v_mfma_f32_16x16x32_bf16 v[32:35], a[80:83], v[64:67], v[32:35]
  v_mfma_f32_16x16x32_bf16 v[36:39], a[136:139], v[60:63], v[36:39]
  v_mfma_f32_16x16x32_bf16 v[40:43], a[136:139], v[64:67], v[40:43]
  v_mfma_f32_16x16x32_bf16 v[44:47], a[192:195], v[60:63], v[44:47]
  v_mfma_f32_16x16x32_bf16 v[48:51], a[192:195], v[64:67], v[48:51]
  v_mfma_f32_16x16x32_bf16 v[52:55], a[248:251], v[60:63], v[52:55]
  v_mfma_f32_16x16x32_bf16 v[56:59], a[248:251], v[64:67], v[56:59]
  s_waitcnt lgkmcnt(0)
  v_mfma_f32_16x16x32_bf16 v[4:7], v[172:175], v[68:71], v[4:7]
  v_mfma_f32_16x16x32_bf16 v[8:11], v[172:175], v[72:75], v[8:11]
  v_mfma_f32_16x16x32_bf16 v[12:15], v[228:231], v[68:71], v[12:15]
  v_mfma_f32_16x16x32_bf16 v[16:19], v[228:231], v[72:75], v[16:19]
  v_mfma_f32_16x16x32_bf16 v[20:23], a[28:31], v[68:71], v[20:23]
  v_mfma_f32_16x16x32_bf16 v[24:27], a[28:31], v[72:75], v[24:27]
  v_mfma_f32_16x16x32_bf16 v[28:31], a[84:87], v[68:71], v[28:31]
  v_mfma_f32_16x16x32_bf16 v[32:35], a[84:87], v[72:75], v[32:35]
  v_mfma_f32_16x16x32_bf16 v[36:39], a[140:143], v[68:71], v[36:39]
  v_mfma_f32_16x16x32_bf16 v[40:43], a[140:143], v[72:75], v[40:43]
  v_mfma_f32_16x16x32_bf16 v[44:47], a[196:199], v[68:71], v[44:47]
  v_mfma_f32_16x16x32_bf16 v[48:51], a[196:199], v[72:75], v[48:51]
  v_mfma_f32_16x16x32_bf16 v[52:55], a[252:255], v[68:71], v[52:55]
  v_mfma_f32_16x16x32_bf16 v[56:59], a[252:255], v[72:75], v[56:59]
  v_add_u32 v92, s47, v92
  s_sub_u32 s47, 0, s47
  s_add_u32 s26, s45, 14336
  s_bitcmp1_b32 s20, 0
  s_cbranch_scc1 Lodd_122
  v_cvt_pk_bf16_f32 v60, v4, v5
  v_cvt_pk_bf16_f32 v61, v6, v7
  v_cvt_pk_bf16_f32 v62, v12, v13
  v_cvt_pk_bf16_f32 v63, v14, v15
  buffer_store_dwordx4 v[60:63], v1, s[4:7], s45 offen offset:0 sc1
  v_cvt_pk_bf16_f32 v64, v20, v21
  v_cvt_pk_bf16_f32 v65, v22, v23
  v_cvt_pk_bf16_f32 v66, v28, v29
  v_cvt_pk_bf16_f32 v67, v30, v31
  buffer_store_dwordx4 v[64:67], v1, s[4:7], s45 offen offset:1024 sc1
  v_cvt_pk_bf16_f32 v68, v36, v37
  v_cvt_pk_bf16_f32 v69, v38, v39
  v_cvt_pk_bf16_f32 v70, v44, v45
  v_cvt_pk_bf16_f32 v71, v46, v47
  buffer_store_dwordx4 v[68:71], v1, s[4:7], s45 offen offset:2048 sc1
  v_cvt_pk_bf16_f32 v72, v52, v53
  v_cvt_pk_bf16_f32 v73, v54, v55
  buffer_store_dwordx2 v[72:73], v1, s[4:7], s45 offen offset:3072 sc1
  v_cvt_pk_bf16_f32 v76, v8, v9
  v_cvt_pk_bf16_f32 v77, v10, v11
  v_cvt_pk_bf16_f32 v78, v16, v17
  v_cvt_pk_bf16_f32 v79, v18, v19
  buffer_store_dwordx4 v[76:79], v1, s[4:7], s26 offen offset:0 sc1
  v_cvt_pk_bf16_f32 v80, v24, v25
  v_cvt_pk_bf16_f32 v81, v26, v27
  v_cvt_pk_bf16_f32 v82, v32, v33
  v_cvt_pk_bf16_f32 v83, v34, v35
  buffer_store_dwordx4 v[80:83], v1, s[4:7], s26 offen offset:1024 sc1
  v_cvt_pk_bf16_f32 v60, v40, v41
  v_cvt_pk_bf16_f32 v61, v42, v43
  v_cvt_pk_bf16_f32 v62, v48, v49
  v_cvt_pk_bf16_f32 v63, v50, v51
  buffer_store_dwordx4 v[60:63], v1, s[4:7], s26 offen offset:2048 sc1
  v_cvt_pk_bf16_f32 v64, v56, v57
  v_cvt_pk_bf16_f32 v65, v58, v59
  buffer_store_dwordx2 v[64:65], v1, s[4:7], s26 offen offset:3072 sc1
  s_branch Ljn_123
Lodd_122:
  v_cvt_pk_bf16_f32 v60, v4, v5
  v_cvt_pk_bf16_f32 v61, v6, v7
  buffer_store_dwordx2 v[60:61], v1, s[4:7], s45 offen offset:8 sc1
  v_cvt_pk_bf16_f32 v64, v12, v13
  v_cvt_pk_bf16_f32 v65, v14, v15
  v_cvt_pk_bf16_f32 v66, v20, v21
  v_cvt_pk_bf16_f32 v67, v22, v23
  buffer_store_dwordx4 v[64:67], v1, s[4:7], s45 offen offset:1024 sc1
  v_cvt_pk_bf16_f32 v68, v28, v29
  v_cvt_pk_bf16_f32 v69, v30, v31
  v_cvt_pk_bf16_f32 v70, v36, v37
  v_cvt_pk_bf16_f32 v71, v38, v39
  buffer_store_dwordx4 v[68:71], v1, s[4:7], s45 offen offset:2048 sc1
  v_cvt_pk_bf16_f32 v72, v44, v45
  v_cvt_pk_bf16_f32 v73, v46, v47
  v_cvt_pk_bf16_f32 v74, v52, v53
  v_cvt_pk_bf16_f32 v75, v54, v55
  buffer_store_dwordx4 v[72:75], v1, s[4:7], s45 offen offset:3072 sc1
  v_cvt_pk_bf16_f32 v76, v8, v9
  v_cvt_pk_bf16_f32 v77, v10, v11
  buffer_store_dwordx2 v[76:77], v1, s[4:7], s26 offen offset:8 sc1
  v_cvt_pk_bf16_f32 v80, v16, v17
  v_cvt_pk_bf16_f32 v81, v18, v19
  v_cvt_pk_bf16_f32 v82, v24, v25
  v_cvt_pk_bf16_f32 v83, v26, v27
  buffer_store_dwordx4 v[80:83], v1, s[4:7], s26 offen offset:1024 sc1
  v_cvt_pk_bf16_f32 v60, v32, v33
  v_cvt_pk_bf16_f32 v61, v34, v35
  v_cvt_pk_bf16_f32 v62, v40, v41
  v_cvt_pk_bf16_f32 v63, v42, v43
  buffer_store_dwordx4 v[60:63], v1, s[4:7], s26 offen offset:2048 sc1
  v_cvt_pk_bf16_f32 v64, v48, v49
  v_cvt_pk_bf16_f32 v65, v50, v51
  v_cvt_pk_bf16_f32 v66, v56, v57
  v_cvt_pk_bf16_f32 v67, v58, v59
  buffer_store_dwordx4 v[64:67], v1, s[4:7], s26 offen offset:3072 sc1
Ljn_123:
  s_add_u32 s45, s45, 3211264
  s_add_u32 s48, s48, 1
  s_cmp_lt_u32 s41, 64
  s_cbranch_scc1 Luw_loop_117
  s_waitcnt vmcnt(0)
  s_barrier
  s_cmp_lg_u32 s20, 0
  s_cbranch_scc1 Lsf_124
  s_mov_b64 exec, 1
  buffer_store_dword v113, v112, s[4:7], s46 offen sc1
  s_mov_b64 exec, -1
Lsf_124:
  s_branch Luw_done
Luw_W:
  v_lshrrev_b32 v92, 2, v2
  v_lshlrev_b32 v92, 3, v92
  v_and_b32 v100, 3, v2
  v_add_u32 v92, v92, v100
  v_mul_u32_u24 v92, 928, v92
  v_lshl_add_u32 v92, v3, 4, v92
  v_add_u32 v100, 0, v2
  v_mul_u32_u24 v101, 0x925, v100
  v_lshrrev_b32 v101, 16, v101
  v_mul_u32_u24 v102, 28, v101
  v_sub_u32 v100, v100, v102
  v_mul_u32_u24 v101, 1792, v101
  v_lshl_add_u32 v100, v100, 4, v101
  v_mul_u32_u24 v101, 448, v3
  v_add_u32 v84, v100, v101
  v_add_u32 v100, 16, v2
  v_mul_u32_u24 v101, 0x925, v100
  v_lshrrev_b32 v101, 16, v101
  v_mul_u32_u24 v102, 28, v101
  v_sub_u32 v100, v100, v102
  v_mul_u32_u24 v101, 1792, v101
  v_lshl_add_u32 v100, v100, 4, v101
  v_mul_u32_u24 v101, 448, v3
  v_add_u32 v85, v100, v101
  v_add_u32 v100, 32, v2
  v_mul_u32_u24 v101, 0x925, v100
  v_lshrrev_b32 v101, 16, v101
  v_mul_u32_u24 v102, 28, v101
  v_sub_u32 v100, v100, v102
  v_mul_u32_u24 v101, 1792, v101
  v_lshl_add_u32 v100, v100, 4, v101
  v_mul_u32_u24 v101, 448, v3
  v_add_u32 v86, v100, v101
  v_add_u32 v100, 48, v2
  v_mul_u32_u24 v101, 0x925, v100
  v_lshrrev_b32 v101, 16, v101
  v_mul_u32_u24 v102, 28, v101
  v_sub_u32 v100, v100, v102
  v_mul_u32_u24 v101, 1792, v101
  v_lshl_add_u32 v100, v100, 4, v101
  v_mul_u32_u24 v101, 448, v3
  v_add_u32 v87, v100, v101
  v_add_u32 v100, 64, v2
  v_mul_u32_u24 v101, 0x925, v100
  v_lshrrev_b32 v101, 16, v101
  v_mul_u32_u24 v102, 28, v101
  v_sub_u32 v100, v100, v102
  v_mul_u32_u24 v101, 1792, v101
  v_lshl_add_u32 v100, v100, 4, v101
  v_mul_u32_u24 v101, 448, v3
  v_add_u32 v88, v100, v101
  v_add_u32 v100, 80, v2
  v_mul_u32_u24 v101, 0x925, v100
  v_lshrrev_b32 v101, 16, v101
  v_mul_u32_u24 v102, 28, v101
  v_sub_u32 v100, v100, v102
  v_mul_u32_u24 v101, 1792, v101
  v_lshl_add_u32 v100, v100, 4, v101
  v_mul_u32_u24 v101, 448, v3
  v_add_u32 v89, v100, v101
  v_add_u32 v100, 96, v2
  v_mul_u32_u24 v101, 0x925, v100
  v_lshrrev_b32 v101, 16, v101
  v_mul_u32_u24 v102, 28, v101
  v_sub_u32 v100, v100, v102
  v_mul_u32_u24 v101, 1792, v101
  v_lshl_add_u32 v100, v100, 4, v101
  v_mul_u32_u24 v101, 448, v3
  v_add_u32 v90, v100, v101
  s_sub_u32 s27, s42, 16
  s_lshl_b32 s26, s27, 6
  s_add_u32 s26, s26, s41
  s_mul_i32 s45, s26, 28672
  s_lshl_b32 s46, s26, 2
  s_add_u32 s46, s46, 72538112
  s_mul_i32 s26, s20, 7168
  s_add_u32 s45, s45, s26
  s_add_u32 s45, s45, 42205184
  s_waitcnt vmcnt(0)
Luw_loop_125:
  s_waitcnt vmcnt(7)
  s_barrier
  s_add_u32 s41, s41, 7
  s_add_u32 s43, s43, s47
  s_cmp_ge_u32 s41, 64
  s_cbranch_scc1 Lnx_127
  s_mul_i32 s44, s41, 28672
  s_mul_i32 s26, s20, 7168
  s_add_u32 s44, s44, s26
  s_mov_b64 exec, s[56:57]
  s_add_u32 m0, s43, 0
  s_nop 0
  buffer_load_dwordx4 v1, s[8:11], s44 offen offset:0 lds
  s_add_u32 m0, s43, 32
  s_nop 0
  buffer_load_dwordx4 v1, s[8:11], s44 offen offset:896 lds
  s_add_u32 m0, s43, 64
  s_nop 0
  buffer_load_dwordx4 v1, s[8:11], s44 offen offset:1792 lds
  s_add_u32 m0, s43, 96
  s_nop 0
  buffer_load_dwordx4 v1, s[8:11], s44 offen offset:2688 lds
  s_add_u32 s44, s44, 3584
  s_add_u32 m0, s43, 3712
  s_nop 0
  buffer_load_dwordx4 v1, s[8:11], s44 offen offset:0 lds
  s_add_u32 m0, s43, 3744
  s_nop 0
  buffer_load_dwordx4 v1, s[8:11], s44 offen offset:896 lds
  s_add_u32 m0, s43, 3776
  s_nop 0
  buffer_load_dwordx4 v1, s[8:11], s44 offen offset:1792 lds
  s_add_u32 m0, s43, 3808
  s_nop 0
  buffer_load_dwordx4 v1, s[8:11], s44 offen offset:2688 lds
  s_mov_b64 exec, -1
Lnx_127:
  ds_read_b128 v[60:63], v92 offset:0
  ds_read_b128 v[64:67], v92 offset:3712
  ds_read_b128 v[68:71], v92 offset:64
  ds_read_b128 v[72:75], v92 offset:3776
  s_waitcnt lgkmcnt(2)
  v_mfma_f32_16x16x32_bf16 v[4:7], v[60:63], v[120:123], 0
  v_mfma_f32_16x16x32_bf16 v[8:11], v[64:67], v[120:123], 0
  v_mfma_f32_16x16x32_bf16 v[12:15], v[60:63], v[176:179], 0
  v_mfma_f32_16x16x32_bf16 v[16:19], v[64:67], v[176:179], 0
  ds_read_b128 v[76:79], v92 offset:128
  ds_read_b128 v[80:83], v92 offset:3840
  v_mfma_f32_16x16x32_bf16 v[20:23], v[60:63], v[232:235], 0
  v_mfma_f32_16x16x32_bf16 v[24:27], v[64:67], v[232:235], 0
  v_mfma_f32_16x16x32_bf16 v[28:31], v[60:63], a[32:35], 0
  v_mfma_f32_16x16x32_bf16 v[32:35], v[64:67], a[32:35], 0
  v_mfma_f32_16x16x32_bf16 v[36:39], v[60:63], a[88:91], 0
  v_mfma_f32_16x16x32_bf16 v[40:43], v[64:67], a[88:91], 0
  v_mfma_f32_16x16x32_bf16 v[44:47], v[60:63], a[144:147], 0
  v_mfma_f32_16x16x32_bf16 v[48:51], v[64:67], a[144:147], 0
  v_mfma_f32_16x16x32_bf16 v[52:55], v[60:63], a[200:203], 0
  v_mfma_f32_16x16x32_bf16 v[56:59], v[64:67], a[200:203], 0
  s_waitcnt lgkmcnt(2)
  v_mfma_f32_16x16x32_bf16 v[4:7], v[68:71], v[124:127], v[4:7]
  v_mfma_f32_16x16x32_bf16 v[8:11], v[72:75], v[124:127], v[8:11]
  v_mfma_f32_16x16x32_bf16 v[12:15], v[68:71], v[180:183], v[12:15]
  v_mfma_f32_16x16x32_bf16 v[16:19], v[72:75], v[180:183], v[16:19]
  ds_read_b128 v[60:63], v92 offset:192
  ds_read_b128 v[64:67], v92 offset:3904
  v_mfma_f32_16x16x32_bf16 v[20:23], v[68:71], v[236:239], v[20:23]
  v_mfma_f32_16x16x32_bf16 v[24:27], v[72:75], v[236:239], v[24:27]
  v_mfma_f32_16x16x32_bf16 v[28:31], v[68:71], a[36:39], v[28:31]
  v_mfma_f32_16x16x32_bf16 v[32:35], v[72:75], a[36:39], v[32:35]
  v_mfma_f32_16x16x32_bf16 v[36:39], v[68:71], a[92:95], v[36:39]
  v_mfma_f32_16x16x32_bf16 v[40:43], v[72:75], a[92:95], v[40:43]
  v_mfma_f32_16x16x32_bf16 v[44:47], v[68:71], a[148:151], v[44:47]
  v_mfma_f32_16x16x32_bf16 v[48:51], v[72:75], a[148:151], v[48:51]
  v_mfma_f32_16x16x32_bf16 v[52:55], v[68:71], a[204:207], v[52:55]
  v_mfma_f32_16x16x32_bf16 v[56:59], v[72:75], a[204:207], v[56:59]
  s_waitcnt lgkmcnt(2)
  v_mfma_f32_16x16x32_bf16 v[4:7], v[76:79], v[128:131], v[4:7]
  v_mfma_f32_16x16x32_bf16 v[8:11], v[80:83], v[128:131], v[8:11]
  v_mfma_f32_16x16x32_bf16 v[12:15], v[76:79], v[184:187], v[12:15]
  v_mfma_f32_16x16x32_bf16 v[16:19], v[80:83], v[184:187], v[16:19]
  ds_read_b128 v[68:71], v92 offset:256
  ds_read_b128 v[72:75], v92 offset:3968
  v_mfma_f32_16x16x32_bf16 v[20:23], v[76:79], v[240:243], v[20:23]
  v_mfma_f32_16x16x32_bf16 v[24:27], v[80:83], v[240:243], v[24:27]
  v_mfma_f32_16x16x32_bf16 v[28:31], v[76:79], a[40:43], v[28:31]
  v_mfma_f32_16x16x32_bf16 v[32:35], v[80:83], a[40:43], v[32:35]
  v_mfma_f32_16x16x32_bf16 v[36:39], v[76:79], a[96:99], v[36:39]
  v_mfma_f32_16x16x32_bf16 v[40:43], v[80:83], a[96:99], v[40:43]
  v_mfma_f32_16x16x32_bf16 v[44:47], v[76:79], a[152:155], v[44:47]
  v_mfma_f32_16x16x32_bf16 v[48:51], v[80:83], a[152:155], v[48:51]
  v_mfma_f32_16x16x32_bf16 v[52:55], v[76:79], a[208:211], v[52:55]
  v_mfma_f32_16x16x32_bf16 v[56:59], v[80:83], a[208:211], v[56:59]
  s_waitcnt lgkmcnt(2)
  v_mfma_f32_16x16x32_bf16 v[4:7], v[60:63], v[132:135], v[4:7]
  v_mfma_f32_16x16x32_bf16 v[8:11], v[64:67], v[132:135], v[8:11]
  v_mfma_f32_16x16x32_bf16 v[12:15], v[60:63], v[188:191], v[12:15]
  v_mfma_f32_16x16x32_bf16 v[16:19], v[64:67], v[188:191], v[16:19]
  ds_read_b128 v[76:79], v92 offset:320
  ds_read_b128 v[80:83], v92 offset:4032
  v_mfma_f32_16x16x32_bf16 v[20:23], v[60:63], v[244:247], v[20:23]
  v_mfma_f32_16x16x32_bf16 v[24:27], v[64:67], v[244:247], v[24:27]
  v_mfma_f32_16x16x32_bf16 v[28:31], v[60:63], a[44:47], v[28:31]
  v_mfma_f32_16x16x32_bf16 v[32:35], v[64:67], a[44:47], v[32:35]
  v_mfma_f32_16x16x32_bf16 v[36:39], v[60:63], a[100:103], v[36:39]
  v_mfma_f32_16x16x32_bf16 v[40:43], v[64:67], a[100:103], v[40:43]
  v_mfma_f32_16x16x32_bf16 v[44:47], v[60:63], a[156:159], v[44:47]
  v_mfma_f32_16x16x32_bf16 v[48:51], v[64:67], a[156:159], v[48:51]
  v_mfma_f32_16x16x32_bf16 v[52:55], v[60:63], a[212:215], v[52:55]
  v_mfma_f32_16x16x32_bf16 v[56:59], v[64:67], a[212:215], v[56:59]
  s_waitcnt lgkmcnt(2)
  v_mfma_f32_16x16x32_bf16 v[4:7], v[68:71], v[136:139], v[4:7]
  v_mfma_f32_16x16x32_bf16 v[8:11], v[72:75], v[136:139], v[8:11]
  v_mfma_f32_16x16x32_bf16 v[12:15], v[68:71], v[192:195], v[12:15]
  v_mfma_f32_16x16x32_bf16 v[16:19], v[72:75], v[192:195], v[16:19]
  ds_read_b128 v[60:63], v92 offset:384
  ds_read_b128 v[64:67], v92 offset:4096
  v_mfma_f32_16x16x32_bf16 v[20:23], v[68:71], v[248:251], v[20:23]
  v_mfma_f32_16x16x32_bf16 v[24:27], v[72:75], v[248:251], v[24:27]
  v_mfma_f32_16x16x32_bf16 v[28:31], v[68:71], a[48:51], v[28:31]
  v_mfma_f32_16x16x32_bf16 v[32:35], v[72:75], a[48:51], v[32:35]
  v_mfma_f32_16x16x32_bf16 v[36:39], v[68:71], a[104:107], v[36:39]
  v_mfma_f32_16x16x32_bf16 v[40:43], v[72:75], a[104:107], v[40:43]
  v_mfma_f32_16x16x32_bf16 v[44:47], v[68:71], a[160:163], v[44:47]
  v_mfma_f32_16x16x32_bf16 v[48:51], v[72:75], a[160:163], v[48:51]
  v_mfma_f32_16x16x32_bf16 v[52:55], v[68:71], a[216:219], v[52:55]
  v_mfma_f32_16x16x32_bf16 v[56:59], v[72:75], a[216:219], v[56:59]
  s_waitcnt lgkmcnt(2)
  v_mfma_f32_16x16x32_bf16 v[4:7], v[76:79], v[140:143], v[4:7]
  v_mfma_f32_16x16x32_bf16 v[8:11], v[80:83], v[140:143], v[8:11]
  v_mfma_f32_16x16x32_bf16 v[12:15], v[76:79], v[196:199], v[12:15]
  v_mfma_f32_16x16x32_bf16 v[16:19], v[80:83], v[196:199], v[16:19]
  ds_read_b128 v[68:71], v92 offset:448
  ds_read_b128 v[72:75], v92 offset:4160
  v_mfma_f32_16x16x32_bf16 v[20:23], v[76:79], v[252:255], v[20:23]
  v_mfma_f32_16x16x32_bf16 v[24:27], v[80:83], v[252:255], v[24:27]
  v_mfma_f32_16x16x32_bf16 v[28:31], v[76:79], a[52:55], v[28:31]
  v_mfma_f32_16x16x32_bf16 v[32:35], v[80:83], a[52:55], v[32:35]
  v_mfma_f32_16x16x32_bf16 v[36:39], v[76:79], a[108:111], v[36:39]
  v_mfma_f32_16x16x32_bf16 v[40:43], v[80:83], a[108:111], v[40:43]
  v_mfma_f32_16x16x32_bf16 v[44:47], v[76:79], a[164:167], v[44:47]
  v_mfma_f32_16x16x32_bf16 v[48:51], v[80:83], a[164:167], v[48:51]
  v_mfma_f32_16x16x32_bf16 v[52:55], v[76:79], a[220:223], v[52:55]
  v_mfma_f32_16x16x32_bf16 v[56:59], v[80:83], a[220:223], v[56:59]
  s_waitcnt lgkmcnt(2)
  v_mfma_f32_16x16x32_bf16 v[4:7], v[60:63], v[144:147], v[4:7]
  v_mfma_f32_16x16x32_bf16 v[8:11], v[64:67], v[144:147], v[8:11]
  v_mfma_f32_16x16x32_bf16 v[12:15], v[60:63], v[200:203], v[12:15]
  v_mfma_f32_16x16x32_bf16 v[16:19], v[64:67], v[200:203], v[16:19]
  ds_read_b128 v[76:79], v92 offset:512
  ds_read_b128 v[80:83], v92 offset:4224
  v_mfma_f32_16x16x32_bf16 v[20:23], v[60:63], a[0:3], v[20:23]
  v_mfma_f32_16x16x32_bf16 v[24:27], v[64:67], a[0:3], v[24:27]
  v_mfma_f32_16x16x32_bf16 v[28:31], v[60:63], a[56:59], v[28:31]
  v_mfma_f32_16x16x32_bf16 v[32:35], v[64:67], a[56:59], v[32:35]
  v_mfma_f32_16x16x32_bf16 v[36:39], v[60:63], a[112:115], v[36:39]
  v_mfma_f32_16x16x32_bf16 v[40:43], v[64:67], a[112:115], v[40:43]
  v_mfma_f32_16x16x32_bf16 v[44:47], v[60:63], a[168:171], v[44:47]
  v_mfma_f32_16x16x32_bf16 v[48:51], v[64:67], a[168:171], v[48:51]
  v_mfma_f32_16x16x32_bf16 v[52:55], v[60:63], a[224:227], v[52:55]
  v_mfma_f32_16x16x32_bf16 v[56:59], v[64:67], a[224:227], v[56:59]
  s_cmp_eq_u32 s48, 0
  s_cbranch_scc1 Lnf_126
  s_cmp_lt_u32 s41, 64
  s_cbranch_scc1 Lnf_126a
  s_waitcnt vmcnt(0)
Lnf_126a:
  s_waitcnt vmcnt(8)
  s_barrier
  s_cmp_lg_u32 s20, 0
  s_cbranch_scc1 Lsf_129
  s_mov_b64 exec, 1
  buffer_store_dword v113, v112, s[4:7], s46 offen sc1
  s_mov_b64 exec, -1
Lsf_129:
  s_add_u32 s46, s46, 28
Lnf_126:
  s_waitcnt lgkmcnt(2)
  v_mfma_f32_16x16x32_bf16 v[4:7], v[68:71], v[148:151], v[4:7]
  v_mfma_f32_16x16x32_bf16 v[8:11], v[72:75], v[148:151], v[8:11]
  v_mfma_f32_16x16x32_bf16 v[12:15], v[68:71], v[204:207], v[12:15]
  v_mfma_f32_16x16x32_bf16 v[16:19], v[72:75], v[204:207], v[16:19]
  ds_read_b128 v[60:63], v92 offset:576
  ds_read_b128 v[64:67], v92 offset:4288
  v_mfma_f32_16x16x32_bf16 v[20:23], v[68:71], a[4:7], v[20:23]
  v_mfma_f32_16x16x32_bf16 v[24:27], v[72:75], a[4:7], v[24:27]
  v_mfma_f32_16x16x32_bf16 v[28:31], v[68:71], a[60:63], v[28:31]
  v_mfma_f32_16x16x32_bf16 v[32:35], v[72:75], a[60:63], v[32:35]
  v_mfma_f32_16x16x32_bf16 v[36:39], v[68:71], a[116:119], v[36:39]
  v_mfma_f32_16x16x32_bf16 v[40:43], v[72:75], a[116:119], v[40:43]
  v_mfma_f32_16x16x32_bf16 v[44:47], v[68:71], a[172:175], v[44:47]
  v_mfma_f32_16x16x32_bf16 v[48:51], v[72:75], a[172:175], v[48:51]
  v_mfma_f32_16x16x32_bf16 v[52:55], v[68:71], a[228:231], v[52:55]
  v_mfma_f32_16x16x32_bf16 v[56:59], v[72:75], a[228:231], v[56:59]
  s_waitcnt lgkmcnt(2)
  v_mfma_f32_16x16x32_bf16 v[4:7], v[76:79], v[152:155], v[4:7]
  v_mfma_f32_16x16x32_bf16 v[8:11], v[80:83], v[152:155], v[8:11]
  v_mfma_f32_16x16x32_bf16 v[12:15], v[76:79], v[208:211], v[12:15]
  v_mfma_f32_16x16x32_bf16 v[16:19], v[80:83], v[208:211], v[16:19]
  ds_read_b128 v[68:71], v92 offset:640
  ds_read_b128 v[72:75], v92 offset:4352
  v_mfma_f32_16x16x32_bf16 v[20:23], v[76:79], a[8:11], v[20:23]
  v_mfma_f32_16x16x32_bf16 v[24:27], v[80:83], a[8:11], v[24:27]
  v_mfma_f32_16x16x32_bf16 v[28:31], v[76:79], a[64:67], v[28:31]
  v_mfma_f32_16x16x32_bf16 v[32:35], v[80:83], a[64:67], v[32:35]
  v_mfma_f32_16x16x32_bf16 v[36:39], v[76:79], a[120:123], v[36:39]
  v_mfma_f32_16x16x32_bf16 v[40:43], v[80:83], a[120:123], v[40:43]
  v_mfma_f32_16x16x32_bf16 v[44:47], v[76:79], a[176:179], v[44:47]
  v_mfma_f32_16x16x32_bf16 v[48:51], v[80:83], a[176:179], v[48:51]
  v_mfma_f32_16x16x32_bf16 v[52:55], v[76:79], a[232:235], v[52:55]
  v_mfma_f32_16x16x32_bf16 v[56:59], v[80:83], a[232:235], v[56:59]
  s_waitcnt lgkmcnt(2)
  v_mfma_f32_16x16x32_bf16 v[4:7], v[60:63], v[156:159], v[4:7]
  v_mfma_f32_16x16x32_bf16 v[8:11], v[64:67], v[156:159], v[8:11]
  v_mfma_f32_16x16x32_bf16 v[12:15], v[60:63], v[212:215], v[12:15]
  v_mfma_f32_16x16x32_bf16 v[16:19], v[64:67], v[212:215], v[16:19]
  ds_read_b128 v[76:79], v92 offset:704
  ds_read_b128 v[80:83], v92 offset:4416
  v_mfma_f32_16x16x32_bf16 v[20:23], v[60:63], a[12:15], v[20:23]
  v_mfma_f32_16x16x32_bf16 v[24:27], v[64:67], a[12:15], v[24:27]
  v_mfma_f32_16x16x32_bf16 v[28:31], v[60:63], a[68:71], v[28:31]
  v_mfma_f32_16x16x32_bf16 v[32:35], v[64:67], a[68:71], v[32:35]
  v_mfma_f32_16x16x32_bf16 v[36:39], v[60:63], a[124:127], v[36:39]
  v_mfma_f32_16x16x32_bf16 v[40:43], v[64:67], a[124:127], v[40:43]
  v_mfma_f32_16x16x32_bf16 v[44:47], v[60:63], a[180:183], v[44:47]
  v_mfma_f32_16x16x32_bf16 v[48:51], v[64:67], a[180:183], v[48:51]
  v_mfma_f32_16x16x32_bf16 v[52:55], v[60:63], a[236:239], v[52:55]
  v_mfma_f32_16x16x32_bf16 v[56:59], v[64:67], a[236:239], v[56:59]
  s_waitcnt lgkmcnt(2)
  v_mfma_f32_16x16x32_bf16 v[4:7], v[68:71], v[160:163], v[4:7]
  v_mfma_f32_16x16x32_bf16 v[8:11], v[72:75], v[160:163], v[8:11]
  v_mfma_f32_16x16x32_bf16 v[12:15], v[68:71], v[216:219], v[12:15]
  v_mfma_f32_16x16x32_bf16 v[16:19], v[72:75], v[216:219], v[16:19]
  ds_read_b128 v[60:63], v92 offset:768
  ds_read_b128 v[64:67], v92 offset:4480
  v_mfma_f32_16x16x32_bf16 v[20:23], v[68:71], a[16:19], v[20:23]
  v_mfma_f32_16x16x32_bf16 v[24:27], v[72:75], a[16:19], v[24:27]
  v_mfma_f32_16x16x32_bf16 v[28:31], v[68:71], a[72:75], v[28:31]
  v_mfma_f32_16x16x32_bf16 v[32:35], v[72:75], a[72:75], v[32:35]
  v_mfma_f32_16x16x32_bf16 v[36:39], v[68:71], a[128:131], v[36:39]
  v_mfma_f32_16x16x32_bf16 v[40:43], v[72:75], a[128:131], v[40:43]
  v_mfma_f32_16x16x32_bf16 v[44:47], v[68:71], a[184:187], v[44:47]
  v_mfma_f32_16x16x32_bf16 v[48:51], v[72:75], a[184:187], v[48:51]
  v_mfma_f32_16x16x32_bf16 v[52:55], v[68:71], a[240:243], v[52:55]
  v_mfma_f32_16x16x32_bf16 v[56:59], v[72:75], a[240:243], v[56:59]
  s_waitcnt lgkmcnt(2)
  v_mfma_f32_16x16x32_bf16 v[4:7], v[76:79], v[164:167], v[4:7]
  v_mfma_f32_16x16x32_bf16 v[8:11], v[80:83], v[164:167], v[8:11]
  v_mfma_f32_16x16x32_bf16 v[12:15], v[76:79], v[220:223], v[12:15]
  v_mfma_f32_16x16x32_bf16 v[16:19], v[80:83], v[220:223], v[16:19]
  ds_read_b128 v[68:71], v92 offset:832
  ds_read_b128 v[72:75], v92 offset:4544
  v_mfma_f32_16x16x32_bf16 v[20:23], v[76:79], a[20:23], v[20:23]
  v_mfma_f32_16x16x32_bf16 v[24:27], v[80:83], a[20:23], v[24:27]
  v_mfma_f32_16x16x32_bf16 v[28:31], v[76:79], a[76:79], v[28:31]
  v_mfma_f32_16x16x32_bf16 v[32:35], v[80:83], a[76:79], v[32:35]
  v_mfma_f32_16x16x32_bf16 v[36:39], v[76:79], a[132:135], v[36:39]
  v_mfma_f32_16x16x32_bf16 v[40:43], v[80:83], a[132:135], v[40:43]
  v_mfma_f32_16x16x32_bf16 v[44:47], v[76:79], a[188:191], v[44:47]
  v_mfma_f32_16x16x32_bf16 v[48:51], v[80:83], a[188:191], v[48:51]
  v_mfma_f32_16x16x32_bf16 v[52:55], v[76:79], a[244:247], v[52:55]
  v_mfma_f32_16x16x32_bf16 v[56:59], v[80:83], a[244:247], v[56:59]
  s_waitcnt lgkmcnt(2)
  v_mfma_f32_16x16x32_bf16 v[4:7], v[60:63], v[168:171], v[4:7]
  v_mfma_f32_16x16x32_bf16 v[8:11], v[64:67], v[168:171], v[8:11]
  v_mfma_f32_16x16x32_bf16 v[12:15], v[60:63], v[224:227], v[12:15]
  v_mfma_f32_16x16x32_bf16 v[16:19], v[64:67], v[224:227], v[16:19]
  v_mfma_f32_16x16x32_bf16 v[20:23], v[60:63], a[24:27], v[20:23]
  v_mfma_f32_16x16x32_bf16 v[24:27], v[64:67], a[24:27], v[24:27]
  v_mfma_f32_16x16x32_bf16 v[28:31], v[60:63], a[80:83], v[28:31]
  v_mfma_f32_16x16x32_bf16 v[32:35], v[64:67], a[80:83], v[32:35]
  v_mfma_f32_16x16x32_bf16 v[36:39], v[60:63], a[136:139], v[36:39]
  v_mfma_f32_16x16x32_bf16 v[40:43], v[64:67], a[136:139], v[40:43]
  v_mfma_f32_16x16x32_bf16 v[44:47], v[60:63], a[192:195], v[44:47]
  v_mfma_f32_16x16x32_bf16 v[48:51], v[64:67], a[192:195], v[48:51]
  v_mfma_f32_16x16x32_bf16 v[52:55], v[60:63], a[248:251], v[52:55]
  v_mfma_f32_16x16x32_bf16 v[56:59], v[64:67], a[248:251], v[56:59]
  s_waitcnt lgkmcnt(0)
  v_mfma_f32_16x16x32_bf16 v[4:7], v[68:71], v[172:175], v[4:7]
  v_mfma_f32_16x16x32_bf16 v[8:11], v[72:75], v[172:175], v[8:11]
  v_mfma_f32_16x16x32_bf16 v[12:15], v[68:71], v[228:231], v[12:15]
  v_mfma_f32_16x16x32_bf16 v[16:19], v[72:75], v[228:231], v[16:19]
  v_mfma_f32_16x16x32_bf16 v[20:23], v[68:71], a[28:31], v[20:23]
  v_mfma_f32_16x16x32_bf16 v[24:27], v[72:75], a[28:31], v[24:27]
  v_mfma_f32_16x16x32_bf16 v[28:31], v[68:71], a[84:87], v[28:31]
  v_mfma_f32_16x16x32_bf16 v[32:35], v[72:75], a[84:87], v[32:35]
  v_mfma_f32_16x16x32_bf16 v[36:39], v[68:71], a[140:143], v[36:39]
  v_mfma_f32_16x16x32_bf16 v[40:43], v[72:75], a[140:143], v[40:43]
  v_mfma_f32_16x16x32_bf16 v[44:47], v[68:71], a[196:199], v[44:47]
  v_mfma_f32_16x16x32_bf16 v[48:51], v[72:75], a[196:199], v[48:51]
  v_mfma_f32_16x16x32_bf16 v[52:55], v[68:71], a[252:255], v[52:55]
  v_mfma_f32_16x16x32_bf16 v[56:59], v[72:75], a[252:255], v[56:59]
  v_add_u32 v92, s47, v92
  s_sub_u32 s47, 0, s47
  v_cvt_pk_bf16_f32 v4, v4, v5
  v_cvt_pk_bf16_f32 v5, v6, v7
  v_cvt_pk_bf16_f32 v6, v8, v9
  v_cvt_pk_bf16_f32 v7, v10, v11
  buffer_store_dwordx4 v[4:7], v84, s[4:7], s45 offen sc1
  v_cvt_pk_bf16_f32 v12, v12, v13
  v_cvt_pk_bf16_f32 v13, v14, v15
  v_cvt_pk_bf16_f32 v14, v16, v17
  v_cvt_pk_bf16_f32 v15, v18, v19
  buffer_store_dwordx4 v[12:15], v85, s[4:7], s45 offen sc1
  v_cvt_pk_bf16_f32 v20, v20, v21
  v_cvt_pk_bf16_f32 v21, v22, v23
  v_cvt_pk_bf16_f32 v22, v24, v25
  v_cvt_pk_bf16_f32 v23, v26, v27
  buffer_store_dwordx4 v[20:23], v86, s[4:7], s45 offen sc1
  v_cvt_pk_bf16_f32 v28, v28, v29
  v_cvt_pk_bf16_f32 v29, v30, v31
  v_cvt_pk_bf16_f32 v30, v32, v33
  v_cvt_pk_bf16_f32 v31, v34, v35
  buffer_store_dwordx4 v[28:31], v87, s[4:7], s45 offen sc1
  v_cvt_pk_bf16_f32 v36, v36, v37
  v_cvt_pk_bf16_f32 v37, v38, v39
  v_cvt_pk_bf16_f32 v38, v40, v41
  v_cvt_pk_bf16_f32 v39, v42, v43
  buffer_store_dwordx4 v[36:39], v88, s[4:7], s45 offen sc1
  v_cvt_pk_bf16_f32 v44, v44, v45
  v_cvt_pk_bf16_f32 v45, v46, v47
  v_cvt_pk_bf16_f32 v46, v48, v49
  v_cvt_pk_bf16_f32 v47, v50, v51
  buffer_store_dwordx4 v[44:47], v89, s[4:7], s45 offen sc1
  v_cvt_pk_bf16_f32 v52, v52, v53
  v_cvt_pk_bf16_f32 v53, v54, v55
  v_cvt_pk_bf16_f32 v54, v56, v57
  v_cvt_pk_bf16_f32 v55, v58, v59
  buffer_store_dwordx4 v[52:55], v90, s[4:7], s45 offen sc1
  s_add_u32 s45, s45, 200704
  s_add_u32 s48, s48, 1
  s_cmp_lt_u32 s41, 64
  s_cbranch_scc1 Luw_loop_125
  s_waitcnt vmcnt(0)
  s_barrier
  s_cmp_lg_u32 s20, 0
  s_cbranch_scc1 Lsf_130
  s_mov_b64 exec, 1
  buffer_store_dword v113, v112, s[4:7], s46 offen sc1
  s_mov_b64 exec, -1
Lsf_130:
Luw_done:
  s_load_dwordx4 s[68:71], s[0:1], 8
  s_waitcnt lgkmcnt(0)
  s_lshl_b32 s26, s40, 3
  s_add_u32 s26, s26, s20
  s_lshl_b32 s73, s26, 10
  s_add_u32 s73, s73, 79968256
  s_cmp_ge_u32 s26, 1344
  s_cbranch_scc1 Lfo_131
  s_mul_hi_u32 s27, s26, 306783379
  s_mul_i32 s28, s27, 14
  s_sub_u32 s28, s26, s28
  s_mul_hi_u32 s29, s27, 715827883
  s_mul_i32 s26, s29, 6
  s_sub_u32 s27, s27, s26
  s_and_b32 s75, s27, 1
  s_lshr_b32 s27, s27, 1
  s_min_u32 s74, s27, 1
  s_mul_i32 s72, s28, 86016
  s_mul_i32 s27, s27, 896
  s_add_u32 s72, s72, s27
  s_mul_i32 s29, s29, 56
  s_add_u32 s72, s72, s29
  s_mov_b32 s64, s68
  s_mov_b32 s65, s69
  s_mov_b32 s66, 1204224
  s_mov_b32 s67, 0x20000
  s_mov_b32 s26, 2688
  s_branch Lfj_132
Lfo_131:
  s_sub_u32 s26, s26, 1344
  s_lshr_b32 s27, s26, 4
  s_and_b32 s28, s26, 15
  s_and_b32 s75, s27, 1
  s_lshr_b32 s27, s27, 1
  s_mov_b32 s74, 2
  s_mul_i32 s72, s28, 25088
  s_lshl_b32 s27, s27, 6
  s_add_u32 s72, s72, s27
  s_mov_b32 s64, s70
  s_mov_b32 s65, s71
  s_mov_b32 s66, 401408
  s_mov_b32 s67, 0x20000
  s_mov_b32 s26, 896
Lfj_132:
  v_lshrrev_b32 v100, 1, v0
  v_mul_lo_u32 v100, v100, s26
  v_and_b32 v101, 1, v0
  v_lshl_add_u32 v100, v101, 5, v100
  buffer_load_dwordx4 v[4:7], v100, s[64:67], s72 offen
  buffer_load_dwordx4 v[8:11], v100, s[64:67], s72 offen offset:16
  s_lshl_b32 s26, s40, 3
  s_add_u32 s26, s26, s20
  s_add_u32 s26, s26, 4
  s_lshl_b32 s77, s26, 10
  s_add_u32 s77, s77, 79968256
  s_cmp_ge_u32 s26, 1344
  s_cbranch_scc1 Lfo_133
  s_mul_hi_u32 s27, s26, 306783379
  s_mul_i32 s28, s27, 14
  s_sub_u32 s28, s26, s28
  s_mul_hi_u32 s29, s27, 715827883
  s_mul_i32 s26, s29, 6
  s_sub_u32 s27, s27, s26
  s_and_b32 s79, s27, 1
  s_lshr_b32 s27, s27, 1
  s_min_u32 s78, s27, 1
  s_mul_i32 s76, s28, 86016
  s_mul_i32 s27, s27, 896
  s_add_u32 s76, s76, s27
  s_mul_i32 s29, s29, 56
  s_add_u32 s76, s76, s29
  s_mov_b32 s64, s68
  s_mov_b32 s65, s69
  s_mov_b32 s66, 1204224
  s_mov_b32 s67, 0x20000
  s_mov_b32 s26, 2688
  s_branch Lfj_134
Lfo_133:
  s_sub_u32 s26, s26, 1344
  s_lshr_b32 s27, s26, 4
  s_and_b32 s28, s26, 15
  s_and_b32 s79, s27, 1
  s_lshr_b32 s27, s27, 1
  s_mov_b32 s78, 2
  s_mul_i32 s76, s28, 25088
  s_lshl_b32 s27, s27, 6
  s_add_u32 s76, s76, s27
  s_mov_b32 s64, s70
  s_mov_b32 s65, s71
  s_mov_b32 s66, 401408
  s_mov_b32 s67, 0x20000
  s_mov_b32 s26, 896
Lfj_134:
  v_lshrrev_b32 v100, 1, v0
  v_mul_lo_u32 v100, v100, s26
  v_and_b32 v101, 1, v0
  v_lshl_add_u32 v100, v101, 5, v100
  buffer_load_dwordx4 v[12:15], v100, s[64:67], s76 offen
  buffer_load_dwordx4 v[16:19], v100, s[64:67], s76 offen offset:16
  s_lshl_b32 s26, s20, 11
  v_lshlrev_b32 v100, 5, v0
  v_add_u32 v100, s26, v100
  v_lshrrev_b32 v101, 2, v2
  v_lshl_add_u32 v101, v3, 3, v101
  v_lshlrev_b32 v101, 6, v101
  v_add_u32 v101, s26, v101
  v_and_b32 v102, 3, v2
  s_waitcnt vmcnt(0)
  ds_write_b128 v100, v[4:7]
  ds_write_b128 v100, v[8:11] offset:16
  s_cmp_eq_u32 s74, 0
  s_cselect_b32 s27, 4, 3
  s_cselect_b32 s28, 3, 5
  s_lshl_b32 s28, s75, s28
  v_lshlrev_b32 v103, s27, v102
  v_add3_u32 v103, v103, v101, s28
  ds_read_b64_tr_b16 v[4:5], v103
  ds_read_b64_tr_b16 v[6:7], v103 offset:256
  s_cmp_lt_u32 s74, 2
  s_cselect_b32 s27, s75, 0
  s_cmp_eq_u32 s27, 1
  s_cselect_b32 s27, 12, 16
  v_cmp_gt_u32 vcc, s27, v2
  s_cmp_eq_u32 s74, 2
  s_cselect_b32 s27, 3, 4
  v_cmp_gt_u32 s[58:59], s27, v3
  s_nop 0
  s_and_b64 s[58:59], s[58:59], vcc
  s_waitcnt lgkmcnt(0)
  v_cndmask_b32 v4, 0, v4, vcc
  v_cndmask_b32 v5, 0, v5, vcc
  v_cndmask_b32 v6, 0, v6, s[58:59]
  v_cndmask_b32 v7, 0, v7, s[58:59]
  buffer_store_dwordx4 v[4:7], v1, s[4:7], s73 offen sc1
  ds_write_b128 v100, v[12:15]
  ds_write_b128 v100, v[16:19] offset:16
  s_cmp_eq_u32 s78, 0
  s_cselect_b32 s27, 4, 3
  s_cselect_b32 s28, 3, 5
  s_lshl_b32 s28, s79, s28
  v_lshlrev_b32 v103, s27, v102
  v_add3_u32 v103, v103, v101, s28
  ds_read_b64_tr_b16 v[12:13], v103
  ds_read_b64_tr_b16 v[14:15], v103 offset:256
  s_cmp_lt_u32 s78, 2
  s_cselect_b32 s27, s79, 0
  s_cmp_eq_u32 s27, 1
  s_cselect_b32 s27, 12, 16
  v_cmp_gt_u32 vcc, s27, v2
  s_cmp_eq_u32 s78, 2
  s_cselect_b32 s27, 3, 4
  v_cmp_gt_u32 s[58:59], s27, v3
  s_nop 0
  s_and_b64 s[58:59], s[58:59], vcc
  s_waitcnt lgkmcnt(0)
  v_cndmask_b32 v12, 0, v12, vcc
  v_cndmask_b32 v13, 0, v13, vcc
  v_cndmask_b32 v14, 0, v14, s[58:59]
  v_cndmask_b32 v15, 0, v15, s[58:59]
  buffer_store_dwordx4 v[12:15], v1, s[4:7], s77 offen sc1
  s_waitcnt vmcnt(0)
  s_barrier
  s_mov_b32 s27, 72558848
  s_cmp_lg_u32 s20, 0
  s_cbranch_scc1 Lcnt_135
  s_mov_b64 exec, 1
  buffer_atomic_add v113, v112, s[4:7], s27 offen
  s_mov_b64 exec, -1
Lcnt_135:
  s_cmp_lt_u32 s40, 112
  s_cbranch_scc1 Lny_136
  s_sub_u32 s27, s42, 16
  s_mul_i32 s26, s42, 7
  s_sub_u32 s26, s40, s26
  s_sub_u32 s40, s40, s27
  s_cmp_lg_u32 s26, 6
  s_cbranch_scc1 Lny_136
  s_mov_b32 s44, s27
  v_and_b32 v1, 15, v0
  v_lshrrev_b32 v2, 4, v0
  v_lshlrev_b32 v115, 4, v0
  v_and_b32 v3, 2, v0
  v_cmp_eq_u32 vcc, 0, v3
  v_mov_b32 v112, 0xdddd
  v_mov_b32 v3, 0x8888
  v_cndmask_b32 v112, v112, v3, vcc
  v_lshlrev_b32 v113, 3, v1
  v_lshl_add_u32 v113, v2, 8, v113
  v_lshlrev_b32 v4, 4, v1
  v_lshl_add_u32 v114, v2, 2, v4
  v_mov_b32 v101, 1
  v_mov_b32 v5, 0x40000000
  v_cmp_gt_u32 vcc, 56, v0
  s_nop 1
  v_cndmask_b32 v100, v5, v115, vcc
  s_mul_i32 s46, s44, 458752
  s_mul_i32 s26, s20, 1792
  s_add_u32 s46, s46, s26
  s_add_u32 s46, s46, 72628224
  s_lshl_b32 s47, s44, 2
  s_add_u32 s47, s47, 72542208
  s_mov_b32 s24, 0
  s_mov_b32 s25, 72079360
  s_cmp_eq_u32 s20, 1
  s_cbranch_scc1 Ly_w_138
  s_cmp_eq_u32 s20, 2
  s_cbranch_scc1 Ly_w_139
  s_cmp_eq_u32 s20, 3
  s_cbranch_scc1 Ly_w_140
Ly_w_137:
Ly_loop_141:
  v_mov_b32 v32, 0
  v_mov_b32 v33, 0
  v_mov_b32 v34, 0
  v_mov_b32 v35, 0
  v_mov_b32 v36, 0
  v_mov_b32 v37, 0
  v_mov_b32 v38, 0
  v_mov_b32 v39, 0
  v_mov_b32 v40, 0
  v_mov_b32 v41, 0
  v_mov_b32 v42, 0
  v_mov_b32 v43, 0
  v_mov_b32 v44, 0
  v_mov_b32 v45, 0
  v_mov_b32 v46, 0
  v_mov_b32 v47, 0
  v_mov_b32 v48, 0
  v_mov_b32 v49, 0
  v_mov_b32 v50, 0
  v_mov_b32 v51, 0
  v_mov_b32 v52, 0
  v_mov_b32 v53, 0
  v_mov_b32 v54, 0
  v_mov_b32 v55, 0
  v_mov_b32 v56, 0
  v_mov_b32 v57, 0
  v_mov_b32 v58, 0
  v_mov_b32 v59, 0
  s_mov_b32 s30, 1048576
  buffer_load_dwordx4 v[60:63], v115, s[4:7], s25 offen offset:0 sc1
  buffer_load_dwordx4 v[64:67], v115, s[4:7], s25 offen offset:1024 sc1
Lpoll_142:
  s_waitcnt vmcnt(0)
  v_max3_u32 v3, v60, v61, v62
  v_max3_u32 v3, v3, v63, v64
  v_max3_u32 v3, v3, v65, v66
  v_max_u32 v3, v3, v67
  v_cmp_eq_u32 vcc, -1, v3
  s_cbranch_vccz Ljoin_1430
  s_sleep 2
  s_cmp_ge_u32 s24, 52
  s_cbranch_scc1 Lnap_145
  s_sleep 120
Lnap_145:
Lfail_144:
  buffer_load_dwordx4 v[60:63], v115, s[4:7], s25 offen offset:0 sc1
  buffer_load_dwordx4 v[64:67], v115, s[4:7], s25 offen offset:1024 sc1
  s_sub_u32 s30, s30, 1
  s_cbranch_scc0 Lpoll_142
  s_branch Lk1_exit
Ljoin_1430:
  ds_write_b128 v115, v[60:63] offset:0
  ds_write_b128 v115, v[64:67] offset:1024
  ds_read_b64_tr_b16 v[4:5], v113 offset:0
  ds_read_b64_tr_b16 v[6:7], v113 offset:128
  ds_read_b64_tr_b16 v[8:9], v113 offset:1024
  ds_read_b64_tr_b16 v[10:11], v113 offset:1152
Ljoin_143:
  s_waitcnt lgkmcnt(4)
  s_barrier
  s_waitcnt lgkmcnt(0)
  v_smfmac_f32_16x16x64_bf16 v[32:35], v[4:7], v[120:127], v112
  ds_read_b64_tr_b16 v[12:13], v113 offset:2048
  v_smfmac_f32_16x16x64_bf16 v[36:39], v[4:7], v[176:183], v112
  ds_read_b64_tr_b16 v[14:15], v113 offset:2176
  v_smfmac_f32_16x16x64_bf16 v[40:43], v[4:7], v[232:239], v112
  ds_read_b64_tr_b16 v[16:17], v113 offset:3072
  v_smfmac_f32_16x16x64_bf16 v[44:47], v[4:7], a[32:39], v112
  ds_read_b64_tr_b16 v[18:19], v113 offset:3200
  v_smfmac_f32_16x16x64_bf16 v[48:51], v[4:7], a[88:95], v112
  ds_read_b64_tr_b16 v[20:21], v113 offset:4096
  v_smfmac_f32_16x16x64_bf16 v[52:55], v[4:7], a[144:151], v112
  ds_read_b64_tr_b16 v[22:23], v113 offset:4224
  v_smfmac_f32_16x16x64_bf16 v[56:59], v[4:7], a[200:207], v112
  ds_read_b64_tr_b16 v[24:25], v113 offset:5120
  v_smfmac_f32_16x16x64_bf16 v[32:35], v[8:11], v[128:135], v112
  ds_read_b64_tr_b16 v[26:27], v113 offset:5248
  v_smfmac_f32_16x16x64_bf16 v[36:39], v[8:11], v[184:191], v112
  ds_read_b64_tr_b16 v[28:29], v113 offset:6144
  v_smfmac_f32_16x16x64_bf16 v[40:43], v[8:11], v[240:247], v112
  ds_read_b64_tr_b16 v[30:31], v113 offset:6272
  v_smfmac_f32_16x16x64_bf16 v[44:47], v[8:11], a[40:47], v112
  v_smfmac_f32_16x16x64_bf16 v[48:51], v[8:11], a[96:103], v112
  v_smfmac_f32_16x16x64_bf16 v[52:55], v[8:11], a[152:159], v112
  v_smfmac_f32_16x16x64_bf16 v[56:59], v[8:11], a[208:215], v112
  s_waitcnt lgkmcnt(8)
  v_smfmac_f32_16x16x64_bf16 v[32:35], v[12:15], v[136:143], v112
  s_waitcnt lgkmcnt(6)
  v_smfmac_f32_16x16x64_bf16 v[32:35], v[16:19], v[144:151], v112
  s_waitcnt lgkmcnt(4)
  v_smfmac_f32_16x16x64_bf16 v[32:35], v[20:23], v[152:159], v112
  s_waitcnt lgkmcnt(2)
  v_smfmac_f32_16x16x64_bf16 v[32:35], v[24:27], v[160:167], v112
  s_waitcnt lgkmcnt(0)
  v_smfmac_f32_16x16x64_bf16 v[32:35], v[28:31], v[168:175], v112
  v_smfmac_f32_16x16x64_bf16 v[36:39], v[12:15], v[192:199], v112
  v_smfmac_f32_16x16x64_bf16 v[36:39], v[16:19], v[200:207], v112
  v_smfmac_f32_16x16x64_bf16 v[36:39], v[20:23], v[208:215], v112
  v_smfmac_f32_16x16x64_bf16 v[36:39], v[24:27], v[216:223], v112
  s_nop 3
  v_add_f32 v32, v32, v34
  v_smfmac_f32_16x16x64_bf16 v[36:39], v[28:31], v[224:231], v112
  v_add_f32 v33, v33, v35
  v_smfmac_f32_16x16x64_bf16 v[40:43], v[12:15], v[248:255], v112
  v_cvt_pk_bf16_f32 v32, v32, v33
  v_smfmac_f32_16x16x64_bf16 v[40:43], v[16:19], a[0:7], v112
  ds_write_b32 v114, v32 offset:7680
  v_smfmac_f32_16x16x64_bf16 v[40:43], v[20:23], a[8:15], v112
  v_smfmac_f32_16x16x64_bf16 v[40:43], v[24:27], a[16:23], v112
  s_nop 0
  v_add_f32 v36, v36, v38
  v_smfmac_f32_16x16x64_bf16 v[40:43], v[28:31], a[24:31], v112
  v_add_f32 v37, v37, v39
  v_smfmac_f32_16x16x64_bf16 v[44:47], v[12:15], a[48:55], v112
  v_cvt_pk_bf16_f32 v36, v36, v37
  v_smfmac_f32_16x16x64_bf16 v[44:47], v[16:19], a[56:63], v112
  ds_write_b32 v114, v36 offset:7936
  v_smfmac_f32_16x16x64_bf16 v[44:47], v[20:23], a[64:71], v112
  v_smfmac_f32_16x16x64_bf16 v[44:47], v[24:27], a[72:79], v112
  s_nop 0
  v_add_f32 v40, v40, v42
  v_smfmac_f32_16x16x64_bf16 v[44:47], v[28:31], a[80:87], v112
  v_add_f32 v41, v41, v43
  v_smfmac_f32_16x16x64_bf16 v[48:51], v[12:15], a[104:111], v112
  v_cvt_pk_bf16_f32 v40, v40, v41
  v_smfmac_f32_16x16x64_bf16 v[48:51], v[16:19], a[112:119], v112
  ds_write_b32 v114, v40 offset:8192
  v_smfmac_f32_16x16x64_bf16 v[48:51], v[20:23], a[120:127], v112
  v_smfmac_f32_16x16x64_bf16 v[48:51], v[24:27], a[128:135], v112
  s_nop 0
  v_add_f32 v44, v44, v46
  v_smfmac_f32_16x16x64_bf16 v[48:51], v[28:31], a[136:143], v112
  v_add_f32 v45, v45, v47
  v_smfmac_f32_16x16x64_bf16 v[52:55], v[12:15], a[160:167], v112
  v_cvt_pk_bf16_f32 v44, v44, v45
  v_smfmac_f32_16x16x64_bf16 v[52:55], v[16:19], a[168:175], v112
  ds_write_b32 v114, v44 offset:8448
  v_smfmac_f32_16x16x64_bf16 v[52:55], v[20:23], a[176:183], v112
  v_smfmac_f32_16x16x64_bf16 v[52:55], v[24:27], a[184:191], v112
  s_nop 0
  v_add_f32 v48, v48, v50
  v_smfmac_f32_16x16x64_bf16 v[52:55], v[28:31], a[192:199], v112
  v_add_f32 v49, v49, v51
  v_smfmac_f32_16x16x64_bf16 v[56:59], v[12:15], a[216:223], v112
  v_cvt_pk_bf16_f32 v48, v48, v49
  v_smfmac_f32_16x16x64_bf16 v[56:59], v[16:19], a[224:231], v112
  ds_write_b32 v114, v48 offset:8704
  v_smfmac_f32_16x16x64_bf16 v[56:59], v[20:23], a[232:239], v112
  v_smfmac_f32_16x16x64_bf16 v[56:59], v[24:27], a[240:247], v112
  s_nop 0
  v_add_f32 v52, v52, v54
  v_smfmac_f32_16x16x64_bf16 v[56:59], v[28:31], a[248:255], v112
  v_add_f32 v53, v53, v55
  v_cvt_pk_bf16_f32 v52, v52, v53
  ds_write_b32 v114, v52 offset:8960
  s_nop 4
  v_add_f32 v56, v56, v58
  v_add_f32 v57, v57, v59
  v_cvt_pk_bf16_f32 v56, v56, v57
  ds_write_b32 v114, v56 offset:9216
  ds_read_b128 v[92:95], v115 offset:7680
  ds_read_b128 v[96:99], v115 offset:8576
  s_waitcnt lgkmcnt(0)
  buffer_store_dwordx4 v[92:95], v100, s[4:7], s46 offen offset:0 sc1
  buffer_store_dwordx4 v[96:99], v100, s[4:7], s46 offen offset:896 sc1
  s_barrier
  s_add_u32 s46, s46, 7168
  s_add_u32 s25, s25, 7168
  s_add_u32 s24, s24, 1
  s_cmp_lt_u32 s24, 64
  s_cbranch_scc1 Ly_loop_141
  s_waitcnt vmcnt(0)
  s_barrier
  s_endpgm
Ly_w_138:
Ly_loop_146:
  v_mov_b32 v32, 0
  v_mov_b32 v33, 0
  v_mov_b32 v34, 0
  v_mov_b32 v35, 0
  v_mov_b32 v36, 0
  v_mov_b32 v37, 0
  v_mov_b32 v38, 0
  v_mov_b32 v39, 0
  v_mov_b32 v40, 0
  v_mov_b32 v41, 0
  v_mov_b32 v42, 0
  v_mov_b32 v43, 0
  v_mov_b32 v44, 0
  v_mov_b32 v45, 0
  v_mov_b32 v46, 0
  v_mov_b32 v47, 0
  v_mov_b32 v48, 0
  v_mov_b32 v49, 0
  v_mov_b32 v50, 0
  v_mov_b32 v51, 0
  v_mov_b32 v52, 0
  v_mov_b32 v53, 0
  v_mov_b32 v54, 0
  v_mov_b32 v55, 0
  v_mov_b32 v56, 0
  v_mov_b32 v57, 0
  v_mov_b32 v58, 0
  v_mov_b32 v59, 0
  s_mov_b32 s30, 1048576
  buffer_load_dwordx4 v[60:63], v115, s[4:7], s25 offen offset:2048 sc1
  buffer_load_dwordx4 v[64:67], v115, s[4:7], s25 offen offset:3072 sc1
Lpoll_147:
  s_waitcnt vmcnt(0)
  v_max3_u32 v3, v60, v61, v62
  v_max3_u32 v3, v3, v63, v64
  v_max3_u32 v3, v3, v65, v66
  v_max_u32 v3, v3, v67
  v_cmp_eq_u32 vcc, -1, v3
  s_cbranch_vccz Ljoin_1480
  s_sleep 2
  s_cmp_ge_u32 s24, 52
  s_cbranch_scc1 Lnap_150
  s_sleep 120
Lnap_150:
Lfail_149:
  buffer_load_dwordx4 v[60:63], v115, s[4:7], s25 offen offset:2048 sc1
  buffer_load_dwordx4 v[64:67], v115, s[4:7], s25 offen offset:3072 sc1
  s_sub_u32 s30, s30, 1
  s_cbranch_scc0 Lpoll_147
  s_branch Lk1_exit
Ljoin_1480:
  ds_write_b128 v115, v[60:63] offset:2048
  ds_write_b128 v115, v[64:67] offset:3072
  ds_read_b64_tr_b16 v[12:13], v113 offset:2048
  ds_read_b64_tr_b16 v[14:15], v113 offset:2176
  ds_read_b64_tr_b16 v[16:17], v113 offset:3072
  ds_read_b64_tr_b16 v[18:19], v113 offset:3200
Ljoin_148:
  s_waitcnt lgkmcnt(4)
  s_barrier
  s_waitcnt lgkmcnt(0)
  v_smfmac_f32_16x16x64_bf16 v[32:35], v[12:15], v[136:143], v112
  ds_read_b64_tr_b16 v[4:5], v113 offset:0
  v_smfmac_f32_16x16x64_bf16 v[36:39], v[12:15], v[192:199], v112
  ds_read_b64_tr_b16 v[6:7], v113 offset:128
  v_smfmac_f32_16x16x64_bf16 v[40:43], v[12:15], v[248:255], v112
  ds_read_b64_tr_b16 v[8:9], v113 offset:1024
  v_smfmac_f32_16x16x64_bf16 v[44:47], v[12:15], a[48:55], v112
  ds_read_b64_tr_b16 v[10:11], v113 offset:1152
  v_smfmac_f32_16x16x64_bf16 v[48:51], v[12:15], a[104:111], v112
  ds_read_b64_tr_b16 v[20:21], v113 offset:4096
  v_smfmac_f32_16x16x64_bf16 v[52:55], v[12:15], a[160:167], v112
  ds_read_b64_tr_b16 v[22:23], v113 offset:4224
  v_smfmac_f32_16x16x64_bf16 v[56:59], v[12:15], a[216:223], v112
  ds_read_b64_tr_b16 v[24:25], v113 offset:5120
  v_smfmac_f32_16x16x64_bf16 v[32:35], v[16:19], v[144:151], v112
  ds_read_b64_tr_b16 v[26:27], v113 offset:5248
  v_smfmac_f32_16x16x64_bf16 v[36:39], v[16:19], v[200:207], v112
  ds_read_b64_tr_b16 v[28:29], v113 offset:6144
  v_smfmac_f32_16x16x64_bf16 v[40:43], v[16:19], a[0:7], v112
  ds_read_b64_tr_b16 v[30:31], v113 offset:6272
  v_smfmac_f32_16x16x64_bf16 v[44:47], v[16:19], a[56:63], v112
  v_smfmac_f32_16x16x64_bf16 v[48:51], v[16:19], a[112:119], v112
  v_smfmac_f32_16x16x64_bf16 v[52:55], v[16:19], a[168:175], v112
  v_smfmac_f32_16x16x64_bf16 v[56:59], v[16:19], a[224:231], v112
  s_waitcnt lgkmcnt(8)
  v_smfmac_f32_16x16x64_bf16 v[32:35], v[4:7], v[120:127], v112
  s_waitcnt lgkmcnt(6)
  v_smfmac_f32_16x16x64_bf16 v[32:35], v[8:11], v[128:135], v112
  s_waitcnt lgkmcnt(4)
  v_smfmac_f32_16x16x64_bf16 v[32:35], v[20:23], v[152:159], v112
  s_waitcnt lgkmcnt(2)
  v_smfmac_f32_16x16x64_bf16 v[32:35], v[24:27], v[160:167], v112
  s_waitcnt lgkmcnt(0)
  v_smfmac_f32_16x16x64_bf16 v[32:35], v[28:31], v[168:175], v112
  v_smfmac_f32_16x16x64_bf16 v[36:39], v[4:7], v[176:183], v112
  v_smfmac_f32_16x16x64_bf16 v[36:39], v[8:11], v[184:191], v112
  v_smfmac_f32_16x16x64_bf16 v[36:39], v[20:23], v[208:215], v112
  v_smfmac_f32_16x16x64_bf16 v[36:39], v[24:27], v[216:223], v112
  s_nop 3
  v_add_f32 v32, v32, v34
  v_smfmac_f32_16x16x64_bf16 v[36:39], v[28:31], v[224:231], v112
  v_add_f32 v33, v33, v35
  v_smfmac_f32_16x16x64_bf16 v[40:43], v[4:7], v[232:239], v112
  v_cvt_pk_bf16_f32 v32, v32, v33
  v_smfmac_f32_16x16x64_bf16 v[40:43], v[8:11], v[240:247], v112
  ds_write_b32 v114, v32 offset:9472
  v_smfmac_f32_16x16x64_bf16 v[40:43], v[20:23], a[8:15], v112
  v_smfmac_f32_16x16x64_bf16 v[40:43], v[24:27], a[16:23], v112
  s_nop 0
  v_add_f32 v36, v36, v38
  v_smfmac_f32_16x16x64_bf16 v[40:43], v[28:31], a[24:31], v112
  v_add_f32 v37, v37, v39
  v_smfmac_f32_16x16x64_bf16 v[44:47], v[4:7], a[32:39], v112
  v_cvt_pk_bf16_f32 v36, v36, v37
  v_smfmac_f32_16x16x64_bf16 v[44:47], v[8:11], a[40:47], v112
  ds_write_b32 v114, v36 offset:9728
  v_smfmac_f32_16x16x64_bf16 v[44:47], v[20:23], a[64:71], v112
  v_smfmac_f32_16x16x64_bf16 v[44:47], v[24:27], a[72:79], v112
  s_nop 0
  v_add_f32 v40, v40, v42
  v_smfmac_f32_16x16x64_bf16 v[44:47], v[28:31], a[80:87], v112
  v_add_f32 v41, v41, v43
  v_smfmac_f32_16x16x64_bf16 v[48:51], v[4:7], a[88:95], v112
  v_cvt_pk_bf16_f32 v40, v40, v41
  v_smfmac_f32_16x16x64_bf16 v[48:51], v[8:11], a[96:103], v112
  ds_write_b32 v114, v40 offset:9984
  v_smfmac_f32_16x16x64_bf16 v[48:51], v[20:23], a[120:127], v112
  v_smfmac_f32_16x16x64_bf16 v[48:51], v[24:27], a[128:135], v112
  s_nop 0
  v_add_f32 v44, v44, v46
  v_smfmac_f32_16x16x64_bf16 v[48:51], v[28:31], a[136:143], v112
  v_add_f32 v45, v45, v47
  v_smfmac_f32_16x16x64_bf16 v[52:55], v[4:7], a[144:151], v112
  v_cvt_pk_bf16_f32 v44, v44, v45
  v_smfmac_f32_16x16x64_bf16 v[52:55], v[8:11], a[152:159], v112
  ds_write_b32 v114, v44 offset:10240
  v_smfmac_f32_16x16x64_bf16 v[52:55], v[20:23], a[176:183], v112
  v_smfmac_f32_16x16x64_bf16 v[52:55], v[24:27], a[184:191], v112
  s_nop 0
  v_add_f32 v48, v48, v50
  v_smfmac_f32_16x16x64_bf16 v[52:55], v[28:31], a[192:199], v112
  v_add_f32 v49, v49, v51
  v_smfmac_f32_16x16x64_bf16 v[56:59], v[4:7], a[200:207], v112
  v_cvt_pk_bf16_f32 v48, v48, v49
  v_smfmac_f32_16x16x64_bf16 v[56:59], v[8:11], a[208:215], v112
  ds_write_b32 v114, v48 offset:10496
  v_smfmac_f32_16x16x64_bf16 v[56:59], v[20:23], a[232:239], v112
  v_smfmac_f32_16x16x64_bf16 v[56:59], v[24:27], a[240:247], v112
  s_nop 0
  v_add_f32 v52, v52, v54
  v_smfmac_f32_16x16x64_bf16 v[56:59], v[28:31], a[248:255], v112
  v_add_f32 v53, v53, v55
  v_cvt_pk_bf16_f32 v52, v52, v53
  ds_write_b32 v114, v52 offset:10752
  s_nop 4
  v_add_f32 v56, v56, v58
  v_add_f32 v57, v57, v59
  v_cvt_pk_bf16_f32 v56, v56, v57
  ds_write_b32 v114, v56 offset:11008
  ds_read_b128 v[92:95], v115 offset:9472
  ds_read_b128 v[96:99], v115 offset:10368
  s_waitcnt lgkmcnt(0)
  buffer_store_dwordx4 v[92:95], v100, s[4:7], s46 offen offset:0 sc1
  buffer_store_dwordx4 v[96:99], v100, s[4:7], s46 offen offset:896 sc1
  s_barrier
  s_add_u32 s46, s46, 7168
  s_add_u32 s25, s25, 7168
  s_add_u32 s24, s24, 1
  s_cmp_lt_u32 s24, 64
  s_cbranch_scc1 Ly_loop_146
  s_waitcnt vmcnt(0)
  s_barrier
  s_endpgm
Ly_w_139:
Ly_loop_151:
  v_mov_b32 v32, 0
  v_mov_b32 v33, 0
  v_mov_b32 v34, 0
  v_mov_b32 v35, 0
  v_mov_b32 v36, 0
  v_mov_b32 v37, 0
  v_mov_b32 v38, 0
  v_mov_b32 v39, 0
  v_mov_b32 v40, 0
  v_mov_b32 v41, 0
  v_mov_b32 v42, 0
  v_mov_b32 v43, 0
  v_mov_b32 v44, 0
  v_mov_b32 v45, 0
  v_mov_b32 v46, 0
  v_mov_b32 v47, 0
  v_mov_b32 v48, 0
  v_mov_b32 v49, 0
  v_mov_b32 v50, 0
  v_mov_b32 v51, 0
  v_mov_b32 v52, 0
  v_mov_b32 v53, 0
  v_mov_b32 v54, 0
  v_mov_b32 v55, 0
  v_mov_b32 v56, 0
  v_mov_b32 v57, 0
  v_mov_b32 v58, 0
  v_mov_b32 v59, 0
  s_add_u32 s31, s25, 4096
  s_mov_b32 s30, 1048576
  buffer_load_dwordx4 v[60:63], v115, s[4:7], s31 offen offset:0 sc1
  buffer_load_dwordx4 v[64:67], v115, s[4:7], s31 offen offset:1024 sc1
Lpoll_152:
  s_waitcnt vmcnt(0)
  v_max3_u32 v3, v60, v61, v62
  v_max3_u32 v3, v3, v63, v64
  v_max3_u32 v3, v3, v65, v66
  v_max_u32 v3, v3, v67
  v_cmp_eq_u32 vcc, -1, v3
  s_cbranch_vccz Ljoin_1530
  s_sleep 2
  s_cmp_ge_u32 s24, 52
  s_cbranch_scc1 Lnap_155
  s_sleep 120
Lnap_155:
Lfail_154:
  buffer_load_dwordx4 v[60:63], v115, s[4:7], s31 offen offset:0 sc1
  buffer_load_dwordx4 v[64:67], v115, s[4:7], s31 offen offset:1024 sc1
  s_sub_u32 s30, s30, 1
  s_cbranch_scc0 Lpoll_152
  s_branch Lk1_exit
Ljoin_1530:
  ds_write_b128 v115, v[60:63] offset:4096
  ds_write_b128 v115, v[64:67] offset:5120
  ds_read_b64_tr_b16 v[20:21], v113 offset:4096
  ds_read_b64_tr_b16 v[22:23], v113 offset:4224
  ds_read_b64_tr_b16 v[24:25], v113 offset:5120
  ds_read_b64_tr_b16 v[26:27], v113 offset:5248
Ljoin_153:
  s_waitcnt lgkmcnt(4)
  s_barrier
  s_waitcnt lgkmcnt(0)
  v_smfmac_f32_16x16x64_bf16 v[32:35], v[20:23], v[152:159], v112
  ds_read_b64_tr_b16 v[4:5], v113 offset:0
  v_smfmac_f32_16x16x64_bf16 v[36:39], v[20:23], v[208:215], v112
  ds_read_b64_tr_b16 v[6:7], v113 offset:128
  v_smfmac_f32_16x16x64_bf16 v[40:43], v[20:23], a[8:15], v112
  ds_read_b64_tr_b16 v[8:9], v113 offset:1024
  v_smfmac_f32_16x16x64_bf16 v[44:47], v[20:23], a[64:71], v112
  ds_read_b64_tr_b16 v[10:11], v113 offset:1152
  v_smfmac_f32_16x16x64_bf16 v[48:51], v[20:23], a[120:127], v112
  ds_read_b64_tr_b16 v[12:13], v113 offset:2048
  v_smfmac_f32_16x16x64_bf16 v[52:55], v[20:23], a[176:183], v112
  ds_read_b64_tr_b16 v[14:15], v113 offset:2176
  v_smfmac_f32_16x16x64_bf16 v[56:59], v[20:23], a[232:239], v112
  ds_read_b64_tr_b16 v[16:17], v113 offset:3072
  v_smfmac_f32_16x16x64_bf16 v[32:35], v[24:27], v[160:167], v112
  ds_read_b64_tr_b16 v[18:19], v113 offset:3200
  v_smfmac_f32_16x16x64_bf16 v[36:39], v[24:27], v[216:223], v112
  ds_read_b64_tr_b16 v[28:29], v113 offset:6144
  v_smfmac_f32_16x16x64_bf16 v[40:43], v[24:27], a[16:23], v112
  ds_read_b64_tr_b16 v[30:31], v113 offset:6272
  v_smfmac_f32_16x16x64_bf16 v[44:47], v[24:27], a[72:79], v112
  v_smfmac_f32_16x16x64_bf16 v[48:51], v[24:27], a[128:135], v112
  v_smfmac_f32_16x16x64_bf16 v[52:55], v[24:27], a[184:191], v112
  v_smfmac_f32_16x16x64_bf16 v[56:59], v[24:27], a[240:247], v112
  s_waitcnt lgkmcnt(8)
  v_smfmac_f32_16x16x64_bf16 v[32:35], v[4:7], v[120:127], v112
  s_waitcnt lgkmcnt(6)
  v_smfmac_f32_16x16x64_bf16 v[32:35], v[8:11], v[128:135], v112
  s_waitcnt lgkmcnt(4)
  v_smfmac_f32_16x16x64_bf16 v[32:35], v[12:15], v[136:143], v112
  s_waitcnt lgkmcnt(2)
  v_smfmac_f32_16x16x64_bf16 v[32:35], v[16:19], v[144:151], v112
  s_waitcnt lgkmcnt(0)
  v_smfmac_f32_16x16x64_bf16 v[32:35], v[28:31], v[168:175], v112
  v_smfmac_f32_16x16x64_bf16 v[36:39], v[4:7], v[176:183], v112
  v_smfmac_f32_16x16x64_bf16 v[36:39], v[8:11], v[184:191], v112
  v_smfmac_f32_16x16x64_bf16 v[36:39], v[12:15], v[192:199], v112
  v_smfmac_f32_16x16x64_bf16 v[36:39], v[16:19], v[200:207], v112
  s_nop 3
  v_add_f32 v32, v32, v34
  v_smfmac_f32_16x16x64_bf16 v[36:39], v[28:31], v[224:231], v112
  v_add_f32 v33, v33, v35
  v_smfmac_f32_16x16x64_bf16 v[40:43], v[4:7], v[232:239], v112
  v_cvt_pk_bf16_f32 v32, v32, v33
  v_smfmac_f32_16x16x64_bf16 v[40:43], v[8:11], v[240:247], v112
  ds_write_b32 v114, v32 offset:11264
  v_smfmac_f32_16x16x64_bf16 v[40:43], v[12:15], v[248:255], v112
  v_smfmac_f32_16x16x64_bf16 v[40:43], v[16:19], a[0:7], v112
  s_nop 0
  v_add_f32 v36, v36, v38
  v_smfmac_f32_16x16x64_bf16 v[40:43], v[28:31], a[24:31], v112
  v_add_f32 v37, v37, v39
  v_smfmac_f32_16x16x64_bf16 v[44:47], v[4:7], a[32:39], v112
  v_cvt_pk_bf16_f32 v36, v36, v37
  v_smfmac_f32_16x16x64_bf16 v[44:47], v[8:11], a[40:47], v112
  ds_write_b32 v114, v36 offset:11520
  v_smfmac_f32_16x16x64_bf16 v[44:47], v[12:15], a[48:55], v112
  v_smfmac_f32_16x16x64_bf16 v[44:47], v[16:19], a[56:63], v112
  s_nop 0
  v_add_f32 v40, v40, v42
  v_smfmac_f32_16x16x64_bf16 v[44:47], v[28:31], a[80:87], v112
  v_add_f32 v41, v41, v43
  v_smfmac_f32_16x16x64_bf16 v[48:51], v[4:7], a[88:95], v112
  v_cvt_pk_bf16_f32 v40, v40, v41
  v_smfmac_f32_16x16x64_bf16 v[48:51], v[8:11], a[96:103], v112
  ds_write_b32 v114, v40 offset:11776
  v_smfmac_f32_16x16x64_bf16 v[48:51], v[12:15], a[104:111], v112
  v_smfmac_f32_16x16x64_bf16 v[48:51], v[16:19], a[112:119], v112
  s_nop 0
  v_add_f32 v44, v44, v46
  v_smfmac_f32_16x16x64_bf16 v[48:51], v[28:31], a[136:143], v112
  v_add_f32 v45, v45, v47
  v_smfmac_f32_16x16x64_bf16 v[52:55], v[4:7], a[144:151], v112
  v_cvt_pk_bf16_f32 v44, v44, v45
  v_smfmac_f32_16x16x64_bf16 v[52:55], v[8:11], a[152:159], v112
  ds_write_b32 v114, v44 offset:12032
  v_smfmac_f32_16x16x64_bf16 v[52:55], v[12:15], a[160:167], v112
  v_smfmac_f32_16x16x64_bf16 v[52:55], v[16:19], a[168:175], v112
  s_nop 0
  v_add_f32 v48, v48, v50
  v_smfmac_f32_16x16x64_bf16 v[52:55], v[28:31], a[192:199], v112
  v_add_f32 v49, v49, v51
  v_smfmac_f32_16x16x64_bf16 v[56:59], v[4:7], a[200:207], v112
  v_cvt_pk_bf16_f32 v48, v48, v49
  v_smfmac_f32_16x16x64_bf16 v[56:59], v[8:11], a[208:215], v112
  ds_write_b32 v114, v48 offset:12288
  v_smfmac_f32_16x16x64_bf16 v[56:59], v[12:15], a[216:223], v112
  v_smfmac_f32_16x16x64_bf16 v[56:59], v[16:19], a[224:231], v112
  s_nop 0
  v_add_f32 v52, v52, v54
  v_smfmac_f32_16x16x64_bf16 v[56:59], v[28:31], a[248:255], v112
  v_add_f32 v53, v53, v55
  v_cvt_pk_bf16_f32 v52, v52, v53
  ds_write_b32 v114, v52 offset:12544
  s_nop 4
  v_add_f32 v56, v56, v58
  v_add_f32 v57, v57, v59
  v_cvt_pk_bf16_f32 v56, v56, v57
  ds_write_b32 v114, v56 offset:12800
  ds_read_b128 v[92:95], v115 offset:11264
  ds_read_b128 v[96:99], v115 offset:12160
  s_waitcnt lgkmcnt(0)
  buffer_store_dwordx4 v[92:95], v100, s[4:7], s46 offen offset:0 sc1
  buffer_store_dwordx4 v[96:99], v100, s[4:7], s46 offen offset:896 sc1
  s_barrier
  s_add_u32 s46, s46, 7168
  s_add_u32 s25, s25, 7168
  s_add_u32 s24, s24, 1
  s_cmp_lt_u32 s24, 64
  s_cbranch_scc1 Ly_loop_151
  s_waitcnt vmcnt(0)
  s_barrier
  s_endpgm
Ly_w_140:
Ly_loop_156:
  v_mov_b32 v32, 0
  v_mov_b32 v33, 0
  v_mov_b32 v34, 0
  v_mov_b32 v35, 0
  v_mov_b32 v36, 0
  v_mov_b32 v37, 0
  v_mov_b32 v38, 0
  v_mov_b32 v39, 0
  v_mov_b32 v40, 0
  v_mov_b32 v41, 0
  v_mov_b32 v42, 0
  v_mov_b32 v43, 0
  v_mov_b32 v44, 0
  v_mov_b32 v45, 0
  v_mov_b32 v46, 0
  v_mov_b32 v47, 0
  v_mov_b32 v48, 0
  v_mov_b32 v49, 0
  v_mov_b32 v50, 0
  v_mov_b32 v51, 0
  v_mov_b32 v52, 0
  v_mov_b32 v53, 0
  v_mov_b32 v54, 0
  v_mov_b32 v55, 0
  v_mov_b32 v56, 0
  v_mov_b32 v57, 0
  v_mov_b32 v58, 0
  v_mov_b32 v59, 0
  s_add_u32 s31, s25, 4096
  s_mov_b32 s30, 1048576
  buffer_load_dwordx4 v[60:63], v115, s[4:7], s31 offen offset:2048 sc1
Lpoll_157:
  s_waitcnt vmcnt(0)
  v_max3_u32 v3, v60, v61, v62
  v_max_u32 v3, v3, v63
  v_cmp_eq_u32 vcc, -1, v3
  s_cbranch_vccz Ljoin_1580
  s_sleep 2
  s_cmp_ge_u32 s24, 52
  s_cbranch_scc1 Lnap_160
  s_sleep 120
Lnap_160:
Lfail_159:
  buffer_load_dwordx4 v[60:63], v115, s[4:7], s31 offen offset:2048 sc1
  s_sub_u32 s30, s30, 1
  s_cbranch_scc0 Lpoll_157
  s_branch Lk1_exit
Ljoin_1580:
  ds_write_b128 v115, v[60:63] offset:6144
  ds_read_b64_tr_b16 v[28:29], v113 offset:6144
  ds_read_b64_tr_b16 v[30:31], v113 offset:6272
Ljoin_158:
  s_waitcnt lgkmcnt(2)
  s_barrier
  s_cmp_eq_u32 s24, 0
  s_cbranch_scc1 Lsk_161
  s_mov_b64 exec, 1
  buffer_store_dword v101, off, s[4:7], s47 sc1
  s_mov_b64 exec, -1
  s_add_u32 s47, s47, 64
Lsk_161:
  s_waitcnt lgkmcnt(0)
  v_smfmac_f32_16x16x64_bf16 v[32:35], v[28:31], v[168:175], v112
  ds_read_b64_tr_b16 v[4:5], v113 offset:0
  ds_read_b64_tr_b16 v[6:7], v113 offset:128
  v_smfmac_f32_16x16x64_bf16 v[36:39], v[28:31], v[224:231], v112
  ds_read_b64_tr_b16 v[8:9], v113 offset:1024
  ds_read_b64_tr_b16 v[10:11], v113 offset:1152
  v_smfmac_f32_16x16x64_bf16 v[40:43], v[28:31], a[24:31], v112
  ds_read_b64_tr_b16 v[12:13], v113 offset:2048
  ds_read_b64_tr_b16 v[14:15], v113 offset:2176
  v_smfmac_f32_16x16x64_bf16 v[44:47], v[28:31], a[80:87], v112
  ds_read_b64_tr_b16 v[16:17], v113 offset:3072
  ds_read_b64_tr_b16 v[18:19], v113 offset:3200
  v_smfmac_f32_16x16x64_bf16 v[48:51], v[28:31], a[136:143], v112
  ds_read_b64_tr_b16 v[20:21], v113 offset:4096
  ds_read_b64_tr_b16 v[22:23], v113 offset:4224
  v_smfmac_f32_16x16x64_bf16 v[52:55], v[28:31], a[192:199], v112
  ds_read_b64_tr_b16 v[24:25], v113 offset:5120
  ds_read_b64_tr_b16 v[26:27], v113 offset:5248
  v_smfmac_f32_16x16x64_bf16 v[56:59], v[28:31], a[248:255], v112
  s_waitcnt lgkmcnt(10)
  v_smfmac_f32_16x16x64_bf16 v[32:35], v[4:7], v[120:127], v112
  s_waitcnt lgkmcnt(8)
  v_smfmac_f32_16x16x64_bf16 v[32:35], v[8:11], v[128:135], v112
  s_waitcnt lgkmcnt(6)
  v_smfmac_f32_16x16x64_bf16 v[32:35], v[12:15], v[136:143], v112
  s_waitcnt lgkmcnt(4)
  v_smfmac_f32_16x16x64_bf16 v[32:35], v[16:19], v[144:151], v112
  s_waitcnt lgkmcnt(2)
  v_smfmac_f32_16x16x64_bf16 v[32:35], v[20:23], v[152:159], v112
  s_waitcnt lgkmcnt(0)
  v_smfmac_f32_16x16x64_bf16 v[32:35], v[24:27], v[160:167], v112
  v_smfmac_f32_16x16x64_bf16 v[36:39], v[4:7], v[176:183], v112
  v_smfmac_f32_16x16x64_bf16 v[36:39], v[8:11], v[184:191], v112
  v_smfmac_f32_16x16x64_bf16 v[36:39], v[12:15], v[192:199], v112
  v_smfmac_f32_16x16x64_bf16 v[36:39], v[16:19], v[200:207], v112
  s_nop 3
  v_add_f32 v32, v32, v34
  v_smfmac_f32_16x16x64_bf16 v[36:39], v[20:23], v[208:215], v112
  v_add_f32 v33, v33, v35
  v_smfmac_f32_16x16x64_bf16 v[36:39], v[24:27], v[216:223], v112
  v_cvt_pk_bf16_f32 v32, v32, v33
  v_smfmac_f32_16x16x64_bf16 v[40:43], v[4:7], v[232:239], v112
  ds_write_b32 v114, v32 offset:13056
  v_smfmac_f32_16x16x64_bf16 v[40:43], v[8:11], v[240:247], v112
  v_smfmac_f32_16x16x64_bf16 v[40:43], v[12:15], v[248:255], v112
  v_smfmac_f32_16x16x64_bf16 v[40:43], v[16:19], a[0:7], v112
  s_nop 1
  v_add_f32 v36, v36, v38
  v_smfmac_f32_16x16x64_bf16 v[40:43], v[20:23], a[8:15], v112
  v_add_f32 v37, v37, v39
  v_smfmac_f32_16x16x64_bf16 v[40:43], v[24:27], a[16:23], v112
  v_cvt_pk_bf16_f32 v36, v36, v37
  v_smfmac_f32_16x16x64_bf16 v[44:47], v[4:7], a[32:39], v112
  ds_write_b32 v114, v36 offset:13312
  v_smfmac_f32_16x16x64_bf16 v[44:47], v[8:11], a[40:47], v112
  v_smfmac_f32_16x16x64_bf16 v[44:47], v[12:15], a[48:55], v112
  v_smfmac_f32_16x16x64_bf16 v[44:47], v[16:19], a[56:63], v112
  s_nop 1
  v_add_f32 v40, v40, v42
  v_smfmac_f32_16x16x64_bf16 v[44:47], v[20:23], a[64:71], v112
  v_add_f32 v41, v41, v43
  v_smfmac_f32_16x16x64_bf16 v[44:47], v[24:27], a[72:79], v112
  v_cvt_pk_bf16_f32 v40, v40, v41
  v_smfmac_f32_16x16x64_bf16 v[48:51], v[4:7], a[88:95], v112
  ds_write_b32 v114, v40 offset:13568
  v_smfmac_f32_16x16x64_bf16 v[48:51], v[8:11], a[96:103], v112
  v_smfmac_f32_16x16x64_bf16 v[48:51], v[12:15], a[104:111], v112
  v_smfmac_f32_16x16x64_bf16 v[48:51], v[16:19], a[112:119], v112
  s_nop 1
  v_add_f32 v44, v44, v46
  v_smfmac_f32_16x16x64_bf16 v[48:51], v[20:23], a[120:127], v112
  v_add_f32 v45, v45, v47
  v_smfmac_f32_16x16x64_bf16 v[48:51], v[24:27], a[128:135], v112
  v_cvt_pk_bf16_f32 v44, v44, v45
  v_smfmac_f32_16x16x64_bf16 v[52:55], v[4:7], a[144:151], v112
  ds_write_b32 v114, v44 offset:13824
  v_smfmac_f32_16x16x64_bf16 v[52:55], v[8:11], a[152:159], v112
  v_smfmac_f32_16x16x64_bf16 v[52:55], v[12:15], a[160:167], v112
  v_smfmac_f32_16x16x64_bf16 v[52:55], v[16:19], a[168:175], v112
  s_nop 1
  v_add_f32 v48, v48, v50
  v_smfmac_f32_16x16x64_bf16 v[52:55], v[20:23], a[176:183], v112
  v_add_f32 v49, v49, v51
  v_smfmac_f32_16x16x64_bf16 v[52:55], v[24:27], a[184:191], v112
  v_cvt_pk_bf16_f32 v48, v48, v49
  v_smfmac_f32_16x16x64_bf16 v[56:59], v[4:7], a[200:207], v112
  ds_write_b32 v114, v48 offset:14080
  v_smfmac_f32_16x16x64_bf16 v[56:59], v[8:11], a[208:215], v112
  v_smfmac_f32_16x16x64_bf16 v[56:59], v[12:15], a[216:223], v112
  v_smfmac_f32_16x16x64_bf16 v[56:59], v[16:19], a[224:231], v112
  s_nop 1
  v_add_f32 v52, v52, v54
  v_smfmac_f32_16x16x64_bf16 v[56:59], v[20:23], a[232:239], v112
  v_add_f32 v53, v53, v55
  v_smfmac_f32_16x16x64_bf16 v[56:59], v[24:27], a[240:247], v112
  v_cvt_pk_bf16_f32 v52, v52, v53
  ds_write_b32 v114, v52 offset:14336
  s_nop 5
  v_add_f32 v56, v56, v58
  v_add_f32 v57, v57, v59
  v_cvt_pk_bf16_f32 v56, v56, v57
  ds_write_b32 v114, v56 offset:14592
  ds_read_b128 v[92:95], v115 offset:13056
  ds_read_b128 v[96:99], v115 offset:13952
  s_waitcnt lgkmcnt(0)
  buffer_store_dwordx4 v[92:95], v100, s[4:7], s46 offen offset:0 sc1
  buffer_store_dwordx4 v[96:99], v100, s[4:7], s46 offen offset:896 sc1
  s_barrier
  s_add_u32 s46, s46, 7168
  s_add_u32 s25, s25, 7168
  s_add_u32 s24, s24, 1
  s_cmp_lt_u32 s24, 64
  s_cbranch_scc1 Ly_loop_156
  s_waitcnt vmcnt(0)
  s_barrier
  s_mov_b64 exec, 1
  buffer_store_dword v101, off, s[4:7], s47 sc1
  s_mov_b64 exec, -1
  s_add_u32 s47, s47, 64
  s_endpgm
Lny_136:
  s_mov_b32 s27, 72558848
  s_mov_b32 s30, 1048576
Lwf_162:
  buffer_load_dword v110, v112, s[4:7], s27 offen sc1
  s_waitcnt vmcnt(0)
  v_cmp_gt_u32 vcc, 0xe0, v110
  s_cbranch_vccz Lwfd_163
  s_sleep 2
  s_cmp_ge_u32 s41, 61
  s_cbranch_scc1 Lnap_164
  s_sleep 8
Lnap_164:
  s_sub_u32 s30, s30, 1
  s_cbranch_scc0 Lwf_162
  s_branch Lk1_exit
Lwfd_163:
  s_cmp_ge_u32 s40, 128
  s_cbranch_scc1 Ll_done
  s_and_b32 s43, s40, 3
  s_lshr_b32 s41, s40, 2
  s_lshl_b32 s41, s41, 1
  s_lshl_b32 s42, s43, 2
  s_add_u32 s42, s42, s20
  s_mul_i32 s44, s20, 14848
  s_mul_i32 s45, s41, 28672
  s_mul_i32 s26, s20, 14336
  s_add_u32 s45, s45, s26
  s_mov_b64 exec, s[56:57]
  s_add_u32 m0, s44, 0
  s_nop 0
  buffer_load_dwordx4 v1, s[8:11], s45 offen offset:0 lds
  s_add_u32 m0, s44, 32
  s_nop 0
  buffer_load_dwordx4 v1, s[8:11], s45 offen offset:896 lds
  s_add_u32 m0, s44, 64
  s_nop 0
  buffer_load_dwordx4 v1, s[8:11], s45 offen offset:1792 lds
  s_add_u32 m0, s44, 96
  s_nop 0
  buffer_load_dwordx4 v1, s[8:11], s45 offen offset:2688 lds
  s_add_u32 s45, s45, 3584
  s_add_u32 m0, s44, 3712
  s_nop 0
  buffer_load_dwordx4 v1, s[8:11], s45 offen offset:0 lds
  s_add_u32 m0, s44, 3744
  s_nop 0
  buffer_load_dwordx4 v1, s[8:11], s45 offen offset:896 lds
  s_add_u32 m0, s44, 3776
  s_nop 0
  buffer_load_dwordx4 v1, s[8:11], s45 offen offset:1792 lds
  s_add_u32 m0, s44, 3808
  s_nop 0
  buffer_load_dwordx4 v1, s[8:11], s45 offen offset:2688 lds
  s_add_u32 s45, s45, 3584
  s_add_u32 m0, s44, 7424
  s_nop 0
  buffer_load_dwordx4 v1, s[8:11], s45 offen offset:0 lds
  s_add_u32 m0, s44, 7456
  s_nop 0
  buffer_load_dwordx4 v1, s[8:11], s45 offen offset:896 lds
  s_add_u32 m0, s44, 7488
  s_nop 0
  buffer_load_dwordx4 v1, s[8:11], s45 offen offset:1792 lds
  s_add_u32 m0, s44, 7520
  s_nop 0
  buffer_load_dwordx4 v1, s[8:11], s45 offen offset:2688 lds
  s_add_u32 s45, s45, 3584
  s_add_u32 m0, s44, 11136
  s_nop 0
  buffer_load_dwordx4 v1, s[8:11], s45 offen offset:0 lds
  s_add_u32 m0, s44, 11168
  s_nop 0
  buffer_load_dwordx4 v1, s[8:11], s45 offen offset:896 lds
  s_add_u32 m0, s44, 11200
  s_nop 0
  buffer_load_dwordx4 v1, s[8:11], s45 offen offset:1792 lds
  s_add_u32 m0, s44, 11232
  s_nop 0
  buffer_load_dwordx4 v1, s[8:11], s45 offen offset:2688 lds
  s_mov_b64 exec, -1
  s_mul_i32 s28, s42, 86016
  s_add_u32 s28, s28, 79968256
  buffer_load_dwordx4 v[120:123], v1, s[4:7], s28 offen offset:0 sc1
  buffer_load_dwordx4 v[124:127], v1, s[4:7], s28 offen offset:1024 sc1
  buffer_load_dwordx4 v[128:131], v1, s[4:7], s28 offen offset:2048 sc1
  buffer_load_dwordx4 v[132:135], v1, s[4:7], s28 offen offset:3072 sc1
  s_add_u32 s28, s28, 4096
  buffer_load_dwordx4 v[136:139], v1, s[4:7], s28 offen offset:0 sc1
  buffer_load_dwordx4 v[140:143], v1, s[4:7], s28 offen offset:1024 sc1
  buffer_load_dwordx4 v[144:147], v1, s[4:7], s28 offen offset:2048 sc1
  buffer_load_dwordx4 v[148:151], v1, s[4:7], s28 offen offset:3072 sc1
  s_add_u32 s28, s28, 4096
  buffer_load_dwordx4 v[152:155], v1, s[4:7], s28 offen offset:0 sc1
  buffer_load_dwordx4 v[156:159], v1, s[4:7], s28 offen offset:1024 sc1
  buffer_load_dwordx4 v[160:163], v1, s[4:7], s28 offen offset:2048 sc1
  buffer_load_dwordx4 v[164:167], v1, s[4:7], s28 offen offset:3072 sc1
  s_add_u32 s28, s28, 4096
  buffer_load_dwordx4 v[168:171], v1, s[4:7], s28 offen offset:0 sc1
  buffer_load_dwordx4 v[172:175], v1, s[4:7], s28 offen offset:1024 sc1
  buffer_load_dwordx4 v[176:179], v1, s[4:7], s28 offen offset:2048 sc1
  buffer_load_dwordx4 v[180:183], v1, s[4:7], s28 offen offset:3072 sc1
  s_add_u32 s28, s28, 4096
  buffer_load_dwordx4 v[184:187], v1, s[4:7], s28 offen offset:0 sc1
  buffer_load_dwordx4 v[188:191], v1, s[4:7], s28 offen offset:1024 sc1
  buffer_load_dwordx4 v[192:195], v1, s[4:7], s28 offen offset:2048 sc1
  buffer_load_dwordx4 v[196:199], v1, s[4:7], s28 offen offset:3072 sc1
  s_add_u32 s28, s28, 4096
  buffer_load_dwordx4 v[200:203], v1, s[4:7], s28 offen offset:0 sc1
  buffer_load_dwordx4 v[204:207], v1, s[4:7], s28 offen offset:1024 sc1
  buffer_load_dwordx4 v[208:211], v1, s[4:7], s28 offen offset:2048 sc1
  buffer_load_dwordx4 v[212:215], v1, s[4:7], s28 offen offset:3072 sc1
  s_add_u32 s28, s28, 4096
  buffer_load_dwordx4 v[216:219], v1, s[4:7], s28 offen offset:0 sc1
  buffer_load_dwordx4 v[220:223], v1, s[4:7], s28 offen offset:1024 sc1
  buffer_load_dwordx4 v[224:227], v1, s[4:7], s28 offen offset:2048 sc1
  buffer_load_dwordx4 v[228:231], v1, s[4:7], s28 offen offset:3072 sc1
  s_add_u32 s28, s28, 4096
  buffer_load_dwordx4 v[232:235], v1, s[4:7], s28 offen offset:0 sc1
  buffer_load_dwordx4 v[236:239], v1, s[4:7], s28 offen offset:1024 sc1
  buffer_load_dwordx4 v[240:243], v1, s[4:7], s28 offen offset:2048 sc1
  buffer_load_dwordx4 v[244:247], v1, s[4:7], s28 offen offset:3072 sc1
  s_add_u32 s28, s28, 4096
  buffer_load_dwordx4 v[248:251], v1, s[4:7], s28 offen offset:0 sc1
  buffer_load_dwordx4 v[252:255], v1, s[4:7], s28 offen offset:1024 sc1
  buffer_load_dwordx4 a[0:3], v1, s[4:7], s28 offen offset:2048 sc1
  buffer_load_dwordx4 a[4:7], v1, s[4:7], s28 offen offset:3072 sc1
  s_add_u32 s28, s28, 4096
  buffer_load_dwordx4 a[8:11], v1, s[4:7], s28 offen offset:0 sc1
  buffer_load_dwordx4 a[12:15], v1, s[4:7], s28 offen offset:1024 sc1
  buffer_load_dwordx4 a[16:19], v1, s[4:7], s28 offen offset:2048 sc1
  buffer_load_dwordx4 a[20:23], v1, s[4:7], s28 offen offset:3072 sc1
  s_add_u32 s28, s28, 4096
  buffer_load_dwordx4 a[24:27], v1, s[4:7], s28 offen offset:0 sc1
  buffer_load_dwordx4 a[28:31], v1, s[4:7], s28 offen offset:1024 sc1
  buffer_load_dwordx4 a[32:35], v1, s[4:7], s28 offen offset:2048 sc1
  buffer_load_dwordx4 a[36:39], v1, s[4:7], s28 offen offset:3072 sc1
  s_add_u32 s28, s28, 4096
  buffer_load_dwordx4 a[40:43], v1, s[4:7], s28 offen offset:0 sc1
  buffer_load_dwordx4 a[44:47], v1, s[4:7], s28 offen offset:1024 sc1
  buffer_load_dwordx4 a[48:51], v1, s[4:7], s28 offen offset:2048 sc1
  buffer_load_dwordx4 a[52:55], v1, s[4:7], s28 offen offset:3072 sc1
  s_add_u32 s28, s28, 4096
  buffer_load_dwordx4 a[56:59], v1, s[4:7], s28 offen offset:0 sc1
  buffer_load_dwordx4 a[60:63], v1, s[4:7], s28 offen offset:1024 sc1
  buffer_load_dwordx4 a[64:67], v1, s[4:7], s28 offen offset:2048 sc1
  buffer_load_dwordx4 a[68:71], v1, s[4:7], s28 offen offset:3072 sc1
  s_add_u32 s28, s28, 4096
  buffer_load_dwordx4 a[72:75], v1, s[4:7], s28 offen offset:0 sc1
  buffer_load_dwordx4 a[76:79], v1, s[4:7], s28 offen offset:1024 sc1
  buffer_load_dwordx4 a[80:83], v1, s[4:7], s28 offen offset:2048 sc1
  buffer_load_dwordx4 a[84:87], v1, s[4:7], s28 offen offset:3072 sc1
  s_add_u32 s28, s28, 4096
  buffer_load_dwordx4 a[88:91], v1, s[4:7], s28 offen offset:0 sc1
  buffer_load_dwordx4 a[92:95], v1, s[4:7], s28 offen offset:1024 sc1
  buffer_load_dwordx4 a[96:99], v1, s[4:7], s28 offen offset:2048 sc1
  buffer_load_dwordx4 a[100:103], v1, s[4:7], s28 offen offset:3072 sc1
  s_add_u32 s28, s28, 4096
  buffer_load_dwordx4 a[104:107], v1, s[4:7], s28 offen offset:0 sc1
  buffer_load_dwordx4 a[108:111], v1, s[4:7], s28 offen offset:1024 sc1
  buffer_load_dwordx4 a[112:115], v1, s[4:7], s28 offen offset:2048 sc1
  buffer_load_dwordx4 a[116:119], v1, s[4:7], s28 offen offset:3072 sc1
  s_add_u32 s28, s28, 4096
  buffer_load_dwordx4 a[120:123], v1, s[4:7], s28 offen offset:0 sc1
  buffer_load_dwordx4 a[124:127], v1, s[4:7], s28 offen offset:1024 sc1
  buffer_load_dwordx4 a[128:131], v1, s[4:7], s28 offen offset:2048 sc1
  buffer_load_dwordx4 a[132:135], v1, s[4:7], s28 offen offset:3072 sc1
  s_add_u32 s28, s28, 4096
  buffer_load_dwordx4 a[136:139], v1, s[4:7], s28 offen offset:0 sc1
  buffer_load_dwordx4 a[140:143], v1, s[4:7], s28 offen offset:1024 sc1
  buffer_load_dwordx4 a[144:147], v1, s[4:7], s28 offen offset:2048 sc1
  buffer_load_dwordx4 a[148:151], v1, s[4:7], s28 offen offset:3072 sc1
  s_add_u32 s28, s28, 4096
  buffer_load_dwordx4 a[152:155], v1, s[4:7], s28 offen offset:0 sc1
  buffer_load_dwordx4 a[156:159], v1, s[4:7], s28 offen offset:1024 sc1
  buffer_load_dwordx4 a[160:163], v1, s[4:7], s28 offen offset:2048 sc1
  buffer_load_dwordx4 a[164:167], v1, s[4:7], s28 offen offset:3072 sc1
  s_add_u32 s28, s28, 4096
  buffer_load_dwordx4 a[168:171], v1, s[4:7], s28 offen offset:0 sc1
  buffer_load_dwordx4 a[172:175], v1, s[4:7], s28 offen offset:1024 sc1
  buffer_load_dwordx4 a[176:179], v1, s[4:7], s28 offen offset:2048 sc1
  buffer_load_dwordx4 a[180:183], v1, s[4:7], s28 offen offset:3072 sc1
  s_add_u32 s28, s28, 4096
  buffer_load_dwordx4 a[184:187], v1, s[4:7], s28 offen offset:0 sc1
  buffer_load_dwordx4 a[188:191], v1, s[4:7], s28 offen offset:1024 sc1
  buffer_load_dwordx4 a[192:195], v1, s[4:7], s28 offen offset:2048 sc1
  buffer_load_dwordx4 a[196:199], v1, s[4:7], s28 offen offset:3072 sc1
  v_lshlrev_b32 v100, 4, v3
  buffer_load_dwordx4 a[200:203], v100, s[52:55], 0 offen offset:0
  buffer_load_dwordx4 a[204:207], v100, s[52:55], 0 offen offset:64
  buffer_load_dwordx4 a[208:211], v100, s[52:55], 0 offen offset:128
  buffer_load_dwordx4 a[212:215], v100, s[52:55], 0 offen offset:192
  buffer_load_dwordx4 a[216:219], v100, s[52:55], 0 offen offset:256
  buffer_load_dwordx4 a[220:223], v100, s[52:55], 0 offen offset:320
  buffer_load_dwordx4 a[224:227], v100, s[52:55], 0 offen offset:384
  buffer_load_dwordx4 a[228:231], v100, s[52:55], 0 offen offset:448
  buffer_load_dwordx4 a[232:235], v100, s[52:55], 0 offen offset:512
  buffer_load_dwordx4 a[236:239], v100, s[52:55], 0 offen offset:576
  buffer_load_dwordx4 a[240:243], v100, s[52:55], 0 offen offset:640
  buffer_load_dwordx4 a[244:247], v100, s[52:55], 0 offen offset:704
  buffer_load_dwordx4 a[248:251], v100, s[52:55], 0 offen offset:768
  buffer_load_dwordx4 a[252:255], v100, s[52:55], 0 offen offset:832
  v_mul_u32_u24 v108, 928, v2
  v_lshl_add_u32 v108, v3, 4, v108
  v_lshrrev_b32 v109, 2, v2
  v_lshlrev_b32 v109, 3, v109
  v_and_b32 v100, 3, v2
  v_add_u32 v109, v109, v100
  v_mul_u32_u24 v109, 928, v109
  v_lshl_add_u32 v109, v3, 4, v109
  s_lshl_b32 s26, s20, 12
  s_add_u32 s26, s26, 61440
  v_add_u32 v111, s26, v1
  v_mov_b32 v52, 0
  v_mov_b32 v53, 0
  v_mov_b32 v54, 0
  v_mov_b32 v55, 0
  v_mov_b32 v56, 0
  v_mov_b32 v57, 0
  v_mov_b32 v58, 0
  v_mov_b32 v59, 0
  v_mov_b32 v104, 0
  v_mov_b32 v105, 0
  v_mov_b32 v106, 0
  v_mov_b32 v107, 0
  v_mov_b32 v116, 0
  v_mov_b32 v117, 0
  v_mov_b32 v118, 0
  v_mov_b32 v119, 0
  v_cmp_gt_u32 s[58:59], 3, v3
  v_cmp_eq_u32 s[60:61], 12, v2
  s_mov_b32 s48, 0
  s_waitcnt vmcnt(0)
  s_barrier
Ll_seg_165:
  ds_read_b128 v[60:63], v108 offset:0
  ds_read_b128 v[64:67], v108 offset:14848
  ds_read_b128 v[68:71], v109 offset:0
  ds_read_b128 v[72:75], v109 offset:3712
  ds_read_b128 v[76:79], v108 offset:64
  ds_read_b128 v[80:83], v108 offset:14912
  ds_read_b128 v[84:87], v109 offset:64
  ds_read_b128 v[88:91], v109 offset:3776
  s_waitcnt lgkmcnt(4)
  v_mfma_f32_16x16x32_bf16 v[4:7], v[120:123], v[60:63], 0
  v_mfma_f32_16x16x32_bf16 v[8:11], v[176:179], v[60:63], 0
  v_mfma_f32_16x16x32_bf16 v[92:95], a[200:203], v[60:63], 0
  v_mfma_f32_16x16x32_bf16 v[12:15], v[120:123], v[64:67], 0
  v_mfma_f32_16x16x32_bf16 v[16:19], v[176:179], v[64:67], 0
  v_mfma_f32_16x16x32_bf16 v[96:99], a[200:203], v[64:67], 0
  v_mfma_f32_16x16x32_bf16 v[20:23], v[68:71], v[232:235], 0
  v_mfma_f32_16x16x32_bf16 v[36:39], v[68:71], a[88:91], 0
  v_mfma_f32_16x16x32_bf16 v[24:27], v[72:75], v[232:235], 0
  v_mfma_f32_16x16x32_bf16 v[40:43], v[72:75], a[88:91], 0
  v_mfma_f32_16x16x32_bf16 v[28:31], v[68:71], a[32:35], 0
  v_mfma_f32_16x16x32_bf16 v[44:47], v[68:71], a[144:147], 0
  v_mfma_f32_16x16x32_bf16 v[32:35], v[72:75], a[32:35], 0
  v_mfma_f32_16x16x32_bf16 v[48:51], v[72:75], a[144:147], 0
  ds_read_b128 v[60:63], v108 offset:128
  ds_read_b128 v[64:67], v108 offset:14976
  ds_read_b128 v[68:71], v109 offset:128
  ds_read_b128 v[72:75], v109 offset:3840
  s_waitcnt lgkmcnt(4)
  v_mfma_f32_16x16x32_bf16 v[4:7], v[124:127], v[76:79], v[4:7]
  v_mfma_f32_16x16x32_bf16 v[8:11], v[180:183], v[76:79], v[8:11]
  v_mfma_f32_16x16x32_bf16 v[92:95], a[204:207], v[76:79], v[92:95]
  v_mfma_f32_16x16x32_bf16 v[12:15], v[124:127], v[80:83], v[12:15]
  v_mfma_f32_16x16x32_bf16 v[16:19], v[180:183], v[80:83], v[16:19]
  v_mfma_f32_16x16x32_bf16 v[96:99], a[204:207], v[80:83], v[96:99]
  v_mfma_f32_16x16x32_bf16 v[20:23], v[84:87], v[236:239], v[20:23]
  v_mfma_f32_16x16x32_bf16 v[36:39], v[84:87], a[92:95], v[36:39]
  v_mfma_f32_16x16x32_bf16 v[24:27], v[88:91], v[236:239], v[24:27]
  v_mfma_f32_16x16x32_bf16 v[40:43], v[88:91], a[92:95], v[40:43]
  v_mfma_f32_16x16x32_bf16 v[28:31], v[84:87], a[36:39], v[28:31]
  v_mfma_f32_16x16x32_bf16 v[44:47], v[84:87], a[148:151], v[44:47]
  v_mfma_f32_16x16x32_bf16 v[32:35], v[88:91], a[36:39], v[32:35]
  v_mfma_f32_16x16x32_bf16 v[48:51], v[88:91], a[148:151], v[48:51]
  ds_read_b128 v[76:79], v108 offset:192
  ds_read_b128 v[80:83], v108 offset:15040
  ds_read_b128 v[84:87], v109 offset:192
  ds_read_b128 v[88:91], v109 offset:3904
  s_waitcnt lgkmcnt(4)
  v_mfma_f32_16x16x32_bf16 v[4:7], v[128:131], v[60:63], v[4:7]
  v_mfma_f32_16x16x32_bf16 v[8:11], v[184:187], v[60:63], v[8:11]
  v_mfma_f32_16x16x32_bf16 v[92:95], a[208:211], v[60:63], v[92:95]
  v_mfma_f32_16x16x32_bf16 v[12:15], v[128:131], v[64:67], v[12:15]
  v_mfma_f32_16x16x32_bf16 v[16:19], v[184:187], v[64:67], v[16:19]
  v_mfma_f32_16x16x32_bf16 v[96:99], a[208:211], v[64:67], v[96:99]
  v_mfma_f32_16x16x32_bf16 v[20:23], v[68:71], v[240:243], v[20:23]
  v_mfma_f32_16x16x32_bf16 v[36:39], v[68:71], a[96:99], v[36:39]
  v_mfma_f32_16x16x32_bf16 v[24:27], v[72:75], v[240:243], v[24:27]
  v_mfma_f32_16x16x32_bf16 v[40:43], v[72:75], a[96:99], v[40:43]
  v_mfma_f32_16x16x32_bf16 v[28:31], v[68:71], a[40:43], v[28:31]
  v_mfma_f32_16x16x32_bf16 v[44:47], v[68:71], a[152:155], v[44:47]
  v_mfma_f32_16x16x32_bf16 v[32:35], v[72:75], a[40:43], v[32:35]
  v_mfma_f32_16x16x32_bf16 v[48:51], v[72:75], a[152:155], v[48:51]
  ds_read_b128 v[60:63], v108 offset:256
  ds_read_b128 v[64:67], v108 offset:15104
  ds_read_b128 v[68:71], v109 offset:256
  ds_read_b128 v[72:75], v109 offset:3968
  s_waitcnt lgkmcnt(4)
  v_mfma_f32_16x16x32_bf16 v[4:7], v[132:135], v[76:79], v[4:7]
  v_mfma_f32_16x16x32_bf16 v[8:11], v[188:191], v[76:79], v[8:11]
  v_mfma_f32_16x16x32_bf16 v[92:95], a[212:215], v[76:79], v[92:95]
  v_mfma_f32_16x16x32_bf16 v[12:15], v[132:135], v[80:83], v[12:15]
  v_mfma_f32_16x16x32_bf16 v[16:19], v[188:191], v[80:83], v[16:19]
  v_mfma_f32_16x16x32_bf16 v[96:99], a[212:215], v[80:83], v[96:99]
  v_mfma_f32_16x16x32_bf16 v[20:23], v[84:87], v[244:247], v[20:23]
  v_mfma_f32_16x16x32_bf16 v[36:39], v[84:87], a[100:103], v[36:39]
  v_mfma_f32_16x16x32_bf16 v[24:27], v[88:91], v[244:247], v[24:27]
  v_mfma_f32_16x16x32_bf16 v[40:43], v[88:91], a[100:103], v[40:43]
  v_mfma_f32_16x16x32_bf16 v[28:31], v[84:87], a[44:47], v[28:31]
  v_mfma_f32_16x16x32_bf16 v[44:47], v[84:87], a[156:159], v[44:47]
  v_mfma_f32_16x16x32_bf16 v[32:35], v[88:91], a[44:47], v[32:35]
  v_mfma_f32_16x16x32_bf16 v[48:51], v[88:91], a[156:159], v[48:51]
  ds_read_b128 v[76:79], v108 offset:320
  ds_read_b128 v[80:83], v108 offset:15168
  ds_read_b128 v[84:87], v109 offset:320
  ds_read_b128 v[88:91], v109 offset:4032
  s_waitcnt lgkmcnt(4)
  v_mfma_f32_16x16x32_bf16 v[4:7], v[136:139], v[60:63], v[4:7]
  v_mfma_f32_16x16x32_bf16 v[8:11], v[192:195], v[60:63], v[8:11]
  v_mfma_f32_16x16x32_bf16 v[92:95], a[216:219], v[60:63], v[92:95]
  v_mfma_f32_16x16x32_bf16 v[12:15], v[136:139], v[64:67], v[12:15]
  v_mfma_f32_16x16x32_bf16 v[16:19], v[192:195], v[64:67], v[16:19]
  v_mfma_f32_16x16x32_bf16 v[96:99], a[216:219], v[64:67], v[96:99]
  v_mfma_f32_16x16x32_bf16 v[20:23], v[68:71], v[248:251], v[20:23]
  v_mfma_f32_16x16x32_bf16 v[36:39], v[68:71], a[104:107], v[36:39]
  v_mfma_f32_16x16x32_bf16 v[24:27], v[72:75], v[248:251], v[24:27]
  v_mfma_f32_16x16x32_bf16 v[40:43], v[72:75], a[104:107], v[40:43]
  v_mfma_f32_16x16x32_bf16 v[28:31], v[68:71], a[48:51], v[28:31]
  v_mfma_f32_16x16x32_bf16 v[44:47], v[68:71], a[160:163], v[44:47]
  v_mfma_f32_16x16x32_bf16 v[32:35], v[72:75], a[48:51], v[32:35]
  v_mfma_f32_16x16x32_bf16 v[48:51], v[72:75], a[160:163], v[48:51]
  ds_read_b128 v[60:63], v108 offset:384
  ds_read_b128 v[64:67], v108 offset:15232
  ds_read_b128 v[68:71], v109 offset:384
  ds_read_b128 v[72:75], v109 offset:4096
  s_waitcnt lgkmcnt(4)
  v_mfma_f32_16x16x32_bf16 v[4:7], v[140:143], v[76:79], v[4:7]
  v_mfma_f32_16x16x32_bf16 v[8:11], v[196:199], v[76:79], v[8:11]
  v_mfma_f32_16x16x32_bf16 v[92:95], a[220:223], v[76:79], v[92:95]
  v_mfma_f32_16x16x32_bf16 v[12:15], v[140:143], v[80:83], v[12:15]
  v_mfma_f32_16x16x32_bf16 v[16:19], v[196:199], v[80:83], v[16:19]
  v_mfma_f32_16x16x32_bf16 v[96:99], a[220:223], v[80:83], v[96:99]
  v_mfma_f32_16x16x32_bf16 v[20:23], v[84:87], v[252:255], v[20:23]
  v_mfma_f32_16x16x32_bf16 v[36:39], v[84:87], a[108:111], v[36:39]
  v_mfma_f32_16x16x32_bf16 v[24:27], v[88:91], v[252:255], v[24:27]
  v_mfma_f32_16x16x32_bf16 v[40:43], v[88:91], a[108:111], v[40:43]
  v_mfma_f32_16x16x32_bf16 v[28:31], v[84:87], a[52:55], v[28:31]
  v_mfma_f32_16x16x32_bf16 v[44:47], v[84:87], a[164:167], v[44:47]
  v_mfma_f32_16x16x32_bf16 v[32:35], v[88:91], a[52:55], v[32:35]
  v_mfma_f32_16x16x32_bf16 v[48:51], v[88:91], a[164:167], v[48:51]
  ds_read_b128 v[76:79], v108 offset:448
  ds_read_b128 v[80:83], v108 offset:15296
  ds_read_b128 v[84:87], v109 offset:448
  ds_read_b128 v[88:91], v109 offset:4160
  s_waitcnt lgkmcnt(4)
  v_mfma_f32_16x16x32_bf16 v[4:7], v[144:147], v[60:63], v[4:7]
  v_mfma_f32_16x16x32_bf16 v[8:11], v[200:203], v[60:63], v[8:11]
  v_mfma_f32_16x16x32_bf16 v[92:95], a[224:227], v[60:63], v[92:95]
  v_mfma_f32_16x16x32_bf16 v[12:15], v[144:147], v[64:67], v[12:15]
  v_mfma_f32_16x16x32_bf16 v[16:19], v[200:203], v[64:67], v[16:19]
  v_mfma_f32_16x16x32_bf16 v[96:99], a[224:227], v[64:67], v[96:99]
  v_mfma_f32_16x16x32_bf16 v[20:23], v[68:71], a[0:3], v[20:23]
  v_mfma_f32_16x16x32_bf16 v[36:39], v[68:71], a[112:115], v[36:39]
  v_mfma_f32_16x16x32_bf16 v[24:27], v[72:75], a[0:3], v[24:27]
  v_mfma_f32_16x16x32_bf16 v[40:43], v[72:75], a[112:115], v[40:43]
  v_mfma_f32_16x16x32_bf16 v[28:31], v[68:71], a[56:59], v[28:31]
  v_mfma_f32_16x16x32_bf16 v[44:47], v[68:71], a[168:171], v[44:47]
  v_mfma_f32_16x16x32_bf16 v[32:35], v[72:75], a[56:59], v[32:35]
  v_mfma_f32_16x16x32_bf16 v[48:51], v[72:75], a[168:171], v[48:51]
  ds_read_b128 v[60:63], v108 offset:512
  ds_read_b128 v[64:67], v108 offset:15360
  ds_read_b128 v[68:71], v109 offset:512
  ds_read_b128 v[72:75], v109 offset:4224
  s_waitcnt lgkmcnt(4)
  v_mfma_f32_16x16x32_bf16 v[4:7], v[148:151], v[76:79], v[4:7]
  v_mfma_f32_16x16x32_bf16 v[8:11], v[204:207], v[76:79], v[8:11]
  v_mfma_f32_16x16x32_bf16 v[92:95], a[228:231], v[76:79], v[92:95]
  v_mfma_f32_16x16x32_bf16 v[12:15], v[148:151], v[80:83], v[12:15]
  v_mfma_f32_16x16x32_bf16 v[16:19], v[204:207], v[80:83], v[16:19]
  v_mfma_f32_16x16x32_bf16 v[96:99], a[228:231], v[80:83], v[96:99]
  v_mfma_f32_16x16x32_bf16 v[20:23], v[84:87], a[4:7], v[20:23]
  v_mfma_f32_16x16x32_bf16 v[36:39], v[84:87], a[116:119], v[36:39]
  v_mfma_f32_16x16x32_bf16 v[24:27], v[88:91], a[4:7], v[24:27]
  v_mfma_f32_16x16x32_bf16 v[40:43], v[88:91], a[116:119], v[40:43]
  v_mfma_f32_16x16x32_bf16 v[28:31], v[84:87], a[60:63], v[28:31]
  v_mfma_f32_16x16x32_bf16 v[44:47], v[84:87], a[172:175], v[44:47]
  v_mfma_f32_16x16x32_bf16 v[32:35], v[88:91], a[60:63], v[32:35]
  v_mfma_f32_16x16x32_bf16 v[48:51], v[88:91], a[172:175], v[48:51]
  ds_read_b128 v[76:79], v108 offset:576
  ds_read_b128 v[80:83], v108 offset:15424
  ds_read_b128 v[84:87], v109 offset:576
  ds_read_b128 v[88:91], v109 offset:4288
  s_waitcnt lgkmcnt(4)
  v_mfma_f32_16x16x32_bf16 v[4:7], v[152:155], v[60:63], v[4:7]
  v_mfma_f32_16x16x32_bf16 v[8:11], v[208:211], v[60:63], v[8:11]
  v_mfma_f32_16x16x32_bf16 v[92:95], a[232:235], v[60:63], v[92:95]
  v_mfma_f32_16x16x32_bf16 v[12:15], v[152:155], v[64:67], v[12:15]
  v_mfma_f32_16x16x32_bf16 v[16:19], v[208:211], v[64:67], v[16:19]
  v_mfma_f32_16x16x32_bf16 v[96:99], a[232:235], v[64:67], v[96:99]
  v_mfma_f32_16x16x32_bf16 v[20:23], v[68:71], a[8:11], v[20:23]
  v_mfma_f32_16x16x32_bf16 v[36:39], v[68:71], a[120:123], v[36:39]
  v_mfma_f32_16x16x32_bf16 v[24:27], v[72:75], a[8:11], v[24:27]
  v_mfma_f32_16x16x32_bf16 v[40:43], v[72:75], a[120:123], v[40:43]
  v_mfma_f32_16x16x32_bf16 v[28:31], v[68:71], a[64:67], v[28:31]
  v_mfma_f32_16x16x32_bf16 v[44:47], v[68:71], a[176:179], v[44:47]
  v_mfma_f32_16x16x32_bf16 v[32:35], v[72:75], a[64:67], v[32:35]
  v_mfma_f32_16x16x32_bf16 v[48:51], v[72:75], a[176:179], v[48:51]
  ds_read_b128 v[60:63], v108 offset:640
  ds_read_b128 v[64:67], v108 offset:15488
  ds_read_b128 v[68:71], v109 offset:640
  ds_read_b128 v[72:75], v109 offset:4352
  s_waitcnt lgkmcnt(4)
  v_mfma_f32_16x16x32_bf16 v[4:7], v[156:159], v[76:79], v[4:7]
  v_mfma_f32_16x16x32_bf16 v[8:11], v[212:215], v[76:79], v[8:11]
  v_mfma_f32_16x16x32_bf16 v[92:95], a[236:239], v[76:79], v[92:95]
  v_mfma_f32_16x16x32_bf16 v[12:15], v[156:159], v[80:83], v[12:15]
  v_mfma_f32_16x16x32_bf16 v[16:19], v[212:215], v[80:83], v[16:19]
  v_mfma_f32_16x16x32_bf16 v[96:99], a[236:239], v[80:83], v[96:99]
  v_mfma_f32_16x16x32_bf16 v[20:23], v[84:87], a[12:15], v[20:23]
  v_mfma_f32_16x16x32_bf16 v[36:39], v[84:87], a[124:127], v[36:39]
  v_mfma_f32_16x16x32_bf16 v[24:27], v[88:91], a[12:15], v[24:27]
  v_mfma_f32_16x16x32_bf16 v[40:43], v[88:91], a[124:127], v[40:43]
  v_mfma_f32_16x16x32_bf16 v[28:31], v[84:87], a[68:71], v[28:31]
  v_mfma_f32_16x16x32_bf16 v[44:47], v[84:87], a[180:183], v[44:47]
  v_mfma_f32_16x16x32_bf16 v[32:35], v[88:91], a[68:71], v[32:35]
  v_mfma_f32_16x16x32_bf16 v[48:51], v[88:91], a[180:183], v[48:51]
  ds_read_b128 v[76:79], v108 offset:704
  ds_read_b128 v[80:83], v108 offset:15552
  ds_read_b128 v[84:87], v109 offset:704
  ds_read_b128 v[88:91], v109 offset:4416
  s_waitcnt lgkmcnt(4)
  v_mfma_f32_16x16x32_bf16 v[4:7], v[160:163], v[60:63], v[4:7]
  v_mfma_f32_16x16x32_bf16 v[8:11], v[216:219], v[60:63], v[8:11]
  v_mfma_f32_16x16x32_bf16 v[92:95], a[240:243], v[60:63], v[92:95]
  v_mfma_f32_16x16x32_bf16 v[12:15], v[160:163], v[64:67], v[12:15]
  v_mfma_f32_16x16x32_bf16 v[16:19], v[216:219], v[64:67], v[16:19]
  v_mfma_f32_16x16x32_bf16 v[96:99], a[240:243], v[64:67], v[96:99]
  v_mfma_f32_16x16x32_bf16 v[20:23], v[68:71], a[16:19], v[20:23]
  v_mfma_f32_16x16x32_bf16 v[36:39], v[68:71], a[128:131], v[36:39]
  v_mfma_f32_16x16x32_bf16 v[24:27], v[72:75], a[16:19], v[24:27]
  v_mfma_f32_16x16x32_bf16 v[40:43], v[72:75], a[128:131], v[40:43]
  v_mfma_f32_16x16x32_bf16 v[28:31], v[68:71], a[72:75], v[28:31]
  v_mfma_f32_16x16x32_bf16 v[44:47], v[68:71], a[184:187], v[44:47]
  v_mfma_f32_16x16x32_bf16 v[32:35], v[72:75], a[72:75], v[32:35]
  v_mfma_f32_16x16x32_bf16 v[48:51], v[72:75], a[184:187], v[48:51]
  ds_read_b128 v[60:63], v108 offset:768
  ds_read_b128 v[64:67], v108 offset:15616
  ds_read_b128 v[68:71], v109 offset:768
  ds_read_b128 v[72:75], v109 offset:4480
  s_waitcnt lgkmcnt(4)
  v_mfma_f32_16x16x32_bf16 v[4:7], v[164:167], v[76:79], v[4:7]
  v_mfma_f32_16x16x32_bf16 v[8:11], v[220:223], v[76:79], v[8:11]
  v_mfma_f32_16x16x32_bf16 v[92:95], a[244:247], v[76:79], v[92:95]
  v_mfma_f32_16x16x32_bf16 v[12:15], v[164:167], v[80:83], v[12:15]
  v_mfma_f32_16x16x32_bf16 v[16:19], v[220:223], v[80:83], v[16:19]
  v_mfma_f32_16x16x32_bf16 v[96:99], a[244:247], v[80:83], v[96:99]
  v_mfma_f32_16x16x32_bf16 v[20:23], v[84:87], a[20:23], v[20:23]
  v_mfma_f32_16x16x32_bf16 v[36:39], v[84:87], a[132:135], v[36:39]
  v_mfma_f32_16x16x32_bf16 v[24:27], v[88:91], a[20:23], v[24:27]
  v_mfma_f32_16x16x32_bf16 v[40:43], v[88:91], a[132:135], v[40:43]
  v_mfma_f32_16x16x32_bf16 v[28:31], v[84:87], a[76:79], v[28:31]
  v_mfma_f32_16x16x32_bf16 v[44:47], v[84:87], a[188:191], v[44:47]
  v_mfma_f32_16x16x32_bf16 v[32:35], v[88:91], a[76:79], v[32:35]
  v_mfma_f32_16x16x32_bf16 v[48:51], v[88:91], a[188:191], v[48:51]
  ds_read_b128 v[76:79], v108 offset:832
  ds_read_b128 v[80:83], v108 offset:15680
  ds_read_b128 v[84:87], v109 offset:832
  ds_read_b128 v[88:91], v109 offset:4544
  s_waitcnt lgkmcnt(4)
  v_mfma_f32_16x16x32_bf16 v[4:7], v[168:171], v[60:63], v[4:7]
  v_mfma_f32_16x16x32_bf16 v[8:11], v[224:227], v[60:63], v[8:11]
  v_mfma_f32_16x16x32_bf16 v[92:95], a[248:251], v[60:63], v[92:95]
  v_mfma_f32_16x16x32_bf16 v[12:15], v[168:171], v[64:67], v[12:15]
  v_mfma_f32_16x16x32_bf16 v[16:19], v[224:227], v[64:67], v[16:19]
  v_mfma_f32_16x16x32_bf16 v[96:99], a[248:251], v[64:67], v[96:99]
  v_mfma_f32_16x16x32_bf16 v[20:23], v[68:71], a[24:27], v[20:23]
  v_mfma_f32_16x16x32_bf16 v[36:39], v[68:71], a[136:139], v[36:39]
  v_mfma_f32_16x16x32_bf16 v[24:27], v[72:75], a[24:27], v[24:27]
  v_mfma_f32_16x16x32_bf16 v[40:43], v[72:75], a[136:139], v[40:43]
  v_mfma_f32_16x16x32_bf16 v[28:31], v[68:71], a[80:83], v[28:31]
  v_mfma_f32_16x16x32_bf16 v[44:47], v[68:71], a[192:195], v[44:47]
  v_mfma_f32_16x16x32_bf16 v[32:35], v[72:75], a[80:83], v[32:35]
  v_mfma_f32_16x16x32_bf16 v[48:51], v[72:75], a[192:195], v[48:51]
  s_waitcnt lgkmcnt(0)
  v_mfma_f32_16x16x32_bf16 v[4:7], v[172:175], v[76:79], v[4:7]
  v_mfma_f32_16x16x32_bf16 v[8:11], v[228:231], v[76:79], v[8:11]
  v_mfma_f32_16x16x32_bf16 v[92:95], a[252:255], v[76:79], v[92:95]
  v_mfma_f32_16x16x32_bf16 v[12:15], v[172:175], v[80:83], v[12:15]
  v_mfma_f32_16x16x32_bf16 v[16:19], v[228:231], v[80:83], v[16:19]
  v_mfma_f32_16x16x32_bf16 v[96:99], a[252:255], v[80:83], v[96:99]
  v_mfma_f32_16x16x32_bf16 v[20:23], v[84:87], a[28:31], v[20:23]
  v_mfma_f32_16x16x32_bf16 v[36:39], v[84:87], a[140:143], v[36:39]
  v_mfma_f32_16x16x32_bf16 v[24:27], v[88:91], a[28:31], v[24:27]
  v_mfma_f32_16x16x32_bf16 v[40:43], v[88:91], a[140:143], v[40:43]
  v_mfma_f32_16x16x32_bf16 v[28:31], v[84:87], a[84:87], v[28:31]
  v_mfma_f32_16x16x32_bf16 v[44:47], v[84:87], a[196:199], v[44:47]
  v_mfma_f32_16x16x32_bf16 v[32:35], v[88:91], a[84:87], v[32:35]
  v_mfma_f32_16x16x32_bf16 v[48:51], v[88:91], a[196:199], v[48:51]
  s_nop 0
  v_mul_f32 v100, 0x3fb8aa3b, v20
  v_exp_f32 v100, v100
  v_cmp_lt_f32 vcc, 0, v20
  v_add_f32 v20, 1.0, v20
  s_nop 0
  v_cndmask_b32 v20, v100, v20, vcc
  v_add_f32 v20, 0x358637bd, v20
  v_mul_f32 v100, 0x3fb8aa3b, v21
  v_exp_f32 v100, v100
  v_cmp_lt_f32 vcc, 0, v21
  v_add_f32 v21, 1.0, v21
  s_nop 0
  v_cndmask_b32 v21, v100, v21, vcc
  v_add_f32 v21, 0x358637bd, v21
  v_mul_f32 v100, 0x3fb8aa3b, v22
  v_exp_f32 v100, v100
  v_cmp_lt_f32 vcc, 0, v22
  v_add_f32 v22, 1.0, v22
  s_nop 0
  v_cndmask_b32 v22, v100, v22, vcc
  v_add_f32 v22, 0x358637bd, v22
  v_mul_f32 v100, 0x3fb8aa3b, v23
  v_exp_f32 v100, v100
  v_cmp_lt_f32 vcc, 0, v23
  v_add_f32 v23, 1.0, v23
  s_nop 0
  v_cndmask_b32 v23, v100, v23, vcc
  v_add_f32 v23, 0x358637bd, v23
  v_mul_f32 v100, 0x3fb8aa3b, v24
  v_exp_f32 v100, v100
  v_cmp_lt_f32 vcc, 0, v24
  v_add_f32 v24, 1.0, v24
  s_nop 0
  v_cndmask_b32 v24, v100, v24, vcc
  v_add_f32 v24, 0x358637bd, v24
  v_mul_f32 v100, 0x3fb8aa3b, v25
  v_exp_f32 v100, v100
  v_cmp_lt_f32 vcc, 0, v25
  v_add_f32 v25, 1.0, v25
  s_nop 0
  v_cndmask_b32 v25, v100, v25, vcc
  v_add_f32 v25, 0x358637bd, v25
  v_mul_f32 v100, 0x3fb8aa3b, v26
  v_exp_f32 v100, v100
  v_cmp_lt_f32 vcc, 0, v26
  v_add_f32 v26, 1.0, v26
  s_nop 0
  v_cndmask_b32 v26, v100, v26, vcc
  v_add_f32 v26, 0x358637bd, v26
  v_mul_f32 v100, 0x3fb8aa3b, v27
  v_exp_f32 v100, v100
  v_cmp_lt_f32 vcc, 0, v27
  v_add_f32 v27, 1.0, v27
  s_nop 0
  v_cndmask_b32 v27, v100, v27, vcc
  v_add_f32 v27, 0x358637bd, v27
  v_mul_f32 v100, 0x3fb8aa3b, v28
  v_exp_f32 v100, v100
  v_cmp_lt_f32 vcc, 0, v28
  v_add_f32 v28, 1.0, v28
  s_nop 0
  v_cndmask_b32 v28, v100, v28, vcc
  v_add_f32 v28, 0x358637bd, v28
  v_mul_f32 v100, 0x3fb8aa3b, v29
  v_exp_f32 v100, v100
  v_cmp_lt_f32 vcc, 0, v29
  v_add_f32 v29, 1.0, v29
  s_nop 0
  v_cndmask_b32 v29, v100, v29, vcc
  v_add_f32 v29, 0x358637bd, v29
  v_mul_f32 v100, 0x3fb8aa3b, v30
  v_exp_f32 v100, v100
  v_cmp_lt_f32 vcc, 0, v30
  v_add_f32 v30, 1.0, v30
  s_nop 0
  v_cndmask_b32 v30, v100, v30, vcc
  v_add_f32 v30, 0x358637bd, v30
  v_mul_f32 v100, 0x3fb8aa3b, v31
  v_exp_f32 v100, v100
  v_cmp_lt_f32 vcc, 0, v31
  v_add_f32 v31, 1.0, v31
  s_nop 0
  v_cndmask_b32 v31, v100, v31, vcc
  v_add_f32 v31, 0x358637bd, v31
  v_mul_f32 v100, 0x3fb8aa3b, v32
  v_exp_f32 v100, v100
  v_cmp_lt_f32 vcc, 0, v32
  v_add_f32 v32, 1.0, v32
  s_nop 0
  v_cndmask_b32 v32, v100, v32, vcc
  v_add_f32 v32, 0x358637bd, v32
  v_mul_f32 v100, 0x3fb8aa3b, v33
  v_exp_f32 v100, v100
  v_cmp_lt_f32 vcc, 0, v33
  v_add_f32 v33, 1.0, v33
  s_nop 0
  v_cndmask_b32 v33, v100, v33, vcc
  v_add_f32 v33, 0x358637bd, v33
  v_mul_f32 v100, 0x3fb8aa3b, v34
  v_exp_f32 v100, v100
  v_cmp_lt_f32 vcc, 0, v34
  v_add_f32 v34, 1.0, v34
  s_nop 0
  v_cndmask_b32 v34, v100, v34, vcc
  v_add_f32 v34, 0x358637bd, v34
  v_mul_f32 v100, 0x3fb8aa3b, v35
  v_exp_f32 v100, v100
  v_cmp_lt_f32 vcc, 0, v35
  v_add_f32 v35, 1.0, v35
  s_nop 0
  v_cndmask_b32 v35, v100, v35, vcc
  v_add_f32 v35, 0x358637bd, v35
  v_cndmask_b32 v44, v44, 1.0, s[60:61]
  v_cndmask_b32 v45, v45, 1.0, s[60:61]
  v_cndmask_b32 v46, v46, 1.0, s[60:61]
  v_cndmask_b32 v47, v47, 1.0, s[60:61]
  v_cndmask_b32 v48, v48, 1.0, s[60:61]
  v_cndmask_b32 v49, v49, 1.0, s[60:61]
  v_cndmask_b32 v50, v50, 1.0, s[60:61]
  v_cndmask_b32 v51, v51, 1.0, s[60:61]
  v_cvt_pk_bf16_f32 v60, v20, v21
  v_cvt_pk_bf16_f32 v61, v22, v23
  v_cvt_pk_bf16_f32 v62, v24, v25
  v_cvt_pk_bf16_f32 v63, v26, v27
  v_cvt_pk_bf16_f32 v64, v28, v29
  v_cvt_pk_bf16_f32 v65, v30, v31
  v_cvt_pk_bf16_f32 v66, v32, v33
  v_cvt_pk_bf16_f32 v67, v34, v35
  v_cvt_pk_bf16_f32 v68, v36, v37
  v_cvt_pk_bf16_f32 v69, v38, v39
  v_cvt_pk_bf16_f32 v70, v40, v41
  v_cvt_pk_bf16_f32 v71, v42, v43
  v_cvt_pk_bf16_f32 v72, v44, v45
  v_cvt_pk_bf16_f32 v73, v46, v47
  v_cvt_pk_bf16_f32 v74, v48, v49
  v_cvt_pk_bf16_f32 v75, v50, v51
  v_mfma_f32_16x16x32_bf16 v[52:55], v[68:71], v[60:63], v[52:55]
  v_mfma_f32_16x16x32_bf16 v[56:59], v[68:71], v[64:67], v[56:59]
  v_mfma_f32_16x16x32_bf16 v[104:107], v[72:75], v[60:63], v[104:107]
  v_mfma_f32_16x16x32_bf16 v[116:119], v[72:75], v[64:67], v[116:119]
  v_mul_f32 v100, 0x3fb8aa3b, v4
  v_exp_f32 v100, v100
  v_cmp_lt_f32 vcc, 0, v4
  v_add_f32 v4, 1.0, v4
  s_nop 0
  v_cndmask_b32 v4, v100, v4, vcc
  v_add_f32 v4, 0x358637bd, v4
  v_mul_f32 v100, 0x3fb8aa3b, v5
  v_exp_f32 v100, v100
  v_cmp_lt_f32 vcc, 0, v5
  v_add_f32 v5, 1.0, v5
  s_nop 0
  v_cndmask_b32 v5, v100, v5, vcc
  v_add_f32 v5, 0x358637bd, v5
  v_mul_f32 v100, 0x3fb8aa3b, v6
  v_exp_f32 v100, v100
  v_cmp_lt_f32 vcc, 0, v6
  v_add_f32 v6, 1.0, v6
  s_nop 0
  v_cndmask_b32 v6, v100, v6, vcc
  v_add_f32 v6, 0x358637bd, v6
  v_mul_f32 v100, 0x3fb8aa3b, v7
  v_exp_f32 v100, v100
  v_cmp_lt_f32 vcc, 0, v7
  v_add_f32 v7, 1.0, v7
  s_nop 0
  v_cndmask_b32 v7, v100, v7, vcc
  v_add_f32 v7, 0x358637bd, v7
  v_mul_f32 v100, 0x3fb8aa3b, v8
  v_exp_f32 v100, v100
  v_cmp_lt_f32 vcc, 0, v8
  v_add_f32 v8, 1.0, v8
  s_nop 0
  v_cndmask_b32 v8, v100, v8, vcc
  v_add_f32 v8, 0x358637bd, v8
  v_mul_f32 v100, 0x3fb8aa3b, v9
  v_exp_f32 v100, v100
  v_cmp_lt_f32 vcc, 0, v9
  v_add_f32 v9, 1.0, v9
  s_nop 0
  v_cndmask_b32 v9, v100, v9, vcc
  v_add_f32 v9, 0x358637bd, v9
  v_mul_f32 v100, 0x3fb8aa3b, v10
  v_exp_f32 v100, v100
  v_cmp_lt_f32 vcc, 0, v10
  v_add_f32 v10, 1.0, v10
  s_nop 0
  v_cndmask_b32 v10, v100, v10, vcc
  v_add_f32 v10, 0x358637bd, v10
  v_mul_f32 v100, 0x3fb8aa3b, v11
  v_exp_f32 v100, v100
  v_cmp_lt_f32 vcc, 0, v11
  v_add_f32 v11, 1.0, v11
  s_nop 0
  v_cndmask_b32 v11, v100, v11, vcc
  v_add_f32 v11, 0x358637bd, v11
  v_mul_f32 v100, 0x3fb8aa3b, v12
  v_exp_f32 v100, v100
  v_cmp_lt_f32 vcc, 0, v12
  v_add_f32 v12, 1.0, v12
  s_nop 0
  v_cndmask_b32 v12, v100, v12, vcc
  v_add_f32 v12, 0x358637bd, v12
  v_mul_f32 v100, 0x3fb8aa3b, v13
  v_exp_f32 v100, v100
  v_cmp_lt_f32 vcc, 0, v13
  v_add_f32 v13, 1.0, v13
  s_nop 0
  v_cndmask_b32 v13, v100, v13, vcc
  v_add_f32 v13, 0x358637bd, v13
  v_mul_f32 v100, 0x3fb8aa3b, v14
  v_exp_f32 v100, v100
  v_cmp_lt_f32 vcc, 0, v14
  v_add_f32 v14, 1.0, v14
  s_nop 0
  v_cndmask_b32 v14, v100, v14, vcc
  v_add_f32 v14, 0x358637bd, v14
  v_mul_f32 v100, 0x3fb8aa3b, v15
  v_exp_f32 v100, v100
  v_cmp_lt_f32 vcc, 0, v15
  v_add_f32 v15, 1.0, v15
  s_nop 0
  v_cndmask_b32 v15, v100, v15, vcc
  v_add_f32 v15, 0x358637bd, v15
  v_mul_f32 v100, 0x3fb8aa3b, v16
  v_exp_f32 v100, v100
  v_cmp_lt_f32 vcc, 0, v16
  v_add_f32 v16, 1.0, v16
  s_nop 0
  v_cndmask_b32 v16, v100, v16, vcc
  v_add_f32 v16, 0x358637bd, v16
  v_mul_f32 v100, 0x3fb8aa3b, v17
  v_exp_f32 v100, v100
  v_cmp_lt_f32 vcc, 0, v17
  v_add_f32 v17, 1.0, v17
  s_nop 0
  v_cndmask_b32 v17, v100, v17, vcc
  v_add_f32 v17, 0x358637bd, v17
  v_mul_f32 v100, 0x3fb8aa3b, v18
  v_exp_f32 v100, v100
  v_cmp_lt_f32 vcc, 0, v18
  v_add_f32 v18, 1.0, v18
  s_nop 0
  v_cndmask_b32 v18, v100, v18, vcc
  v_add_f32 v18, 0x358637bd, v18
  v_mul_f32 v100, 0x3fb8aa3b, v19
  v_exp_f32 v100, v100
  v_cmp_lt_f32 vcc, 0, v19
  v_add_f32 v19, 1.0, v19
  s_nop 0
  v_cndmask_b32 v19, v100, v19, vcc
  v_add_f32 v19, 0x358637bd, v19
  v_cvt_pk_bf16_f32 v76, v4, v5
  v_cvt_pk_bf16_f32 v77, v6, v7
  v_cvt_pk_bf16_f32 v78, v8, v9
  v_cvt_pk_bf16_f32 v79, v10, v11
  v_cndmask_b32 v78, 0, v78, s[58:59]
  v_cndmask_b32 v79, 0, v79, s[58:59]
  ds_write_b128 v111, v[76:79] offset:0
  v_cvt_pk_bf16_f32 v80, v12, v13
  v_cvt_pk_bf16_f32 v81, v14, v15
  v_cvt_pk_bf16_f32 v82, v16, v17
  v_cvt_pk_bf16_f32 v83, v18, v19
  v_cndmask_b32 v82, 0, v82, s[58:59]
  v_cndmask_b32 v83, 0, v83, s[58:59]
  ds_write_b128 v111, v[80:83] offset:1024
  s_cmp_lg_u32 s42, 0
  s_cbranch_scc1 Lng_166
  s_add_u32 s26, s41, s48
  s_lshl_b32 s26, s26, 7
  s_add_u32 s26, s26, 86521856
  v_lshlrev_b32 v101, 2, v2
  v_mul_f32 v92, 0xbfb8aa3b, v92
  v_exp_f32 v92, v92
  s_nop 0
  v_add_f32 v92, 1.0, v92
  v_rcp_f32 v92, v92
  s_mov_b64 exec, 0xffff
  buffer_store_dword v92, v101, s[4:7], s26 offen offset:0 sc1
  s_mov_b64 exec, -1
  v_mul_f32 v96, 0xbfb8aa3b, v96
  v_exp_f32 v96, v96
  s_nop 0
  v_add_f32 v96, 1.0, v96
  v_rcp_f32 v96, v96
  s_mov_b64 exec, 0xffff
  buffer_store_dword v96, v101, s[4:7], s26 offen offset:64 sc1
  s_mov_b64 exec, -1
Lng_166:
  v_add_u32 v108, 29696, v108
  v_add_u32 v109, 29696, v109
  v_add_u32 v111, 2048, v111
  s_add_u32 s48, s48, 1
  s_cmp_lt_u32 s48, 2
  s_cbranch_scc1 Ll_seg_165
  s_lshl_b32 s26, s42, 12
  s_add_u32 s26, s26, 72562688
  v_lshlrev_b32 v100, 2, v2
  v_lshl_add_u32 v100, v3, 9, v100
  buffer_atomic_add_f32 v52, v100, s[4:7], s26 offen offset:0
  buffer_atomic_add_f32 v53, v100, s[4:7], s26 offen offset:128
  buffer_atomic_add_f32 v54, v100, s[4:7], s26 offen offset:256
  buffer_atomic_add_f32 v55, v100, s[4:7], s26 offen offset:384
  buffer_atomic_add_f32 v56, v100, s[4:7], s26 offen offset:64
  buffer_atomic_add_f32 v57, v100, s[4:7], s26 offen offset:192
  buffer_atomic_add_f32 v58, v100, s[4:7], s26 offen offset:320
  buffer_atomic_add_f32 v59, v100, s[4:7], s26 offen offset:448
  buffer_atomic_add_f32 v104, v100, s[4:7], s26 offen offset:2048
  buffer_atomic_add_f32 v105, v100, s[4:7], s26 offen offset:2176
  buffer_atomic_add_f32 v106, v100, s[4:7], s26 offen offset:2304
  buffer_atomic_add_f32 v107, v100, s[4:7], s26 offen offset:2432
  buffer_atomic_add_f32 v116, v100, s[4:7], s26 offen offset:2112
  buffer_atomic_add_f32 v117, v100, s[4:7], s26 offen offset:2240
  buffer_atomic_add_f32 v118, v100, s[4:7], s26 offen offset:2368
  buffer_atomic_add_f32 v119, v100, s[4:7], s26 offen offset:2496
  s_waitcnt vmcnt(0)
  s_barrier
  s_mov_b32 s27, 72558592
  s_cmp_lg_u32 s20, 0
  s_cbranch_scc1 Lcnt_167
  s_mov_b64 exec, 1
  buffer_atomic_add v113, v112, s[4:7], s27 offen
  s_mov_b64 exec, -1
Lcnt_167:
  s_mov_b32 s30, 1048576
Lwf_168:
  buffer_load_dword v110, v112, s[4:7], s27 offen sc1
  s_waitcnt vmcnt(0)
  v_cmp_gt_u32 vcc, 0x80, v110
  s_cbranch_vccz Lwfd_169
  s_sleep 2
  s_cmp_ge_u32 s41, 61
  s_cbranch_scc1 Lnap_170
  s_sleep 8
Lnap_170:
  s_sub_u32 s30, s30, 1
  s_cbranch_scc0 Lwf_168
  s_branch Lk1_exit
Lwfd_169:
  v_lshrrev_b32 v100, 2, v2
  v_lshlrev_b32 v100, 3, v100
  v_and_b32 v101, 3, v2
  v_add_u32 v100, v100, v101
  v_lshlrev_b32 v100, 7, v100
  v_lshlrev_b32 v101, 5, v3
  v_add_u32 v100, v100, v101
  buffer_load_dwordx4 v[4:7], v100, s[4:7], s26 offen offset:0 sc1
  buffer_load_dwordx4 v[8:11], v100, s[4:7], s26 offen offset:16 sc1
  buffer_load_dwordx4 v[12:15], v100, s[4:7], s26 offen offset:512 sc1
  buffer_load_dwordx4 v[16:19], v100, s[4:7], s26 offen offset:528 sc1
  buffer_load_dwordx4 v[20:23], v101, s[4:7], s26 offen offset:3584 sc1
  buffer_load_dwordx4 v[24:27], v101, s[4:7], s26 offen offset:3600 sc1
  v_subrev_u32 v111, 4096, v111
  ds_read_b128 v[60:63], v111 offset:0
  ds_read_b128 v[64:67], v111 offset:1024
  ds_read_b128 v[68:71], v111 offset:2048
  ds_read_b128 v[72:75], v111 offset:3072
  s_waitcnt vmcnt(0) lgkmcnt(0)
  v_cvt_pk_bf16_f32 v28, v4, v5
  v_cvt_pk_bf16_f32 v29, v6, v7
  v_cvt_pk_bf16_f32 v30, v8, v9
  v_cvt_pk_bf16_f32 v31, v10, v11
  v_cvt_pk_bf16_f32 v32, v12, v13
  v_cvt_pk_bf16_f32 v33, v14, v15
  v_cvt_pk_bf16_f32 v34, v16, v17
  v_cvt_pk_bf16_f32 v35, v18, v19
  v_cvt_pk_bf16_f32 v36, v20, v21
  v_cvt_pk_bf16_f32 v37, v22, v23
  v_cvt_pk_bf16_f32 v38, v24, v25
  v_cvt_pk_bf16_f32 v39, v26, v27
  s_lshl_b32 s26, s41, 15
  s_lshl_b32 s27, s42, 11
  s_add_u32 s26, s26, s27
  s_add_u32 s26, s26, 81803264
  v_mfma_f32_16x16x32_bf16 v[40:43], v[28:31], v[60:63], 0
  v_mfma_f32_16x16x32_bf16 v[44:47], v[32:35], v[60:63], 0
  v_mfma_f32_16x16x32_bf16 v[48:51], v[36:39], v[60:63], 0
  s_nop 7
  v_add_f32 v48, 0x358637bd, v48
  v_rcp_f32 v48, v48
  s_nop 0
  v_mul_f32 v40, v40, v48
  v_mul_f32 v41, v41, v48
  v_mul_f32 v42, v42, v48
  v_mul_f32 v43, v43, v48
  v_mul_f32 v44, v44, v48
  v_mul_f32 v45, v45, v48
  v_mul_f32 v46, v46, v48
  v_mul_f32 v47, v47, v48
  v_cvt_pk_bf16_f32 v76, v40, v41
  v_cvt_pk_bf16_f32 v77, v42, v43
  v_cvt_pk_bf16_f32 v78, v44, v45
  v_cvt_pk_bf16_f32 v79, v46, v47
  buffer_store_dwordx4 v[76:79], v1, s[4:7], s26 offen offset:0 sc1
  v_mfma_f32_16x16x32_bf16 v[40:43], v[28:31], v[64:67], 0
  v_mfma_f32_16x16x32_bf16 v[44:47], v[32:35], v[64:67], 0
  v_mfma_f32_16x16x32_bf16 v[48:51], v[36:39], v[64:67], 0
  s_nop 7
  v_add_f32 v48, 0x358637bd, v48
  v_rcp_f32 v48, v48
  s_nop 0
  v_mul_f32 v40, v40, v48
  v_mul_f32 v41, v41, v48
  v_mul_f32 v42, v42, v48
  v_mul_f32 v43, v43, v48
  v_mul_f32 v44, v44, v48
  v_mul_f32 v45, v45, v48
  v_mul_f32 v46, v46, v48
  v_mul_f32 v47, v47, v48
  v_cvt_pk_bf16_f32 v80, v40, v41
  v_cvt_pk_bf16_f32 v81, v42, v43
  v_cvt_pk_bf16_f32 v82, v44, v45
  v_cvt_pk_bf16_f32 v83, v46, v47
  buffer_store_dwordx4 v[80:83], v1, s[4:7], s26 offen offset:1024 sc1
  v_mfma_f32_16x16x32_bf16 v[40:43], v[28:31], v[68:71], 0
  v_mfma_f32_16x16x32_bf16 v[44:47], v[32:35], v[68:71], 0
  v_mfma_f32_16x16x32_bf16 v[48:51], v[36:39], v[68:71], 0
  s_nop 7
  v_add_f32 v48, 0x358637bd, v48
  v_rcp_f32 v48, v48
  s_nop 0
  v_mul_f32 v40, v40, v48
  v_mul_f32 v41, v41, v48
  v_mul_f32 v42, v42, v48
  v_mul_f32 v43, v43, v48
  v_mul_f32 v44, v44, v48
  v_mul_f32 v45, v45, v48
  v_mul_f32 v46, v46, v48
  v_mul_f32 v47, v47, v48
  v_cvt_pk_bf16_f32 v84, v40, v41
  v_cvt_pk_bf16_f32 v85, v42, v43
  v_cvt_pk_bf16_f32 v86, v44, v45
  v_cvt_pk_bf16_f32 v87, v46, v47
  s_add_u32 s26, s26, 32768
  buffer_store_dwordx4 v[84:87], v1, s[4:7], s26 offen offset:0 sc1
  v_mfma_f32_16x16x32_bf16 v[40:43], v[28:31], v[72:75], 0
  v_mfma_f32_16x16x32_bf16 v[44:47], v[32:35], v[72:75], 0
  v_mfma_f32_16x16x32_bf16 v[48:51], v[36:39], v[72:75], 0
  s_nop 7
  v_add_f32 v48, 0x358637bd, v48
  v_rcp_f32 v48, v48
  s_nop 0
  v_mul_f32 v40, v40, v48
  v_mul_f32 v41, v41, v48
  v_mul_f32 v42, v42, v48
  v_mul_f32 v43, v43, v48
  v_mul_f32 v44, v44, v48
  v_mul_f32 v45, v45, v48
  v_mul_f32 v46, v46, v48
  v_mul_f32 v47, v47, v48
  v_cvt_pk_bf16_f32 v88, v40, v41
  v_cvt_pk_bf16_f32 v89, v42, v43
  v_cvt_pk_bf16_f32 v90, v44, v45
  v_cvt_pk_bf16_f32 v91, v46, v47
  buffer_store_dwordx4 v[88:91], v1, s[4:7], s26 offen offset:1024 sc1
  s_waitcnt vmcnt(0)
  s_barrier
  s_lshl_b32 s26, s41, 6
  s_lshl_b32 s27, s43, 2
  s_add_u32 s26, s26, s27
  s_add_u32 s26, s26, 72554496
  s_cmp_lg_u32 s20, 0
  s_cbranch_scc1 Lsf_171
  s_mov_b64 exec, 1
  buffer_store_dword v113, v112, s[4:7], s26 offen sc1
  s_mov_b64 exec, -1
Lsf_171:
  s_add_u32 s26, s26, 64
  s_cmp_lg_u32 s20, 0
  s_cbranch_scc1 Lsf_172
  s_mov_b64 exec, 1
  buffer_store_dword v113, v112, s[4:7], s26 offen sc1
  s_mov_b64 exec, -1
Lsf_172:
Ll_done:
  s_mov_b32 s62, s40
Lit_loop:
  s_barrier
  s_mul_hi_u32 s41, s62, 390451573
  s_mul_i32 s26, s41, 11
  s_sub_u32 s42, s62, s26
  s_cmp_ge_u32 s42, 4
  s_cbranch_scc1 Lit_o
  s_lshl_b32 s43, s42, 2
  s_add_u32 s43, s43, s20
  s_mul_i32 s44, s20, 7424
  s_mul_i32 s45, s41, 28672
  s_mul_i32 s26, s20, 7168
  s_add_u32 s45, s45, s26
  s_mov_b64 exec, s[56:57]
  s_add_u32 m0, s44, 0
  s_nop 0
  buffer_load_dwordx4 v1, s[8:11], s45 offen offset:0 lds
  s_add_u32 m0, s44, 32
  s_nop 0
  buffer_load_dwordx4 v1, s[8:11], s45 offen offset:896 lds
  s_add_u32 m0, s44, 64
  s_nop 0
  buffer_load_dwordx4 v1, s[8:11], s45 offen offset:1792 lds
  s_add_u32 m0, s44, 96
  s_nop 0
  buffer_load_dwordx4 v1, s[8:11], s45 offen offset:2688 lds
  s_add_u32 s45, s45, 3584
  s_add_u32 m0, s44, 3712
  s_nop 0
  buffer_load_dwordx4 v1, s[8:11], s45 offen offset:0 lds
  s_add_u32 m0, s44, 3744
  s_nop 0
  buffer_load_dwordx4 v1, s[8:11], s45 offen offset:896 lds
  s_add_u32 m0, s44, 3776
  s_nop 0
  buffer_load_dwordx4 v1, s[8:11], s45 offen offset:1792 lds
  s_add_u32 m0, s44, 3808
  s_nop 0
  buffer_load_dwordx4 v1, s[8:11], s45 offen offset:2688 lds
  s_mov_b64 exec, -1
  s_lshl_b32 s26, s41, 4
  s_add_u32 s26, s26, s43
  s_lshl_b32 s27, s26, 2
  s_add_u32 s27, s27, 72546304
  s_mul_i32 s28, s26, 28672
  s_add_u32 s28, s28, 12845056
  s_mov_b32 s30, 1048576
Lwf_173:
  buffer_load_dword v110, v112, s[4:7], s27 offen sc1
  s_waitcnt vmcnt(0)
  v_cmp_gt_u32 vcc, 0x1, v110
  s_cbranch_vccz Lwfd_174
  s_sleep 2
  s_cmp_ge_u32 s41, 61
  s_cbranch_scc1 Lnap_175
  s_sleep 8
Lnap_175:
  s_sub_u32 s30, s30, 1
  s_cbranch_scc0 Lwf_173
  s_branch Lk1_exit
Lwfd_174:
  buffer_load_dwordx4 v[120:123], v1, s[4:7], s28 offen offset:0 sc1
  buffer_load_dwordx4 v[124:127], v1, s[4:7], s28 offen offset:1024 sc1
  buffer_load_dwordx4 v[128:131], v1, s[4:7], s28 offen offset:2048 sc1
  buffer_load_dwordx4 v[132:135], v1, s[4:7], s28 offen offset:3072 sc1
  s_add_u32 s28, s28, 4096
  buffer_load_dwordx4 v[136:139], v1, s[4:7], s28 offen offset:0 sc1
  buffer_load_dwordx4 v[140:143], v1, s[4:7], s28 offen offset:1024 sc1
  buffer_load_dwordx4 v[144:147], v1, s[4:7], s28 offen offset:2048 sc1
  buffer_load_dwordx4 v[148:151], v1, s[4:7], s28 offen offset:3072 sc1
  s_add_u32 s28, s28, 4096
  buffer_load_dwordx4 v[152:155], v1, s[4:7], s28 offen offset:0 sc1
  buffer_load_dwordx4 v[156:159], v1, s[4:7], s28 offen offset:1024 sc1
  buffer_load_dwordx4 v[160:163], v1, s[4:7], s28 offen offset:2048 sc1
  buffer_load_dwordx4 v[164:167], v1, s[4:7], s28 offen offset:3072 sc1
  s_add_u32 s28, s28, 4096
  buffer_load_dwordx4 v[168:171], v1, s[4:7], s28 offen offset:0 sc1
  buffer_load_dwordx4 v[172:175], v1, s[4:7], s28 offen offset:1024 sc1
  buffer_load_dwordx4 v[176:179], v1, s[4:7], s28 offen offset:2048 sc1
  buffer_load_dwordx4 v[180:183], v1, s[4:7], s28 offen offset:3072 sc1
  s_add_u32 s28, s28, 4096
  buffer_load_dwordx4 v[184:187], v1, s[4:7], s28 offen offset:0 sc1
  buffer_load_dwordx4 v[188:191], v1, s[4:7], s28 offen offset:1024 sc1
  buffer_load_dwordx4 v[192:195], v1, s[4:7], s28 offen offset:2048 sc1
  buffer_load_dwordx4 v[196:199], v1, s[4:7], s28 offen offset:3072 sc1
  s_add_u32 s28, s28, 4096
  buffer_load_dwordx4 v[200:203], v1, s[4:7], s28 offen offset:0 sc1
  buffer_load_dwordx4 v[204:207], v1, s[4:7], s28 offen offset:1024 sc1
  buffer_load_dwordx4 v[208:211], v1, s[4:7], s28 offen offset:2048 sc1
  buffer_load_dwordx4 v[212:215], v1, s[4:7], s28 offen offset:3072 sc1
  s_add_u32 s28, s28, 4096
  buffer_load_dwordx4 v[216:219], v1, s[4:7], s28 offen offset:0 sc1
  buffer_load_dwordx4 v[220:223], v1, s[4:7], s28 offen offset:1024 sc1
  buffer_load_dwordx4 v[224:227], v1, s[4:7], s28 offen offset:2048 sc1
  buffer_load_dwordx4 v[228:231], v1, s[4:7], s28 offen offset:3072 sc1
  v_lshrrev_b32 v104, 2, v2
  v_lshlrev_b32 v104, 3, v104
  v_and_b32 v100, 3, v2
  v_add_u32 v104, v104, v100
  v_mul_u32_u24 v104, 928, v104
  v_lshl_add_u32 v104, v3, 3, v104
  v_add_u32 v105, 3712, v104
  v_lshrrev_b32 v106, 1, v3
  v_lshlrev_b32 v106, 4, v106
  v_and_b32 v100, 1, v3
  v_lshl_add_u32 v106, v100, 2, v106
  v_bfe_u32 v100, v2, 2, 1
  v_add_u32 v106, v106, v100
  v_lshrrev_b32 v100, 3, v2
  v_lshl_add_u32 v106, v100, 3, v106
  v_lshlrev_b32 v106, 5, v106
  v_and_b32 v100, 3, v2
  v_lshl_add_u32 v106, v100, 3, v106
  v_and_b32 v100, 2, v0
  v_cmp_eq_u32 vcc, 0, v100
  v_mov_b32 v108, 0xdddd
  v_mov_b32 v100, 0x8888
  v_cndmask_b32 v108, v108, v100, vcc
  v_mov_b32 v20, 0
  v_mov_b32 v21, 0
  v_mov_b32 v22, 0
  v_mov_b32 v23, 0
  v_mov_b32 v24, 0
  v_mov_b32 v25, 0
  v_mov_b32 v26, 0
  v_mov_b32 v27, 0
  v_lshlrev_b32 v107, 3, v3
  v_sub_u32 v107, v2, v107
  s_waitcnt vmcnt(0)
  s_barrier
  ds_read2_b64 v[28:31], v104 offset0:0 offset1:4
  ds_read2_b64 v[32:35], v105 offset0:0 offset1:4
  ds_read2_b64 v[36:39], v104 offset0:8 offset1:12
  ds_read2_b64 v[40:43], v105 offset0:8 offset1:12
  s_waitcnt lgkmcnt(2)
  v_mfma_f32_16x16x32_bf16 v[4:7], v[28:31], v[120:123], 0
  v_mfma_f32_16x16x32_bf16 v[12:15], v[28:31], v[176:179], 0
  v_mfma_f32_16x16x32_bf16 v[8:11], v[32:35], v[120:123], 0
  v_mfma_f32_16x16x32_bf16 v[16:19], v[32:35], v[176:179], 0
  ds_read2_b64 v[28:31], v104 offset0:16 offset1:20
  ds_read2_b64 v[32:35], v105 offset0:16 offset1:20
  s_waitcnt lgkmcnt(2)
  v_mfma_f32_16x16x32_bf16 v[4:7], v[36:39], v[124:127], v[4:7]
  v_mfma_f32_16x16x32_bf16 v[12:15], v[36:39], v[180:183], v[12:15]
  v_mfma_f32_16x16x32_bf16 v[8:11], v[40:43], v[124:127], v[8:11]
  v_mfma_f32_16x16x32_bf16 v[16:19], v[40:43], v[180:183], v[16:19]
  ds_read2_b64 v[36:39], v104 offset0:24 offset1:28
  ds_read2_b64 v[40:43], v105 offset0:24 offset1:28
  s_waitcnt lgkmcnt(2)
  v_mfma_f32_16x16x32_bf16 v[4:7], v[28:31], v[128:131], v[4:7]
  v_mfma_f32_16x16x32_bf16 v[12:15], v[28:31], v[184:187], v[12:15]
  v_mfma_f32_16x16x32_bf16 v[8:11], v[32:35], v[128:131], v[8:11]
  v_mfma_f32_16x16x32_bf16 v[16:19], v[32:35], v[184:187], v[16:19]
  ds_read2_b64 v[28:31], v104 offset0:32 offset1:36
  ds_read2_b64 v[32:35], v105 offset0:32 offset1:36
  s_waitcnt lgkmcnt(2)
  v_mfma_f32_16x16x32_bf16 v[4:7], v[36:39], v[132:135], v[4:7]
  v_mfma_f32_16x16x32_bf16 v[12:15], v[36:39], v[188:191], v[12:15]
  v_mfma_f32_16x16x32_bf16 v[8:11], v[40:43], v[132:135], v[8:11]
  v_mfma_f32_16x16x32_bf16 v[16:19], v[40:43], v[188:191], v[16:19]
  ds_read2_b64 v[36:39], v104 offset0:40 offset1:44
  ds_read2_b64 v[40:43], v105 offset0:40 offset1:44
  s_waitcnt lgkmcnt(2)
  v_mfma_f32_16x16x32_bf16 v[4:7], v[28:31], v[136:139], v[4:7]
  v_mfma_f32_16x16x32_bf16 v[12:15], v[28:31], v[192:195], v[12:15]
  v_mfma_f32_16x16x32_bf16 v[8:11], v[32:35], v[136:139], v[8:11]
  v_mfma_f32_16x16x32_bf16 v[16:19], v[32:35], v[192:195], v[16:19]
  ds_read2_b64 v[28:31], v104 offset0:48 offset1:52
  ds_read2_b64 v[32:35], v105 offset0:48 offset1:52
  s_waitcnt lgkmcnt(2)
  v_mfma_f32_16x16x32_bf16 v[4:7], v[36:39], v[140:143], v[4:7]
  v_mfma_f32_16x16x32_bf16 v[12:15], v[36:39], v[196:199], v[12:15]
  v_mfma_f32_16x16x32_bf16 v[8:11], v[40:43], v[140:143], v[8:11]
  v_mfma_f32_16x16x32_bf16 v[16:19], v[40:43], v[196:199], v[16:19]
  ds_read2_b64 v[36:39], v104 offset0:56 offset1:60
  ds_read2_b64 v[40:43], v105 offset0:56 offset1:60
  s_waitcnt lgkmcnt(2)
  v_mfma_f32_16x16x32_bf16 v[4:7], v[28:31], v[144:147], v[4:7]
  v_mfma_f32_16x16x32_bf16 v[12:15], v[28:31], v[200:203], v[12:15]
  v_mfma_f32_16x16x32_bf16 v[8:11], v[32:35], v[144:147], v[8:11]
  v_mfma_f32_16x16x32_bf16 v[16:19], v[32:35], v[200:203], v[16:19]
  ds_read2_b64 v[28:31], v104 offset0:64 offset1:68
  ds_read2_b64 v[32:35], v105 offset0:64 offset1:68
  s_waitcnt lgkmcnt(2)
  v_mfma_f32_16x16x32_bf16 v[4:7], v[36:39], v[148:151], v[4:7]
  v_mfma_f32_16x16x32_bf16 v[12:15], v[36:39], v[204:207], v[12:15]
  v_mfma_f32_16x16x32_bf16 v[8:11], v[40:43], v[148:151], v[8:11]
  v_mfma_f32_16x16x32_bf16 v[16:19], v[40:43], v[204:207], v[16:19]
  ds_read2_b64 v[36:39], v104 offset0:72 offset1:76
  ds_read2_b64 v[40:43], v105 offset0:72 offset1:76
  s_waitcnt lgkmcnt(2)
  v_mfma_f32_16x16x32_bf16 v[4:7], v[28:31], v[152:155], v[4:7]
  v_mfma_f32_16x16x32_bf16 v[12:15], v[28:31], v[208:211], v[12:15]
  v_mfma_f32_16x16x32_bf16 v[8:11], v[32:35], v[152:155], v[8:11]
  v_mfma_f32_16x16x32_bf16 v[16:19], v[32:35], v[208:211], v[16:19]
  ds_read2_b64 v[28:31], v104 offset0:80 offset1:84
  ds_read2_b64 v[32:35], v105 offset0:80 offset1:84
  s_waitcnt lgkmcnt(2)
  v_mfma_f32_16x16x32_bf16 v[4:7], v[36:39], v[156:159], v[4:7]
  v_mfma_f32_16x16x32_bf16 v[12:15], v[36:39], v[212:215], v[12:15]
  v_mfma_f32_16x16x32_bf16 v[8:11], v[40:43], v[156:159], v[8:11]
  v_mfma_f32_16x16x32_bf16 v[16:19], v[40:43], v[212:215], v[16:19]
  ds_read2_b64 v[36:39], v104 offset0:88 offset1:92
  ds_read2_b64 v[40:43], v105 offset0:88 offset1:92
  s_waitcnt lgkmcnt(2)
  v_mfma_f32_16x16x32_bf16 v[4:7], v[28:31], v[160:163], v[4:7]
  v_mfma_f32_16x16x32_bf16 v[12:15], v[28:31], v[216:219], v[12:15]
  v_mfma_f32_16x16x32_bf16 v[8:11], v[32:35], v[160:163], v[8:11]
  v_mfma_f32_16x16x32_bf16 v[16:19], v[32:35], v[216:219], v[16:19]
  ds_read2_b64 v[28:31], v104 offset0:96 offset1:100
  ds_read2_b64 v[32:35], v105 offset0:96 offset1:100
  s_waitcnt lgkmcnt(2)
  v_mfma_f32_16x16x32_bf16 v[4:7], v[36:39], v[164:167], v[4:7]
  v_mfma_f32_16x16x32_bf16 v[12:15], v[36:39], v[220:223], v[12:15]
  v_mfma_f32_16x16x32_bf16 v[8:11], v[40:43], v[164:167], v[8:11]
  v_mfma_f32_16x16x32_bf16 v[16:19], v[40:43], v[220:223], v[16:19]
  ds_read2_b64 v[36:39], v104 offset0:104 offset1:108
  ds_read2_b64 v[40:43], v105 offset0:104 offset1:108
  s_waitcnt lgkmcnt(2)
  v_mfma_f32_16x16x32_bf16 v[4:7], v[28:31], v[168:171], v[4:7]
  v_mfma_f32_16x16x32_bf16 v[12:15], v[28:31], v[224:227], v[12:15]
  v_mfma_f32_16x16x32_bf16 v[8:11], v[32:35], v[168:171], v[8:11]
  v_mfma_f32_16x16x32_bf16 v[16:19], v[32:35], v[224:227], v[16:19]
  s_waitcnt lgkmcnt(0)
  v_mfma_f32_16x16x32_bf16 v[4:7], v[36:39], v[172:175], v[4:7]
  v_mfma_f32_16x16x32_bf16 v[12:15], v[36:39], v[228:231], v[12:15]
  v_mfma_f32_16x16x32_bf16 v[8:11], v[40:43], v[172:175], v[8:11]
  v_mfma_f32_16x16x32_bf16 v[16:19], v[40:43], v[228:231], v[16:19]
  v_mov_b32 v100, 0xf149f2ca
  v_cmp_le_i32 vcc, 0, v107
  s_nop 2
  v_cndmask_b32 v4, v100, v4, vcc
  v_cmp_le_i32 vcc, 1, v107
  s_nop 1
  v_cndmask_b32 v5, v100, v5, vcc
  v_cmp_le_i32 vcc, 2, v107
  s_nop 1
  v_cndmask_b32 v6, v100, v6, vcc
  v_cmp_le_i32 vcc, 3, v107
  s_nop 1
  v_cndmask_b32 v7, v100, v7, vcc
  v_cmp_le_i32 vcc, 4, v107
  s_nop 1
  v_cndmask_b32 v8, v100, v8, vcc
  v_cmp_le_i32 vcc, 5, v107
  s_nop 1
  v_cndmask_b32 v9, v100, v9, vcc
  v_cmp_le_i32 vcc, 6, v107
  s_nop 1
  v_cndmask_b32 v10, v100, v10, vcc
  v_cmp_le_i32 vcc, 7, v107
  s_nop 1
  v_cndmask_b32 v11, v100, v11, vcc
  v_cmp_le_i32 vcc, -16, v107
  s_nop 1
  v_cndmask_b32 v12, v100, v12, vcc
  v_cmp_le_i32 vcc, -15, v107
  s_nop 1
  v_cndmask_b32 v13, v100, v13, vcc
  v_cmp_le_i32 vcc, -14, v107
  s_nop 1
  v_cndmask_b32 v14, v100, v14, vcc
  v_cmp_le_i32 vcc, -13, v107
  s_nop 1
  v_cndmask_b32 v15, v100, v15, vcc
  v_cmp_le_i32 vcc, -12, v107
  s_nop 1
  v_cndmask_b32 v16, v100, v16, vcc
  v_cmp_le_i32 vcc, -11, v107
  s_nop 1
  v_cndmask_b32 v17, v100, v17, vcc
  v_cmp_le_i32 vcc, -10, v107
  s_nop 1
  v_cndmask_b32 v18, v100, v18, vcc
  v_cmp_le_i32 vcc, -9, v107
  s_nop 1
  v_cndmask_b32 v19, v100, v19, vcc
  s_cmp_lg_u32 s20, 0
  s_cbranch_scc1 Lap_176
  s_cmp_lt_u32 s41, 10
  s_cbranch_scc1 Lap_176
  s_sub_u32 s27, s41, 10
  s_lshl_b32 s27, s27, 6
  s_add_u32 s27, s27, 72542208
  s_mov_b32 s30, 1048576
Lwf_177:
  buffer_load_dword v110, v112, s[4:7], s27 offen sc1
  s_waitcnt vmcnt(0)
  v_cmp_gt_u32 vcc, 0x1, v110
  s_cbranch_vccz Lwfd_178
  s_sleep 60
  s_sub_u32 s30, s30, 1
  s_cbranch_scc0 Lwf_177
  s_branch Lk1_exit
Lwfd_178:
  s_cmp_ge_u32 s41, 61
  s_cbranch_scc1 Lap_176
  s_add_u32 s27, s27, 576
  s_mov_b32 s30, 1048576
Lwf_179:
  buffer_load_dword v110, v112, s[4:7], s27 offen sc1
  s_waitcnt vmcnt(0)
  v_cmp_gt_u32 vcc, 0x1, v110
  s_cbranch_vccz Lwfd_180
  s_sleep 2
  s_cmp_ge_u32 s41, 61
  s_cbranch_scc1 Lnap_181
  s_sleep 8
Lnap_181:
  s_sub_u32 s30, s30, 1
  s_cbranch_scc0 Lwf_179
  s_branch Lk1_exit
Lwfd_180:
Lap_176:
  s_barrier
  s_mul_i32 s28, s41, 7168
  s_lshl_b32 s26, s20, 11
  s_add_u32 s28, s28, s26
  s_add_u32 s28, s28, 72079360
  s_add_u32 s26, s26, 32768
  v_add_u32 v101, s26, v1
  s_cmp_eq_u32 s20, 3
  s_cselect_b32 s29, 0, 1024
  s_add_u32 s29, s29, s28
  s_mov_b32 s30, 1048576
Lmx_182:
  buffer_load_dwordx4 v[28:31], v1, s[4:7], s28 offen sc1
  buffer_load_dwordx4 v[32:35], v1, s[4:7], s29 offen sc1
  s_waitcnt vmcnt(0)
  v_max3_u32 v102, v28, v29, v30
  v_max3_u32 v102, v102, v31, v32
  v_max3_u32 v102, v102, v33, v34
  v_max_u32 v102, v102, v35
  v_cmp_eq_u32 vcc, -1, v102
  s_cbranch_vccz Lmxd_183
  s_sleep 2
  s_cmp_ge_u32 s41, 61
  s_cbranch_scc1 Lnap_184
  s_sleep 8
Lnap_184:
  s_sub_u32 s30, s30, 1
  s_cbranch_scc0 Lmx_182
  s_branch Lk1_exit
Lmxd_183:
  ds_write_b128 v101, v[28:31]
  ds_write_b128 v101, v[32:35] offset:1024
  s_waitcnt lgkmcnt(0)
  s_barrier
  ds_read_b64_tr_b16 v[44:45], v106 offset:32768
  ds_read_b64_tr_b16 v[46:47], v106 offset:32832
  ds_read_b64_tr_b16 v[48:49], v106 offset:33792
  ds_read_b64_tr_b16 v[50:51], v106 offset:33856
  ds_read_b64_tr_b16 v[52:53], v106 offset:34816
  ds_read_b64_tr_b16 v[54:55], v106 offset:34880
  ds_read_b64_tr_b16 v[56:57], v106 offset:35840
  ds_read_b64_tr_b16 v[58:59], v106 offset:35904
  ds_read_b64_tr_b16 v[60:61], v106 offset:36864
  ds_read_b64_tr_b16 v[62:63], v106 offset:36928
  ds_read_b64_tr_b16 v[64:65], v106 offset:37888
  ds_read_b64_tr_b16 v[66:67], v106 offset:37952
  ds_read_b64_tr_b16 v[68:69], v106 offset:38912
  ds_read_b64_tr_b16 v[70:71], v106 offset:38976
  s_waitcnt lgkmcnt(12)
  v_smfmac_f32_16x16x64_bf16 v[20:23], v[44:47], v[120:127], v108
  v_smfmac_f32_16x16x64_bf16 v[24:27], v[44:47], v[176:183], v108
  s_waitcnt lgkmcnt(10)
  v_smfmac_f32_16x16x64_bf16 v[20:23], v[48:51], v[128:135], v108
  v_smfmac_f32_16x16x64_bf16 v[24:27], v[48:51], v[184:191], v108
  s_waitcnt lgkmcnt(8)
  v_smfmac_f32_16x16x64_bf16 v[20:23], v[52:55], v[136:143], v108
  v_smfmac_f32_16x16x64_bf16 v[24:27], v[52:55], v[192:199], v108
  s_waitcnt lgkmcnt(6)
  v_smfmac_f32_16x16x64_bf16 v[20:23], v[56:59], v[144:151], v108
  v_smfmac_f32_16x16x64_bf16 v[24:27], v[56:59], v[200:207], v108
  s_waitcnt lgkmcnt(4)
  v_smfmac_f32_16x16x64_bf16 v[20:23], v[60:63], v[152:159], v108
  v_smfmac_f32_16x16x64_bf16 v[24:27], v[60:63], v[208:215], v108
  s_waitcnt lgkmcnt(2)
  v_smfmac_f32_16x16x64_bf16 v[20:23], v[64:67], v[160:167], v108
  v_smfmac_f32_16x16x64_bf16 v[24:27], v[64:67], v[216:223], v108
  s_waitcnt lgkmcnt(0)
  v_smfmac_f32_16x16x64_bf16 v[20:23], v[68:71], v[168:175], v108
  v_smfmac_f32_16x16x64_bf16 v[24:27], v[68:71], v[224:231], v108
  s_nop 6
  v_add_f32 v20, v20, v22
  v_add_f32 v21, v21, v23
  v_add_f32 v24, v24, v26
  v_add_f32 v25, v25, v27
  s_mul_i32 s28, s41, 40960
  s_add_u32 s28, s28, 83900416
  s_lshl_b32 s26, s42, 11
  s_add_u32 s29, s28, s26
  s_lshl_b32 s26, s20, 8
  s_add_u32 s29, s29, s26
  s_add_u32 s29, s29, 32768
  s_lshl_b32 s26, s43, 11
  s_add_u32 s28, s28, s26
  v_lshlrev_b32 v103, 4, v2
  v_lshl_add_u32 v103, v3, 2, v103
  v_max3_f32 v101, v4, v5, v6
  v_max3_f32 v101, v101, v7, v8
  v_max3_f32 v101, v101, v9, v10
  v_max3_f32 v101, v101, v11, v20
  v_max_f32 v101, v101, v21
  v_mov_b32 v102, v101
  s_nop 1
  v_permlane16_swap_b32 v101, v102
  v_max_f32 v101, v101, v102
  v_mov_b32 v102, v101
  s_nop 1
  v_permlane32_swap_b32 v101, v102
  v_max_f32 v101, v101, v102
  v_sub_f32 v4, v4, v101
  v_sub_f32 v5, v5, v101
  v_sub_f32 v6, v6, v101
  v_sub_f32 v7, v7, v101
  v_sub_f32 v8, v8, v101
  v_sub_f32 v9, v9, v101
  v_sub_f32 v10, v10, v101
  v_sub_f32 v11, v11, v101
  v_sub_f32 v20, v20, v101
  v_sub_f32 v21, v21, v101
  v_exp_f32 v4, v4
  v_exp_f32 v5, v5
  v_exp_f32 v6, v6
  v_exp_f32 v7, v7
  v_exp_f32 v8, v8
  v_exp_f32 v9, v9
  v_exp_f32 v10, v10
  v_exp_f32 v11, v11
  v_exp_f32 v20, v20
  v_exp_f32 v21, v21
  s_nop 0
  v_add_f32 v101, v20, v21
  v_add_f32 v101, v101, v4
  v_add_f32 v101, v101, v5
  v_add_f32 v101, v101, v6
  v_add_f32 v101, v101, v7
  v_add_f32 v101, v101, v8
  v_add_f32 v101, v101, v9
  v_add_f32 v101, v101, v10
  v_add_f32 v101, v101, v11
  v_mov_b32 v102, v101
  s_nop 1
  v_permlane16_swap_b32 v101, v102
  v_add_f32 v101, v101, v102
  v_mov_b32 v102, v101
  s_nop 1
  v_permlane32_swap_b32 v101, v102
  v_add_f32 v101, v101, v102
  v_rcp_f32 v101, v101
  s_nop 0
  v_mul_f32 v4, v4, v101
  v_mul_f32 v5, v5, v101
  v_mul_f32 v6, v6, v101
  v_mul_f32 v7, v7, v101
  v_mul_f32 v8, v8, v101
  v_mul_f32 v9, v9, v101
  v_mul_f32 v10, v10, v101
  v_mul_f32 v11, v11, v101
  v_mul_f32 v20, v20, v101
  v_mul_f32 v21, v21, v101
  v_cvt_pk_bf16_f32 v28, v4, v5
  v_cvt_pk_bf16_f32 v29, v6, v7
  v_cvt_pk_bf16_f32 v30, v8, v9
  v_cvt_pk_bf16_f32 v31, v10, v11
  v_cvt_pk_bf16_f32 v32, v20, v21
  buffer_store_dwordx4 v[28:31], v1, s[4:7], s28 offen offset:0 sc1
  buffer_store_dword v32, v103, s[4:7], s29 offen offset:0 sc1
  v_max3_f32 v101, v12, v13, v14
  v_max3_f32 v101, v101, v15, v16
  v_max3_f32 v101, v101, v17, v18
  v_max3_f32 v101, v101, v19, v24
  v_max_f32 v101, v101, v25
  v_mov_b32 v102, v101
  s_nop 1
  v_permlane16_swap_b32 v101, v102
  v_max_f32 v101, v101, v102
  v_mov_b32 v102, v101
  s_nop 1
  v_permlane32_swap_b32 v101, v102
  v_max_f32 v101, v101, v102
  v_sub_f32 v12, v12, v101
  v_sub_f32 v13, v13, v101
  v_sub_f32 v14, v14, v101
  v_sub_f32 v15, v15, v101
  v_sub_f32 v16, v16, v101
  v_sub_f32 v17, v17, v101
  v_sub_f32 v18, v18, v101
  v_sub_f32 v19, v19, v101
  v_sub_f32 v24, v24, v101
  v_sub_f32 v25, v25, v101
  v_exp_f32 v12, v12
  v_exp_f32 v13, v13
  v_exp_f32 v14, v14
  v_exp_f32 v15, v15
  v_exp_f32 v16, v16
  v_exp_f32 v17, v17
  v_exp_f32 v18, v18
  v_exp_f32 v19, v19
  v_exp_f32 v24, v24
  v_exp_f32 v25, v25
  s_nop 0
  v_add_f32 v101, v24, v25
  v_add_f32 v101, v101, v12
  v_add_f32 v101, v101, v13
  v_add_f32 v101, v101, v14
  v_add_f32 v101, v101, v15
  v_add_f32 v101, v101, v16
  v_add_f32 v101, v101, v17
  v_add_f32 v101, v101, v18
  v_add_f32 v101, v101, v19
  v_mov_b32 v102, v101
  s_nop 1
  v_permlane16_swap_b32 v101, v102
  v_add_f32 v101, v101, v102
  v_mov_b32 v102, v101
  s_nop 1
  v_permlane32_swap_b32 v101, v102
  v_add_f32 v101, v101, v102
  v_rcp_f32 v101, v101
  s_nop 0
  v_mul_f32 v12, v12, v101
  v_mul_f32 v13, v13, v101
  v_mul_f32 v14, v14, v101
  v_mul_f32 v15, v15, v101
  v_mul_f32 v16, v16, v101
  v_mul_f32 v17, v17, v101
  v_mul_f32 v18, v18, v101
  v_mul_f32 v19, v19, v101
  v_mul_f32 v24, v24, v101
  v_mul_f32 v25, v25, v101
  v_cvt_pk_bf16_f32 v36, v12, v13
  v_cvt_pk_bf16_f32 v37, v14, v15
  v_cvt_pk_bf16_f32 v38, v16, v17
  v_cvt_pk_bf16_f32 v39, v18, v19
  v_cvt_pk_bf16_f32 v40, v24, v25
  buffer_store_dwordx4 v[36:39], v1, s[4:7], s28 offen offset:1024 sc1
  buffer_store_dword v40, v103, s[4:7], s29 offen offset:1024 sc1
  s_waitcnt vmcnt(0)
  s_barrier
  s_lshl_b32 s26, s41, 6
  s_lshl_b32 s27, s42, 2
  s_add_u32 s26, s26, s27
  s_add_u32 s26, s26, 72550400
  s_cmp_lg_u32 s20, 0
  s_cbranch_scc1 Lsf_185
  s_mov_b64 exec, 1
  buffer_store_dword v113, v112, s[4:7], s26 offen sc1
  s_mov_b64 exec, -1
Lsf_185:
  s_branch Lit_next
Lit_o:
  s_sub_u32 s42, s42, 4
  s_lshl_b32 s43, s42, 2
  s_add_u32 s43, s43, s20
  s_lshl_b32 s28, s43, 14
  s_add_u32 s28, s28, 81344512
  buffer_load_dwordx4 v[120:123], v1, s[4:7], s28 offen offset:0 sc1
  buffer_load_dwordx4 v[124:127], v1, s[4:7], s28 offen offset:1024 sc1
  buffer_load_dwordx4 v[128:131], v1, s[4:7], s28 offen offset:2048 sc1
  buffer_load_dwordx4 v[132:135], v1, s[4:7], s28 offen offset:3072 sc1
  s_add_u32 s28, s28, 4096
  buffer_load_dwordx4 v[136:139], v1, s[4:7], s28 offen offset:0 sc1
  buffer_load_dwordx4 v[140:143], v1, s[4:7], s28 offen offset:1024 sc1
  buffer_load_dwordx4 v[144:147], v1, s[4:7], s28 offen offset:2048 sc1
  buffer_load_dwordx4 v[148:151], v1, s[4:7], s28 offen offset:3072 sc1
  s_add_u32 s28, s28, 4096
  buffer_load_dwordx4 v[152:155], v1, s[4:7], s28 offen offset:0 sc1
  buffer_load_dwordx4 v[156:159], v1, s[4:7], s28 offen offset:1024 sc1
  buffer_load_dwordx4 v[160:163], v1, s[4:7], s28 offen offset:2048 sc1
  buffer_load_dwordx4 v[164:167], v1, s[4:7], s28 offen offset:3072 sc1
  s_add_u32 s28, s28, 4096
  buffer_load_dwordx4 v[168:171], v1, s[4:7], s28 offen offset:0 sc1
  buffer_load_dwordx4 v[172:175], v1, s[4:7], s28 offen offset:1024 sc1
  buffer_load_dwordx4 v[176:179], v1, s[4:7], s28 offen offset:2048 sc1
  buffer_load_dwordx4 v[180:183], v1, s[4:7], s28 offen offset:3072 sc1
  s_lshl_b32 s26, s43, 4
  v_add_u32 v105, s26, v2
  v_mul_u32_u24 v104, 0x925, v105
  v_lshrrev_b32 v104, 16, v104
  v_mul_u32_u24 v100, 28, v104
  v_sub_u32 v105, v105, v100
  v_mul_u32_u24 v100, 28, v3
  v_add_u32 v100, v100, v105
  v_lshlrev_b32 v100, 4, v100
  v_mul_u32_u24 v106, 1835008, v104
  v_add_u32 v106, v106, v100
  v_mul_u32_u24 v107, 458752, v104
  v_add_u32 v107, v107, v100
  v_and_b32 v108, 3, v2
  v_lshlrev_b32 v108, 2, v108
  v_lshlrev_b32 v101, 8, v2
  s_lshl_b32 s27, s41, 2
  s_add_u32 s27, s27, 72538112
  s_mov_b32 s30, 1048576
Lwf_186:
  buffer_load_dword v110, v101, s[4:7], s27 offen sc1
  s_waitcnt vmcnt(0)
  v_cmp_gt_u32 vcc, 0x1, v110
  s_cbranch_vccz Lwfd_187
  s_sleep 2
  s_cmp_ge_u32 s41, 61
  s_cbranch_scc1 Lnap_188
  s_sleep 8
Lnap_188:
  s_sub_u32 s30, s30, 1
  s_cbranch_scc0 Lwf_186
  s_branch Lk1_exit
Lwfd_187:
  s_lshl_b32 s27, s41, 6
  s_add_u32 s27, s27, 72554496
  s_mov_b32 s30, 1048576
Lwf_189:
  buffer_load_dword v110, v108, s[4:7], s27 offen sc1
  s_waitcnt vmcnt(0)
  v_cmp_gt_u32 vcc, 0x1, v110
  s_cbranch_vccz Lwfd_190
  s_sleep 2
  s_cmp_ge_u32 s41, 61
  s_cbranch_scc1 Lnap_191
  s_sleep 8
Lnap_191:
  s_sub_u32 s30, s30, 1
  s_cbranch_scc0 Lwf_189
  s_branch Lk1_exit
Lwfd_190:
  s_lshl_b32 s28, s41, 15
  s_lshl_b32 s26, s20, 13
  s_add_u32 s28, s28, s26
  s_add_u32 s28, s28, 81803264
  s_add_u32 s29, s26, 40960
  s_mov_b32 m0, s29
  s_nop 0
  buffer_load_dwordx4 v1, s[4:7], s28 offen offset:0 sc1 lds
  buffer_load_dwordx4 v1, s[4:7], s28 offen offset:1024 sc1 lds
  buffer_load_dwordx4 v1, s[4:7], s28 offen offset:2048 sc1 lds
  buffer_load_dwordx4 v1, s[4:7], s28 offen offset:3072 sc1 lds
  s_add_u32 s28, s28, 4096
  s_add_u32 s29, s29, 4096
  s_mov_b32 m0, s29
  s_nop 0
  buffer_load_dwordx4 v1, s[4:7], s28 offen offset:0 sc1 lds
  buffer_load_dwordx4 v1, s[4:7], s28 offen offset:1024 sc1 lds
  buffer_load_dwordx4 v1, s[4:7], s28 offen offset:2048 sc1 lds
  buffer_load_dwordx4 v1, s[4:7], s28 offen offset:3072 sc1 lds
  s_mul_i32 s28, s41, 28672
  s_add_u32 s28, s28, 42205184
  buffer_load_dwordx4 v[184:187], v106, s[4:7], s28 offen offset:0 sc1
  buffer_load_dwordx4 v[188:191], v106, s[4:7], s28 offen offset:1792 sc1
  s_add_u32 s28, s28, 3584
  buffer_load_dwordx4 v[192:195], v106, s[4:7], s28 offen offset:0 sc1
  buffer_load_dwordx4 v[196:199], v106, s[4:7], s28 offen offset:1792 sc1
  s_add_u32 s28, s28, 3584
  buffer_load_dwordx4 v[200:203], v106, s[4:7], s28 offen offset:0 sc1
  buffer_load_dwordx4 v[204:207], v106, s[4:7], s28 offen offset:1792 sc1
  s_add_u32 s28, s28, 3584
  buffer_load_dwordx4 v[208:211], v106, s[4:7], s28 offen offset:0 sc1
  buffer_load_dwordx4 v[212:215], v106, s[4:7], s28 offen offset:1792 sc1
  s_add_u32 s28, s28, 3584
  buffer_load_dwordx4 v[216:219], v106, s[4:7], s28 offen offset:0 sc1
  buffer_load_dwordx4 v[220:223], v106, s[4:7], s28 offen offset:1792 sc1
  s_add_u32 s28, s28, 3584
  buffer_load_dwordx4 v[224:227], v106, s[4:7], s28 offen offset:0 sc1
  buffer_load_dwordx4 v[228:231], v106, s[4:7], s28 offen offset:1792 sc1
  s_add_u32 s28, s28, 3584
  buffer_load_dwordx4 v[232:235], v106, s[4:7], s28 offen offset:0 sc1
  buffer_load_dwordx4 v[236:239], v106, s[4:7], s28 offen offset:1792 sc1
  s_add_u32 s28, s28, 3584
  buffer_load_dwordx4 v[240:243], v106, s[4:7], s28 offen offset:0 sc1
  buffer_load_dwordx4 v[244:247], v106, s[4:7], s28 offen offset:1792 sc1
  s_lshl_b32 s28, s41, 7
  s_add_u32 s28, s28, 86521856
  v_lshlrev_b32 v101, 2, v2
  buffer_load_dword v84, v101, s[4:7], s28 offen offset:0 sc1
  buffer_load_dword v85, v101, s[4:7], s28 offen offset:64 sc1
  s_waitcnt vmcnt(0)
  s_barrier
  v_add_u32 v1, 40960, v1
  ds_read_b128 v[20:23], v1 offset:0
  ds_read_b128 v[24:27], v1 offset:1024
  ds_read_b128 v[28:31], v1 offset:2048
  ds_read_b128 v[32:35], v1 offset:3072
  ds_read_b128 v[36:39], v1 offset:4096
  ds_read_b128 v[40:43], v1 offset:5120
  ds_read_b128 v[44:47], v1 offset:6144
  ds_read_b128 v[48:51], v1 offset:7168
  s_waitcnt lgkmcnt(6)
  v_mfma_f32_16x16x32_bf16 v[4:7], v[120:123], v[20:23], 0
  v_mfma_f32_16x16x32_bf16 v[8:11], v[120:123], v[24:27], 0
  ds_read_b128 v[20:23], v1 offset:8192
  ds_read_b128 v[24:27], v1 offset:9216
  s_waitcnt lgkmcnt(6)
  v_mfma_f32_16x16x32_bf16 v[4:7], v[124:127], v[28:31], v[4:7]
  v_mfma_f32_16x16x32_bf16 v[8:11], v[124:127], v[32:35], v[8:11]
  ds_read_b128 v[28:31], v1 offset:10240
  ds_read_b128 v[32:35], v1 offset:11264
  s_waitcnt lgkmcnt(6)
  v_mfma_f32_16x16x32_bf16 v[4:7], v[128:131], v[36:39], v[4:7]
  v_mfma_f32_16x16x32_bf16 v[8:11], v[128:131], v[40:43], v[8:11]
  ds_read_b128 v[36:39], v1 offset:12288
  ds_read_b128 v[40:43], v1 offset:13312
  s_waitcnt lgkmcnt(6)
  v_mfma_f32_16x16x32_bf16 v[4:7], v[132:135], v[44:47], v[4:7]
  v_mfma_f32_16x16x32_bf16 v[8:11], v[132:135], v[48:51], v[8:11]
  ds_read_b128 v[44:47], v1 offset:14336
  ds_read_b128 v[48:51], v1 offset:15360
  s_waitcnt lgkmcnt(6)
  v_mfma_f32_16x16x32_bf16 v[4:7], v[136:139], v[20:23], v[4:7]
  v_mfma_f32_16x16x32_bf16 v[8:11], v[136:139], v[24:27], v[8:11]
  ds_read_b128 v[20:23], v1 offset:16384
  ds_read_b128 v[24:27], v1 offset:17408
  s_waitcnt lgkmcnt(6)
  v_mfma_f32_16x16x32_bf16 v[4:7], v[140:143], v[28:31], v[4:7]
  v_mfma_f32_16x16x32_bf16 v[8:11], v[140:143], v[32:35], v[8:11]
  ds_read_b128 v[28:31], v1 offset:18432
  ds_read_b128 v[32:35], v1 offset:19456
  s_waitcnt lgkmcnt(6)
  v_mfma_f32_16x16x32_bf16 v[4:7], v[144:147], v[36:39], v[4:7]
  v_mfma_f32_16x16x32_bf16 v[8:11], v[144:147], v[40:43], v[8:11]
  ds_read_b128 v[36:39], v1 offset:20480
  ds_read_b128 v[40:43], v1 offset:21504
  s_waitcnt lgkmcnt(6)
  v_mfma_f32_16x16x32_bf16 v[4:7], v[148:151], v[44:47], v[4:7]
  v_mfma_f32_16x16x32_bf16 v[8:11], v[148:151], v[48:51], v[8:11]
  ds_read_b128 v[44:47], v1 offset:22528
  ds_read_b128 v[48:51], v1 offset:23552
  s_waitcnt lgkmcnt(6)
  v_mfma_f32_16x16x32_bf16 v[4:7], v[152:155], v[20:23], v[4:7]
  v_mfma_f32_16x16x32_bf16 v[8:11], v[152:155], v[24:27], v[8:11]
  ds_read_b128 v[20:23], v1 offset:24576
  ds_read_b128 v[24:27], v1 offset:25600
  s_waitcnt lgkmcnt(6)
  v_mfma_f32_16x16x32_bf16 v[4:7], v[156:159], v[28:31], v[4:7]
  v_mfma_f32_16x16x32_bf16 v[8:11], v[156:159], v[32:35], v[8:11]
  ds_read_b128 v[28:31], v1 offset:26624
  ds_read_b128 v[32:35], v1 offset:27648
  s_waitcnt lgkmcnt(6)
  v_mfma_f32_16x16x32_bf16 v[4:7], v[160:163], v[36:39], v[4:7]
  v_mfma_f32_16x16x32_bf16 v[8:11], v[160:163], v[40:43], v[8:11]
  ds_read_b128 v[36:39], v1 offset:28672
  ds_read_b128 v[40:43], v1 offset:29696
  s_waitcnt lgkmcnt(6)
  v_mfma_f32_16x16x32_bf16 v[4:7], v[164:167], v[44:47], v[4:7]
  v_mfma_f32_16x16x32_bf16 v[8:11], v[164:167], v[48:51], v[8:11]
  ds_read_b128 v[44:47], v1 offset:30720
  ds_read_b128 v[48:51], v1 offset:31744
  s_waitcnt lgkmcnt(6)
  v_mfma_f32_16x16x32_bf16 v[4:7], v[168:171], v[20:23], v[4:7]
  v_mfma_f32_16x16x32_bf16 v[8:11], v[168:171], v[24:27], v[8:11]
  s_waitcnt lgkmcnt(4)
  v_mfma_f32_16x16x32_bf16 v[4:7], v[172:175], v[28:31], v[4:7]
  v_mfma_f32_16x16x32_bf16 v[8:11], v[172:175], v[32:35], v[8:11]
  s_waitcnt lgkmcnt(2)
  v_mfma_f32_16x16x32_bf16 v[4:7], v[176:179], v[36:39], v[4:7]
  v_mfma_f32_16x16x32_bf16 v[8:11], v[176:179], v[40:43], v[8:11]
  s_waitcnt lgkmcnt(0)
  v_mfma_f32_16x16x32_bf16 v[4:7], v[180:183], v[44:47], v[4:7]
  v_mfma_f32_16x16x32_bf16 v[8:11], v[180:183], v[48:51], v[8:11]
  v_subrev_u32 v1, 40960, v1
  s_cmp_lg_u32 s20, 0
  s_cbranch_scc1 Lap_192
  s_cmp_lt_u32 s41, 10
  s_cbranch_scc1 Lap_192
  s_sub_u32 s27, s41, 10
  s_lshl_b32 s27, s27, 6
  s_add_u32 s27, s27, 72542208
  s_mov_b32 s30, 1048576
Lwf_193:
  buffer_load_dword v110, v112, s[4:7], s27 offen sc1
  s_waitcnt vmcnt(0)
  v_cmp_gt_u32 vcc, 0x1, v110
  s_cbranch_vccz Lwfd_194
  s_sleep 60
  s_sub_u32 s30, s30, 1
  s_cbranch_scc0 Lwf_193
  s_branch Lk1_exit
Lwfd_194:
Lap_192:
  s_barrier
  v_add_u32 v108, 8192, v108
  v_cmp_gt_u32 vcc, 32, v0
  s_nop 1
  v_cndmask_b32 v108, v101, v108, vcc
  s_lshl_b32 s27, s41, 6
  s_add_u32 s27, s27, 72542208
  s_mov_b32 s30, 1048576
Lwf_195:
  buffer_load_dword v110, v108, s[4:7], s27 offen sc1
  s_waitcnt vmcnt(0)
  v_cmp_gt_u32 vcc, 0x1, v110
  s_cbranch_vccz Lwfd_196
  s_sleep 2
  s_cmp_ge_u32 s41, 61
  s_cbranch_scc1 Lnap_197
  s_sleep 8
Lnap_197:
  s_sub_u32 s30, s30, 1
  s_cbranch_scc0 Lwf_195
  s_branch Lk1_exit
Lwfd_196:
  s_mul_i32 s28, s41, 40960
  s_mul_i32 s29, s20, 10240
  s_add_u32 s28, s28, s29
  s_add_u32 s28, s28, 83900416
  s_mov_b32 m0, s29
  s_nop 0
  buffer_load_dwordx4 v1, s[4:7], s28 offen offset:0 sc1 lds
  buffer_load_dwordx4 v1, s[4:7], s28 offen offset:1024 sc1 lds
  buffer_load_dwordx4 v1, s[4:7], s28 offen offset:2048 sc1 lds
  buffer_load_dwordx4 v1, s[4:7], s28 offen offset:3072 sc1 lds
  s_add_u32 s28, s28, 4096
  s_add_u32 s29, s29, 4096
  s_mov_b32 m0, s29
  s_nop 0
  buffer_load_dwordx4 v1, s[4:7], s28 offen offset:0 sc1 lds
  buffer_load_dwordx4 v1, s[4:7], s28 offen offset:1024 sc1 lds
  buffer_load_dwordx4 v1, s[4:7], s28 offen offset:2048 sc1 lds
  buffer_load_dwordx4 v1, s[4:7], s28 offen offset:3072 sc1 lds
  s_add_u32 s28, s28, 4096
  s_add_u32 s29, s29, 4096
  s_mov_b32 m0, s29
  s_nop 0
  buffer_load_dwordx4 v1, s[4:7], s28 offen offset:0 sc1 lds
  buffer_load_dwordx4 v1, s[4:7], s28 offen offset:1024 sc1 lds
  s_mul_i32 s28, s41, 7168
  s_add_u32 s28, s28, 72628224
  s_add_u32 s29, s28, 3584
  buffer_load_dwordx4 v[68:71], v107, s[4:7], s28 offen offset:0 sc1
  buffer_load_dwordx4 v[72:75], v107, s[4:7], s28 offen offset:1792 sc1
  buffer_load_dwordx4 v[76:79], v107, s[4:7], s29 offen offset:0 sc1
  buffer_load_dwordx4 v[80:83], v107, s[4:7], s29 offen offset:1792 sc1
  s_mul_i32 s28, s41, 28672
  s_lshl_b32 s26, s43, 5
  s_add_u32 s28, s28, s26
  s_add_u32 s29, s28, 14336
  v_mul_u32_u24 v100, 896, v2
  v_lshl_add_u32 v100, v3, 3, v100
  v_mul_f32 v4, v4, v84
  v_mul_f32 v5, v5, v84
  v_mul_f32 v6, v6, v84
  v_mul_f32 v7, v7, v84
  v_sub_f32 v84, 1.0, v84
  v_mul_f32 v8, v8, v85
  v_mul_f32 v9, v9, v85
  v_mul_f32 v10, v10, v85
  v_mul_f32 v11, v11, v85
  v_sub_f32 v85, 1.0, v85
  s_waitcnt vmcnt(0)
  s_barrier
  ds_read_b128 v[20:23], v1 offset:0
  ds_read_b128 v[24:27], v1 offset:1024
  ds_read_b128 v[28:31], v1 offset:2048
  ds_read_b128 v[32:35], v1 offset:3072
  ds_read_b128 v[36:39], v1 offset:4096
  ds_read_b128 v[40:43], v1 offset:5120
  ds_read_b128 v[44:47], v1 offset:6144
  ds_read_b128 v[48:51], v1 offset:7168
  s_waitcnt lgkmcnt(6)
  v_mfma_f32_16x16x32_bf16 v[12:15], v[184:187], v[20:23], 0
  v_mfma_f32_16x16x32_bf16 v[16:19], v[184:187], v[24:27], 0
  ds_read_b128 v[20:23], v1 offset:8192
  ds_read_b128 v[24:27], v1 offset:9216
  s_waitcnt lgkmcnt(6)
  v_mfma_f32_16x16x32_bf16 v[12:15], v[188:191], v[28:31], v[12:15]
  v_mfma_f32_16x16x32_bf16 v[16:19], v[188:191], v[32:35], v[16:19]
  ds_read_b128 v[28:31], v1 offset:10240
  ds_read_b128 v[32:35], v1 offset:11264
  s_waitcnt lgkmcnt(6)
  v_mfma_f32_16x16x32_bf16 v[12:15], v[192:195], v[36:39], v[12:15]
  v_mfma_f32_16x16x32_bf16 v[16:19], v[192:195], v[40:43], v[16:19]
  ds_read_b128 v[36:39], v1 offset:12288
  ds_read_b128 v[40:43], v1 offset:13312
  s_waitcnt lgkmcnt(6)
  v_mfma_f32_16x16x32_bf16 v[12:15], v[196:199], v[44:47], v[12:15]
  v_mfma_f32_16x16x32_bf16 v[16:19], v[196:199], v[48:51], v[16:19]
  ds_read_b128 v[44:47], v1 offset:14336
  ds_read_b128 v[48:51], v1 offset:15360
  s_waitcnt lgkmcnt(6)
  v_mfma_f32_16x16x32_bf16 v[12:15], v[200:203], v[20:23], v[12:15]
  v_mfma_f32_16x16x32_bf16 v[16:19], v[200:203], v[24:27], v[16:19]
  ds_read_b128 v[20:23], v1 offset:16384
  ds_read_b128 v[24:27], v1 offset:17408
  s_waitcnt lgkmcnt(6)
  v_mfma_f32_16x16x32_bf16 v[12:15], v[204:207], v[28:31], v[12:15]
  v_mfma_f32_16x16x32_bf16 v[16:19], v[204:207], v[32:35], v[16:19]
  ds_read_b128 v[28:31], v1 offset:18432
  ds_read_b128 v[32:35], v1 offset:19456
  s_waitcnt lgkmcnt(6)
  v_mfma_f32_16x16x32_bf16 v[12:15], v[208:211], v[36:39], v[12:15]
  v_mfma_f32_16x16x32_bf16 v[16:19], v[208:211], v[40:43], v[16:19]
  ds_read_b128 v[36:39], v1 offset:20480
  ds_read_b128 v[40:43], v1 offset:21504
  s_waitcnt lgkmcnt(6)
  v_mfma_f32_16x16x32_bf16 v[12:15], v[212:215], v[44:47], v[12:15]
  v_mfma_f32_16x16x32_bf16 v[16:19], v[212:215], v[48:51], v[16:19]
  ds_read_b128 v[44:47], v1 offset:22528
  ds_read_b128 v[48:51], v1 offset:23552
  s_waitcnt lgkmcnt(6)
  v_mfma_f32_16x16x32_bf16 v[12:15], v[216:219], v[20:23], v[12:15]
  v_mfma_f32_16x16x32_bf16 v[16:19], v[216:219], v[24:27], v[16:19]
  ds_read_b128 v[20:23], v1 offset:24576
  ds_read_b128 v[24:27], v1 offset:25600
  s_waitcnt lgkmcnt(6)
  v_mfma_f32_16x16x32_bf16 v[12:15], v[220:223], v[28:31], v[12:15]
  v_mfma_f32_16x16x32_bf16 v[16:19], v[220:223], v[32:35], v[16:19]
  ds_read_b128 v[28:31], v1 offset:26624
  ds_read_b128 v[32:35], v1 offset:27648
  s_waitcnt lgkmcnt(6)
  v_mfma_f32_16x16x32_bf16 v[12:15], v[224:227], v[36:39], v[12:15]
  v_mfma_f32_16x16x32_bf16 v[16:19], v[224:227], v[40:43], v[16:19]
  ds_read_b128 v[36:39], v1 offset:28672
  ds_read_b128 v[40:43], v1 offset:29696
  s_waitcnt lgkmcnt(6)
  v_mfma_f32_16x16x32_bf16 v[12:15], v[228:231], v[44:47], v[12:15]
  v_mfma_f32_16x16x32_bf16 v[16:19], v[228:231], v[48:51], v[16:19]
  ds_read_b128 v[44:47], v1 offset:30720
  ds_read_b128 v[48:51], v1 offset:31744
  s_waitcnt lgkmcnt(6)
  v_mfma_f32_16x16x32_bf16 v[12:15], v[232:235], v[20:23], v[12:15]
  v_mfma_f32_16x16x32_bf16 v[16:19], v[232:235], v[24:27], v[16:19]
  ds_read_b128 v[20:23], v1 offset:32768
  ds_read_b128 v[24:27], v1 offset:33792
  s_waitcnt lgkmcnt(6)
  v_mfma_f32_16x16x32_bf16 v[12:15], v[236:239], v[28:31], v[12:15]
  v_mfma_f32_16x16x32_bf16 v[16:19], v[236:239], v[32:35], v[16:19]
  ds_read_b128 v[28:31], v1 offset:34816
  ds_read_b128 v[32:35], v1 offset:35840
  s_waitcnt lgkmcnt(6)
  v_mfma_f32_16x16x32_bf16 v[12:15], v[240:243], v[36:39], v[12:15]
  v_mfma_f32_16x16x32_bf16 v[16:19], v[240:243], v[40:43], v[16:19]
  ds_read_b128 v[36:39], v1 offset:36864
  ds_read_b128 v[40:43], v1 offset:37888
  s_waitcnt lgkmcnt(6)
  v_mfma_f32_16x16x32_bf16 v[12:15], v[244:247], v[44:47], v[12:15]
  v_mfma_f32_16x16x32_bf16 v[16:19], v[244:247], v[48:51], v[16:19]
  ds_read_b128 v[44:47], v1 offset:38912
  ds_read_b128 v[48:51], v1 offset:39936
  s_waitcnt lgkmcnt(6)
  v_mfma_f32_16x16x32_bf16 v[12:15], v[68:71], v[20:23], v[12:15]
  v_mfma_f32_16x16x32_bf16 v[16:19], v[68:71], v[24:27], v[16:19]
  s_waitcnt lgkmcnt(4)
  v_mfma_f32_16x16x32_bf16 v[12:15], v[72:75], v[28:31], v[12:15]
  v_mfma_f32_16x16x32_bf16 v[16:19], v[72:75], v[32:35], v[16:19]
  s_waitcnt lgkmcnt(2)
  v_mfma_f32_16x16x32_bf16 v[12:15], v[76:79], v[36:39], v[12:15]
  v_mfma_f32_16x16x32_bf16 v[16:19], v[76:79], v[40:43], v[16:19]
  s_waitcnt lgkmcnt(0)
  v_mfma_f32_16x16x32_bf16 v[12:15], v[80:83], v[44:47], v[12:15]
  v_mfma_f32_16x16x32_bf16 v[16:19], v[80:83], v[48:51], v[16:19]
  s_nop 6
  v_fma_f32 v4, v12, v84, v4
  v_fma_f32 v5, v13, v84, v5
  v_fma_f32 v6, v14, v84, v6
  v_fma_f32 v7, v15, v84, v7
  v_cvt_pk_bf16_f32 v4, v4, v5
  v_cvt_pk_bf16_f32 v5, v6, v7
  v_fma_f32 v8, v16, v85, v8
  v_fma_f32 v9, v17, v85, v9
  v_fma_f32 v10, v18, v85, v10
  v_fma_f32 v11, v19, v85, v11
  v_cvt_pk_bf16_f32 v8, v8, v9
  v_cvt_pk_bf16_f32 v9, v10, v11
  buffer_store_dwordx2 v[4:5], v100, s[12:15], s28 offen
  buffer_store_dwordx2 v[8:9], v100, s[12:15], s29 offen
Lit_next:
  s_add_u32 s62, s62, 208
  s_cmp_lt_u32 s62, 704
  s_cbranch_scc1 Lit_loop
  s_endpgm
Lfallback:
  s_cmp_lg_u32 s78, 31
  s_cbranch_scc1 Lrq_199
  s_add_u32 s75, s74, 1
  v_mov_b32 v8, s75
  v_mov_b32 v9, 0
  s_mov_b64 exec, 1
  buffer_atomic_cmpswap v[8:9], off, s[68:71], 0 offset:64
  s_mov_b64 exec, -1
Lrq_199:
  s_mov_b32 s30, 1048576
Lrl_198:
  buffer_load_dword v8, off, s[68:71], 0 offset:64 sc1
  s_waitcnt vmcnt(0)
  v_readfirstlane_b32 s79, v8
  s_nop 0
  s_sub_u32 s23, s79, 1
  s_cbranch_scc0 Ldispatch
  s_sub_u32 s30, s30, 1
  s_cbranch_scc0 Lrl_198
Lk1_exit:
  s_endpgm
.section .rodata,"a"
.p2align 6
.amdhsa_kernel gated_mix__linear_attn_block__memory_aug_recurrent_mem_tr__prompt_kernel
  .amdhsa_next_free_vgpr 512
  .amdhsa_next_free_sgpr 102
  .amdhsa_accum_offset 256
  .amdhsa_group_segment_fixed_size 0
  .amdhsa_kernarg_size 112
  .amdhsa_user_sgpr_count 2
  .amdhsa_user_sgpr_kernarg_segment_ptr 1
  .amdhsa_system_sgpr_workgroup_id_x 1
.end_amdhsa_kernel
```
